```python
import torch

def _softmax(x, axis=-1):
    return torch.softmax(x, dim=axis)
def _gelu(x):
    return torch.nn.functional.gelu(x, approximate="tanh")
def _silu(x):
    return torch.nn.functional.silu(x)
def _sigmoid(x):
    return torch.sigmoid(x)
def _layernorm(x, axis=-1, eps=1e-5):
    m = x.mean(dim=axis, keepdim=True)
    v = x.var(dim=axis, keepdim=True, unbiased=False)
    return (x - m) / torch.sqrt(v + eps)
def _scatter_add(tgt, idx, src, axis=0):
    return tgt.clone().index_add_(axis, idx, src)
def _segment_sum(src, seg, n):
    out = torch.zeros((n,) + src.shape[1:], dtype=src.dtype)
    return out.index_add_(0, seg, src)
def _pad(x, pw):
    flat = tuple(v for pair in reversed(pw) for v in pair)
    return torch.nn.functional.pad(x, flat)

kernel_name = 'parallel_sum__spectral_gfnet__dense_activation_gelu__prompt'

def setup_inputs():

    _w = (lambda a: (lambda t: t.to(torch.bfloat16) if t.is_floating_point() else t)(torch.as_tensor(a)))
    def _A_setup():
        B, S, D = 1, 2048, 640
        Df = D // 2 + 1
        return {
            "x": _w((lambda *s: torch.randn(*s, dtype=torch.bfloat16) * 0.05)(B, S, D)),
            "w_r": _w((lambda *s: torch.randn(*s, dtype=torch.bfloat16) * 0.8)(S, Df) * 0.02),
            "w_i": _w((lambda *s: torch.randn(*s, dtype=torch.bfloat16) * 0.8)(S, Df) * 0.02),
        }
    _A_in = _A_setup()

    def _B_setup():
        B, S, D, F = 1, 2048, 640, 1728
        return {
            "x": _w((lambda *s: torch.randn(*s, dtype=torch.bfloat16) * 0.05)(B, S, D)),
            "w1": _w((lambda *s: torch.randn(*s, dtype=torch.bfloat16) * 0.4)(D, F) * (D ** -0.5)),
            "b1": _w((lambda *s: torch.randn(*s, dtype=torch.bfloat16) * 12.8)(F) * 0.01),
            "w2": _w((lambda *s: torch.randn(*s, dtype=torch.bfloat16) * 0.2)(F, D) * (F ** -0.5)),
            "b2": _w((lambda *s: torch.randn(*s, dtype=torch.bfloat16) * 1.6)(D) * 0.01),
        }
    _B_in = _B_setup()

    return {
        "A_x": _A_in["x"],
        "A_w_r": _A_in["w_r"],
        "A_w_i": _A_in["w_i"],
        "B_x": _B_in["x"],
        "B_w1": _B_in["w1"],
        "B_b1": _B_in["b1"],
        "B_w2": _B_in["w2"],
        "B_b2": _B_in["b2"],
    }

def reference(A_x, A_w_r, A_w_i, B_x, B_w1, B_b1, B_w2, B_b2):
    def _A_ref(x, w_r, w_i):
        B, S, D = x.shape
        X = (lambda x, axes=(-2,-1): torch.fft.rfft2(x.float(), dim=axes))(x, axes=(-2, -1))
        W = w_r + 1j * w_i
        X = X * W
        y = (lambda x, s, axes=(-2,-1): torch.fft.irfft2(x, s=s, dim=axes).to(torch.bfloat16))(X, (S, D), axes=(-2, -1))
        return y

    def _B_ref(x, w1, b1, w2, b2):
        h = torch.einsum("bsd,df->bsf", x, w1) + b1
        h = _gelu(h)
        return torch.einsum("bsf,fd->bsd", h, w2) + b2

    x = A_x
    xn = _layernorm(x, axis=-1)
    return x + _A_ref(xn, A_w_r, A_w_i) + _B_ref(xn, B_w1, B_b1, B_w2, B_b2)
```

```asm
; @launch grid=(256,1,1) block=(512,1,1) lds=163840
.amdgcn_target "amdgcn-amd-amdhsa--gfx950"
.text
.globl parallel_sum__spectral_gfnet__dense_activation_gelu__prompt_kernel
.p2align 8
.type parallel_sum__spectral_gfnet__dense_activation_gelu__prompt_kernel,@function
parallel_sum__spectral_gfnet__dense_activation_gelu__prompt_kernel:
    s_cmp_lt_u32 s2, 256
    s_cbranch_scc1 S_go
    s_endpgm
S_go:
    s_load_dwordx16 s[4:19], s[0:1], 0
    s_load_dwordx2 s[20:21], s[0:1], 64
    s_load_dwordx2 s[22:23], s[0:1], 80
    s_getpc_b64 s[32:33]
S_pc:
    s_sub_u32 s32, s32, S_pc-parallel_sum__spectral_gfnet__dense_activation_gelu__prompt_kernel
    s_subb_u32 s33, s33, 0
    s_mov_b32 s34, code_end-parallel_sum__spectral_gfnet__dense_activation_gelu__prompt_kernel
    s_mov_b32 s35, 0x20000
    s_lshr_b32 s47, s2, 3
    s_lshl_b32 s47, s47, 7
    v_lshl_add_u32 v3, v0, 12, s47
    buffer_load_dword v7, v3, s[32:35], 0 offen
    v_lshrrev_b32 v3, 6, v0
    v_and_b32 v1, 63, v0
    v_readfirstlane_b32 s40, v3
    v_lshlrev_b32 v2, 4, v1
    s_and_b32 s42, s2, 1
    s_bfe_u32 s47, s2, 0x20001
    s_bfe_u32 s48, s2, 0x20003
    s_lshl_b32 s43, s47, 2
    s_add_u32 s43, s43, s48
    s_lshr_b32 s44, s2, 5
    s_add_u32 s46, s44, s48
    s_and_b32 s46, s46, 1
    s_mul_i32 s46, s46, 20
    s_mul_i32 s50, s47, 5
    s_add_u32 s46, s46, s50
    s_mul_i32 s50, s42, 10
    s_add_u32 s46, s46, s50
    s_lshr_b32 s46, s46, 2
    s_mul_i32 s50, s46, 26
    s_lshr_b32 s50, s50, 8
    s_mul_i32 s50, s50, 10
    s_sub_u32 s46, s46, s50
    s_and_b32 s41, s40, 3
    s_mul_i32 s47, s42, 3
    s_add_u32 s47, s47, 4
    s_cmp_eq_u32 s44, s47
    s_cbranch_scc1 S_colsum
    s_cmp_lt_u32 s40, 4
    s_cbranch_scc1 S_comp1
    s_setprio 1
    v_lshrrev_b32 v3, 3, v1
    v_mul_u32_u24 v12, 3456, v3
    v_mul_u32_u24 v3, 81920, v3
    v_lshrrev_b32 v4, 4, v1
    v_and_b32 v5, 7, v1
    v_xor_b32 v8, v4, v5
    v_lshl_add_u32 v8, v8, 4, v3
    v_xor_b32 v3, 64, v8
    v_add_u32 v9, 654336, v3
    v_add_u32 v10, 1308672, v8
    v_add_u32 v11, 1963008, v3
    v_and_b32 v4, 1, v4
    v_lshlrev_b32 v4, 1, v4
    v_xor_b32 v4, v4, v5
    v_lshl_add_u32 v12, v4, 4, v12
    v_xor_b32 v13, 64, v12
    v_add_u32 v13, 26624, v13
    s_lshl_b32 s47, s43, 2
    s_add_u32 s47, s47, s41
    s_mul_i32 s54, s47, 1280
    s_lshl_b32 s47, s46, 7
    s_add_u32 s54, s54, s47
    s_lshl_b32 s47, s42, 2
    s_add_u32 s47, s47, s44
    s_mul_i32 s55, s47, 384
    s_lshl_b32 s47, s46, 2
    s_add_u32 s47, s47, s41
    s_mul_i32 s47, s47, 55296
    s_add_u32 s55, s55, s47
    s_lshl_b32 s56, s41, 12
    s_lshl_b32 s57, s41, 11
    s_waitcnt lgkmcnt(0)
    s_mov_b32 s24, s4
    s_mov_b32 s25, s5
    s_mov_b32 s26, 2621440
    s_mov_b32 s27, 0x20000
    s_mov_b32 s28, s12
    s_mov_b32 s29, s13
    s_mov_b32 s30, 2211840
    s_mov_b32 s31, 0x20000
    s_cmp_ge_u32 s44, 5
    s_cbranch_scc1 S_t1load
    s_add_u32 m0, s56, 0
    s_add_u32 s46, s46, 1
    buffer_load_dwordx4 v8, s[24:27], s54 offen offset:0 lds
    buffer_load_dwordx4 v9, s[24:27], s54 offen offset:1024 lds
    buffer_load_dwordx4 v10, s[24:27], s54 offen offset:2048 lds
    buffer_load_dwordx4 v11, s[24:27], s54 offen offset:3072 lds
    s_add_u32 m0, s57, 16384
    s_nop 0
    buffer_load_dwordx4 v12, s[28:31], s55 offen offset:0 lds
    buffer_load_dwordx4 v13, s[28:31], s55 offen offset:1024 lds
    s_add_u32 m0, s57, 24448
    s_nop 0
    buffer_load_dwordx4 v12, s[28:31], s55 offen offset:128 lds
    buffer_load_dwordx4 v13, s[28:31], s55 offen offset:1152 lds
    s_add_u32 m0, s57, 32512
    s_nop 0
    buffer_load_dwordx4 v12, s[28:31], s55 offen offset:256 lds
    buffer_load_dwordx4 v13, s[28:31], s55 offen offset:1280 lds
    s_cmp_eq_u32 s46, 10
    s_cselect_b32 s47, -9, 1
    s_lshl_b32 s48, s47, 7
    s_add_u32 s54, s54, s48
    s_mul_i32 s47, s47, 221184
    s_add_u32 s55, s55, s47
    s_add_u32 s36, s22, 20578304
    s_addc_u32 s37, s23, 0
    s_mov_b32 s38, 289920
    s_mov_b32 s39, 0x20000
    s_load_dword s45, s[36:37], 289792
    s_call_b64 s[58:59], S_tab0
    s_call_b64 s[58:59], S_tab1
    s_add_u32 m0, s56, 40960
    s_add_u32 s46, s46, 1
    buffer_load_dwordx4 v8, s[24:27], s54 offen offset:0 lds
    buffer_load_dwordx4 v9, s[24:27], s54 offen offset:1024 lds
    buffer_load_dwordx4 v10, s[24:27], s54 offen offset:2048 lds
    buffer_load_dwordx4 v11, s[24:27], s54 offen offset:3072 lds
    s_add_u32 m0, s57, 57344
    s_nop 0
    buffer_load_dwordx4 v12, s[28:31], s55 offen offset:0 lds
    buffer_load_dwordx4 v13, s[28:31], s55 offen offset:1024 lds
    s_add_u32 m0, s57, 65408
    s_nop 0
    buffer_load_dwordx4 v12, s[28:31], s55 offen offset:128 lds
    buffer_load_dwordx4 v13, s[28:31], s55 offen offset:1152 lds
    s_add_u32 m0, s57, 73472
    s_nop 0
    buffer_load_dwordx4 v12, s[28:31], s55 offen offset:256 lds
    buffer_load_dwordx4 v13, s[28:31], s55 offen offset:1280 lds
    s_cmp_eq_u32 s46, 10
    s_cselect_b32 s47, -9, 1
    s_lshl_b32 s48, s47, 7
    s_add_u32 s54, s54, s48
    s_mul_i32 s47, s47, 221184
    s_add_u32 s55, s55, s47
    s_call_b64 s[58:59], S_tab2
    s_call_b64 s[58:59], S_tab3
    s_waitcnt vmcnt(10)
    s_barrier
    s_add_u32 m0, s56, 81920
    s_add_u32 s46, s46, 1
    buffer_load_dwordx4 v8, s[24:27], s54 offen offset:0 lds
    buffer_load_dwordx4 v9, s[24:27], s54 offen offset:1024 lds
    buffer_load_dwordx4 v10, s[24:27], s54 offen offset:2048 lds
    buffer_load_dwordx4 v11, s[24:27], s54 offen offset:3072 lds
    s_add_u32 m0, s57, 98304
    s_nop 0
    buffer_load_dwordx4 v12, s[28:31], s55 offen offset:0 lds
    buffer_load_dwordx4 v13, s[28:31], s55 offen offset:1024 lds
    s_add_u32 m0, s57, 106368
    s_nop 0
    buffer_load_dwordx4 v12, s[28:31], s55 offen offset:128 lds
    buffer_load_dwordx4 v13, s[28:31], s55 offen offset:1152 lds
    s_add_u32 m0, s57, 114432
    s_nop 0
    buffer_load_dwordx4 v12, s[28:31], s55 offen offset:256 lds
    buffer_load_dwordx4 v13, s[28:31], s55 offen offset:1280 lds
    s_cmp_eq_u32 s46, 10
    s_cselect_b32 s47, -9, 1
    s_lshl_b32 s48, s47, 7
    s_add_u32 s54, s54, s48
    s_mul_i32 s47, s47, 221184
    s_add_u32 s55, s55, s47
    s_waitcnt vmcnt(10) lgkmcnt(0)
    s_barrier
    s_add_u32 s45, s45, 2654435769
    v_mov_b32 v6, s45
    s_lshl_b32 s47, s2, 7
    s_cmp_lg_u32 s40, 4
    s_cselect_b32 s47, 2130706432, s47
    v_mov_b32 v3, s47
    s_mov_b64 exec, 1
    buffer_store_dword v6, v3, s[36:39], 0 offen sc1
    s_mov_b64 exec, -1
    s_add_u32 m0, s56, 0
    s_add_u32 s46, s46, 1
    buffer_load_dwordx4 v8, s[24:27], s54 offen offset:0 lds
    buffer_load_dwordx4 v9, s[24:27], s54 offen offset:1024 lds
    buffer_load_dwordx4 v10, s[24:27], s54 offen offset:2048 lds
    buffer_load_dwordx4 v11, s[24:27], s54 offen offset:3072 lds
    s_add_u32 m0, s57, 16384
    s_nop 0
    buffer_load_dwordx4 v12, s[28:31], s55 offen offset:0 lds
    buffer_load_dwordx4 v13, s[28:31], s55 offen offset:1024 lds
    s_add_u32 m0, s57, 24448
    s_nop 0
    buffer_load_dwordx4 v12, s[28:31], s55 offen offset:128 lds
    buffer_load_dwordx4 v13, s[28:31], s55 offen offset:1152 lds
    s_add_u32 m0, s57, 32512
    s_nop 0
    buffer_load_dwordx4 v12, s[28:31], s55 offen offset:256 lds
    buffer_load_dwordx4 v13, s[28:31], s55 offen offset:1280 lds
    s_cmp_eq_u32 s46, 10
    s_cselect_b32 s47, -9, 1
    s_lshl_b32 s48, s47, 7
    s_add_u32 s54, s54, s48
    s_mul_i32 s47, s47, 221184
    s_add_u32 s55, s55, s47
    s_waitcnt vmcnt(11) lgkmcnt(0)
    s_barrier
    s_add_u32 m0, s56, 40960
    s_add_u32 s46, s46, 1
    buffer_load_dwordx4 v8, s[24:27], s54 offen offset:0 lds
    buffer_load_dwordx4 v9, s[24:27], s54 offen offset:1024 lds
    buffer_load_dwordx4 v10, s[24:27], s54 offen offset:2048 lds
    buffer_load_dwordx4 v11, s[24:27], s54 offen offset:3072 lds
    s_add_u32 m0, s57, 57344
    s_nop 0
    buffer_load_dwordx4 v12, s[28:31], s55 offen offset:0 lds
    buffer_load_dwordx4 v13, s[28:31], s55 offen offset:1024 lds
    s_add_u32 m0, s57, 65408
    s_nop 0
    buffer_load_dwordx4 v12, s[28:31], s55 offen offset:128 lds
    buffer_load_dwordx4 v13, s[28:31], s55 offen offset:1152 lds
    s_add_u32 m0, s57, 73472
    s_nop 0
    buffer_load_dwordx4 v12, s[28:31], s55 offen offset:256 lds
    buffer_load_dwordx4 v13, s[28:31], s55 offen offset:1280 lds
    s_cmp_eq_u32 s46, 10
    s_cselect_b32 s47, -9, 1
    s_lshl_b32 s48, s47, 7
    s_add_u32 s54, s54, s48
    s_mul_i32 s47, s47, 221184
    s_add_u32 s55, s55, s47
    s_waitcnt vmcnt(10) lgkmcnt(0)
    s_barrier
    s_add_u32 m0, s56, 81920
    s_add_u32 s46, s46, 1
    buffer_load_dwordx4 v8, s[24:27], s54 offen offset:0 lds
    buffer_load_dwordx4 v9, s[24:27], s54 offen offset:1024 lds
    buffer_load_dwordx4 v10, s[24:27], s54 offen offset:2048 lds
    buffer_load_dwordx4 v11, s[24:27], s54 offen offset:3072 lds
    s_add_u32 m0, s57, 98304
    s_nop 0
    buffer_load_dwordx4 v12, s[28:31], s55 offen offset:0 lds
    buffer_load_dwordx4 v13, s[28:31], s55 offen offset:1024 lds
    s_add_u32 m0, s57, 106368
    s_nop 0
    buffer_load_dwordx4 v12, s[28:31], s55 offen offset:128 lds
    buffer_load_dwordx4 v13, s[28:31], s55 offen offset:1152 lds
    s_add_u32 m0, s57, 114432
    s_nop 0
    buffer_load_dwordx4 v12, s[28:31], s55 offen offset:256 lds
    buffer_load_dwordx4 v13, s[28:31], s55 offen offset:1280 lds
    s_cmp_eq_u32 s46, 10
    s_cselect_b32 s47, -9, 1
    s_lshl_b32 s48, s47, 7
    s_add_u32 s54, s54, s48
    s_mul_i32 s47, s47, 221184
    s_add_u32 s55, s55, s47
    s_waitcnt vmcnt(10) lgkmcnt(0)
    s_barrier
    s_add_u32 m0, s56, 0
    s_add_u32 s46, s46, 1
    buffer_load_dwordx4 v8, s[24:27], s54 offen offset:0 lds
    buffer_load_dwordx4 v9, s[24:27], s54 offen offset:1024 lds
    buffer_load_dwordx4 v10, s[24:27], s54 offen offset:2048 lds
    buffer_load_dwordx4 v11, s[24:27], s54 offen offset:3072 lds
    s_add_u32 m0, s57, 16384
    s_nop 0
    buffer_load_dwordx4 v12, s[28:31], s55 offen offset:0 lds
    buffer_load_dwordx4 v13, s[28:31], s55 offen offset:1024 lds
    s_add_u32 m0, s57, 24448
    s_nop 0
    buffer_load_dwordx4 v12, s[28:31], s55 offen offset:128 lds
    buffer_load_dwordx4 v13, s[28:31], s55 offen offset:1152 lds
    s_add_u32 m0, s57, 32512
    s_nop 0
    buffer_load_dwordx4 v12, s[28:31], s55 offen offset:256 lds
    buffer_load_dwordx4 v13, s[28:31], s55 offen offset:1280 lds
    s_cmp_eq_u32 s46, 10
    s_cselect_b32 s47, -9, 1
    s_lshl_b32 s48, s47, 7
    s_add_u32 s54, s54, s48
    s_mul_i32 s47, s47, 221184
    s_add_u32 s55, s55, s47
    s_waitcnt vmcnt(10) lgkmcnt(0)
    s_barrier
    s_add_u32 m0, s56, 40960
    s_add_u32 s46, s46, 1
    buffer_load_dwordx4 v8, s[24:27], s54 offen offset:0 lds
    buffer_load_dwordx4 v9, s[24:27], s54 offen offset:1024 lds
    buffer_load_dwordx4 v10, s[24:27], s54 offen offset:2048 lds
    buffer_load_dwordx4 v11, s[24:27], s54 offen offset:3072 lds
    s_add_u32 m0, s57, 57344
    s_nop 0
    buffer_load_dwordx4 v12, s[28:31], s55 offen offset:0 lds
    buffer_load_dwordx4 v13, s[28:31], s55 offen offset:1024 lds
    s_add_u32 m0, s57, 65408
    s_nop 0
    buffer_load_dwordx4 v12, s[28:31], s55 offen offset:128 lds
    buffer_load_dwordx4 v13, s[28:31], s55 offen offset:1152 lds
    s_add_u32 m0, s57, 73472
    s_nop 0
    buffer_load_dwordx4 v12, s[28:31], s55 offen offset:256 lds
    buffer_load_dwordx4 v13, s[28:31], s55 offen offset:1280 lds
    s_cmp_eq_u32 s46, 10
    s_cselect_b32 s47, -9, 1
    s_lshl_b32 s48, s47, 7
    s_add_u32 s54, s54, s48
    s_mul_i32 s47, s47, 221184
    s_add_u32 s55, s55, s47
    s_waitcnt vmcnt(10) lgkmcnt(0)
    s_barrier
    s_add_u32 m0, s56, 81920
    s_add_u32 s46, s46, 1
    buffer_load_dwordx4 v8, s[24:27], s54 offen offset:0 lds
    buffer_load_dwordx4 v9, s[24:27], s54 offen offset:1024 lds
    buffer_load_dwordx4 v10, s[24:27], s54 offen offset:2048 lds
    buffer_load_dwordx4 v11, s[24:27], s54 offen offset:3072 lds
    s_add_u32 m0, s57, 98304
    s_nop 0
    buffer_load_dwordx4 v12, s[28:31], s55 offen offset:0 lds
    buffer_load_dwordx4 v13, s[28:31], s55 offen offset:1024 lds
    s_add_u32 m0, s57, 106368
    s_nop 0
    buffer_load_dwordx4 v12, s[28:31], s55 offen offset:128 lds
    buffer_load_dwordx4 v13, s[28:31], s55 offen offset:1152 lds
    s_add_u32 m0, s57, 114432
    s_nop 0
    buffer_load_dwordx4 v12, s[28:31], s55 offen offset:256 lds
    buffer_load_dwordx4 v13, s[28:31], s55 offen offset:1280 lds
    s_cmp_eq_u32 s46, 10
    s_cselect_b32 s47, -9, 1
    s_lshl_b32 s48, s47, 7
    s_add_u32 s54, s54, s48
    s_mul_i32 s47, s47, 221184
    s_add_u32 s55, s55, s47
    s_waitcnt vmcnt(10) lgkmcnt(0)
    s_barrier
    s_add_u32 m0, s56, 0
    s_add_u32 s46, s46, 1
    buffer_load_dwordx4 v8, s[24:27], s54 offen offset:0 lds
    buffer_load_dwordx4 v9, s[24:27], s54 offen offset:1024 lds
    buffer_load_dwordx4 v10, s[24:27], s54 offen offset:2048 lds
    buffer_load_dwordx4 v11, s[24:27], s54 offen offset:3072 lds
    s_add_u32 m0, s57, 16384
    s_nop 0
    buffer_load_dwordx4 v12, s[28:31], s55 offen offset:0 lds
    buffer_load_dwordx4 v13, s[28:31], s55 offen offset:1024 lds
    s_add_u32 m0, s57, 24448
    s_nop 0
    buffer_load_dwordx4 v12, s[28:31], s55 offen offset:128 lds
    buffer_load_dwordx4 v13, s[28:31], s55 offen offset:1152 lds
    s_add_u32 m0, s57, 32512
    s_nop 0
    buffer_load_dwordx4 v12, s[28:31], s55 offen offset:256 lds
    buffer_load_dwordx4 v13, s[28:31], s55 offen offset:1280 lds
    s_cmp_eq_u32 s46, 10
    s_cselect_b32 s47, -9, 1
    s_lshl_b32 s48, s47, 7
    s_add_u32 s54, s54, s48
    s_mul_i32 s47, s47, 221184
    s_add_u32 s55, s55, s47
    s_add_u32 s65, s44, 1
    s_sub_u32 s65, s65, s42
    s_min_u32 s65, s65, 1
    s_add_u32 s65, s65, 1
S_load2:
    s_lshl_b32 s66, s44, 1
    s_sub_u32 s66, s66, s42
    s_cmp_eq_u32 s65, 2
    s_cselect_b32 s66, s66, 0
    s_mov_b32 s24, s16
    s_mov_b32 s25, s17
    s_mov_b32 s26, 2211840
    s_mov_b32 s27, 0x20000
    s_add_u32 s28, s22, 0
    s_addc_u32 s29, s23, 0
    s_mov_b32 s30, 7077888
    s_mov_b32 s31, 0x20000
    s_mul_i32 s60, s42, 1105920
    v_lshrrev_b32 v3, 3, v1
    v_mul_u32_u24 v3, 1280, v3
    v_lshlrev_b32 v4, 1, v19
    v_and_b32 v5, 7, v1
    v_xor_b32 v4, v4, v5
    v_lshl_add_u32 v14, v4, 4, v3
    s_lshr_b32 s47, s41, 1
    s_mul_i32 s47, s47, 640
    s_add_u32 s60, s60, s47
    s_and_b32 s47, s41, 1
    s_lshl_b32 s62, s47, 11
    s_mul_i32 s47, s47, 20480
    s_add_u32 s60, s60, s47
    s_lshl_b32 s47, s44, 7
    s_add_u32 s60, s60, s47
    s_lshr_b32 s47, s41, 1
    s_mul_i32 s47, s47, 12288
    s_add_u32 s62, s62, s47
    s_mul_i32 s63, s41, 6144
    s_add_u32 s63, s63, 24576
    s_xor_b32 s47, s67, s41
    s_mul_i32 s61, s47, 110592
    s_mul_i32 s47, s42, 55296
    s_add_u32 s61, s61, s47
    s_mul_i32 s47, s43, 36
    s_mul_i32 s48, s42, 18
    s_add_u32 s47, s47, s48
    s_add_u32 s47, s47, 256
    v_min_u32 v3, 17, v1
    v_add_lshl_u32 v15, v3, s47, 7
    s_mul_i32 s47, s65, 3
    s_sub_u32 s48, 9, s65
    v_subrev_u32 v3, s47, v1
    v_cmp_le_u32 vcc, s48, v3
    v_subrev_u32 v4, s48, v3
    v_mov_b32 v208, 0
    v_cndmask_b32 v3, v3, v4, vcc
    v_addc_co_u32 v208, vcc, 0, v208, vcc
    v_cmp_le_u32 vcc, s48, v3
    v_subrev_u32 v4, s48, v3
    s_nop 0
    v_cndmask_b32 v3, v3, v4, vcc
    v_addc_co_u32 v208, vcc, 0, v208, vcc
    v_cmp_le_u32 vcc, s66, v3
    v_add_u32 v4, s65, v3
    s_mul_i32 s48, s66, 3
    v_cndmask_b32 v3, v3, v4, vcc
    v_mad_u32_u24 v208, v3, 3, v208
    v_cmp_gt_u32 vcc, s47, v1
    v_add_u32 v4, s48, v1
    s_nop 0
    v_cndmask_b32 v208, v208, v4, vcc
    s_mov_b32 s32, s4
    s_mov_b32 s33, s5
    s_mov_b32 s34, 2621440
    s_mov_b32 s35, 0x20000
    s_and_b32 s48, s41, 1
    s_add_u32 s47, s67, s48
    s_mul_i32 s47, s47, 1280
    s_lshr_b32 s48, s41, 1
    s_mul_i32 s48, s48, 640
    s_add_u32 s47, s47, s48
    s_lshl_b32 s48, s44, 7
    s_add_u32 s47, s47, s48
    v_lshrrev_b32 v3, 3, v1
    v_xor_b32 v4, v3, v5
    v_mul_u32_u24 v3, 81920, v3
    v_lshl_add_u32 v3, v4, 4, v3
    s_lshl_b32 s48, s41, 12
    s_add_u32 m0, s48, 147456
    s_add_u32 s48, s47, 0
    buffer_load_dwordx4 v3, s[32:35], s48 offen offset:0 lds
    s_add_u32 s48, s47, 654336
    buffer_load_dwordx4 v3, s[32:35], s48 offen offset:1024 lds
    s_add_u32 s48, s47, 1308672
    buffer_load_dwordx4 v3, s[32:35], s48 offen offset:2048 lds
    s_add_u32 s48, s47, 1963008
    buffer_load_dwordx4 v3, s[32:35], s48 offen offset:3072 lds
    s_cmp_eq_u32 s65, 0
    s_cbranch_scc1 S_b8
    s_waitcnt vmcnt(14)
    s_barrier
S_b8:
    s_cmp_eq_u32 s65, 0
    s_cbranch_scc1 S_b9
    s_waitcnt vmcnt(4)
    s_barrier
S_b9:
    v_readlane_b32 s47, v208, 3
    s_add_u32 m0, s62, 49152
    s_mul_i32 s64, s47, 40960
    s_add_u32 s64, s64, s60
    s_add_u32 s48, s64, 9216
    buffer_load_dwordx4 v14, s[24:27], s64 offen lds
    buffer_load_dwordx4 v14, s[24:27], s48 offen offset:1024 lds
    v_readlane_b32 s47, v208, 4
    s_add_u32 m0, s62, 53248
    s_mul_i32 s64, s47, 40960
    s_add_u32 s64, s64, s60
    s_add_u32 s48, s64, 9216
    buffer_load_dwordx4 v14, s[24:27], s64 offen lds
    buffer_load_dwordx4 v14, s[24:27], s48 offen offset:1024 lds
    v_readlane_b32 s47, v208, 5
    s_add_u32 m0, s62, 57344
    s_mul_i32 s64, s47, 40960
    s_add_u32 s64, s64, s60
    s_add_u32 s48, s64, 9216
    buffer_load_dwordx4 v14, s[24:27], s64 offen lds
    buffer_load_dwordx4 v14, s[24:27], s48 offen offset:1024 lds
    s_cmp_eq_u32 s65, 0
    s_cbranch_scc1 S_bs
    s_nop 0
    s_barrier
S_bs:
    v_readlane_b32 s47, v208, 0
    s_add_u32 m0, s62, 0
    s_mul_i32 s64, s47, 40960
    s_add_u32 s64, s64, s60
    s_add_u32 s48, s64, 9216
    buffer_load_dwordx4 v14, s[24:27], s64 offen lds
    buffer_load_dwordx4 v14, s[24:27], s48 offen offset:1024 lds
    v_readlane_b32 s47, v208, 1
    s_add_u32 m0, s62, 4096
    s_mul_i32 s64, s47, 40960
    s_add_u32 s64, s64, s60
    s_add_u32 s48, s64, 9216
    buffer_load_dwordx4 v14, s[24:27], s64 offen lds
    buffer_load_dwordx4 v14, s[24:27], s48 offen offset:1024 lds
    v_readlane_b32 s47, v208, 2
    s_add_u32 m0, s62, 8192
    s_mul_i32 s64, s47, 40960
    s_add_u32 s64, s64, s60
    s_add_u32 s48, s64, 9216
    buffer_load_dwordx4 v14, s[24:27], s64 offen lds
    buffer_load_dwordx4 v14, s[24:27], s48 offen offset:1024 lds
    v_readlane_b32 s47, v208, 6
    s_add_u32 m0, s62, 98304
    s_mul_i32 s64, s47, 40960
    s_add_u32 s64, s64, s60
    s_add_u32 s48, s64, 9216
    buffer_load_dwordx4 v14, s[24:27], s64 offen lds
    buffer_load_dwordx4 v14, s[24:27], s48 offen offset:1024 lds
    s_waitcnt vmcnt(1)
    v_readlane_b32 s47, v208, 7
    s_add_u32 m0, s62, 102400
    s_mul_i32 s64, s47, 40960
    s_add_u32 s64, s64, s60
    s_add_u32 s48, s64, 9216
    buffer_load_dwordx4 v14, s[24:27], s64 offen lds
    buffer_load_dwordx4 v14, s[24:27], s48 offen offset:1024 lds
    s_waitcnt vmcnt(1)
    v_readlane_b32 s47, v208, 8
    s_add_u32 m0, s62, 106496
    s_mul_i32 s64, s47, 40960
    s_add_u32 s64, s64, s60
    s_add_u32 s48, s64, 9216
    buffer_load_dwordx4 v14, s[24:27], s64 offen lds
    buffer_load_dwordx4 v14, s[24:27], s48 offen offset:1024 lds
    s_waitcnt vmcnt(1)
    s_add_u32 s32, s22, 9961472
    s_addc_u32 s33, s23, 0
    s_mov_b32 s34, 2883584
    s_mov_b32 s35, 0x20000
    s_cmp_eq_u32 s65, 0
    s_cbranch_scc1 S_b0a
    s_waitcnt vmcnt(0)
    s_barrier
S_b0a:
    s_mov_b32 s50, 0
S_h0:
    buffer_load_dword v16, v15, s[36:39], 0 offen sc1
    s_add_u32 s50, s50, 1
    s_waitcnt vmcnt(0)
    v_subrev_u32 v16, v6, v16
    v_subrev_u32 v16, 0, v16
    v_cmp_lt_u32 vcc, 2, v16
    s_cmp_ge_u32 s50, 131072
    s_cbranch_scc1 S_h0_e
    s_cbranch_vccz S_h0_e
    s_mov_b64 exec, vcc
    s_sleep 2
    s_branch S_h0
S_h0_e:
    s_mov_b64 exec, -1
S_h0_ok:
    s_cmp_gt_u32 s65, 0
    s_cbranch_scc1 S_own0
    v_readlane_b32 s47, v208, 0
    s_add_u32 m0, s63, 0
    s_lshl_b32 s64, s47, 11
    s_add_u32 s64, s64, s61
    buffer_load_dwordx4 v2, s[28:31], s64 offen sc1 lds
    buffer_load_dwordx4 v2, s[28:31], s64 offen offset:1024 sc1 lds
    v_readlane_b32 s47, v208, 1
    s_add_u32 m0, s63, 2048
    s_lshl_b32 s64, s47, 11
    s_add_u32 s64, s64, s61
    buffer_load_dwordx4 v2, s[28:31], s64 offen sc1 lds
    buffer_load_dwordx4 v2, s[28:31], s64 offen offset:1024 sc1 lds
    v_readlane_b32 s47, v208, 2
    s_add_u32 m0, s63, 4096
    s_lshl_b32 s64, s47, 11
    s_add_u32 s64, s64, s61
    buffer_load_dwordx4 v2, s[28:31], s64 offen sc1 lds
    buffer_load_dwordx4 v2, s[28:31], s64 offen offset:1024 sc1 lds
S_own0:
    s_cmp_gt_u32 s65, 1
    s_cbranch_scc1 S_own1
    v_readlane_b32 s47, v208, 3
    s_add_u32 m0, s63, 49152
    s_lshl_b32 s64, s47, 11
    s_add_u32 s64, s64, s61
    buffer_load_dwordx4 v2, s[28:31], s64 offen sc1 lds
    buffer_load_dwordx4 v2, s[28:31], s64 offen offset:1024 sc1 lds
    v_readlane_b32 s47, v208, 4
    s_add_u32 m0, s63, 51200
    s_lshl_b32 s64, s47, 11
    s_add_u32 s64, s64, s61
    buffer_load_dwordx4 v2, s[28:31], s64 offen sc1 lds
    buffer_load_dwordx4 v2, s[28:31], s64 offen offset:1024 sc1 lds
    v_readlane_b32 s47, v208, 5
    s_add_u32 m0, s63, 53248
    s_lshl_b32 s64, s47, 11
    s_add_u32 s64, s64, s61
    buffer_load_dwordx4 v2, s[28:31], s64 offen sc1 lds
    buffer_load_dwordx4 v2, s[28:31], s64 offen offset:1024 sc1 lds
S_own1:
    v_readlane_b32 s47, v208, 6
    s_add_u32 m0, s63, 98304
    s_lshl_b32 s64, s47, 11
    s_add_u32 s64, s64, s61
    buffer_load_dwordx4 v2, s[28:31], s64 offen sc1 lds
    buffer_load_dwordx4 v2, s[28:31], s64 offen offset:1024 sc1 lds
    v_readlane_b32 s47, v208, 7
    s_add_u32 m0, s63, 100352
    s_lshl_b32 s64, s47, 11
    s_add_u32 s64, s64, s61
    buffer_load_dwordx4 v2, s[28:31], s64 offen sc1 lds
    buffer_load_dwordx4 v2, s[28:31], s64 offen offset:1024 sc1 lds
    v_readlane_b32 s47, v208, 8
    s_add_u32 m0, s63, 102400
    s_lshl_b32 s64, s47, 11
    s_add_u32 s64, s64, s61
    buffer_load_dwordx4 v2, s[28:31], s64 offen sc1 lds
    buffer_load_dwordx4 v2, s[28:31], s64 offen offset:1024 sc1 lds
    s_cmp_lg_u32 s65, 0
    s_cbranch_scc1 S_b0b
    s_waitcnt vmcnt(12)
    s_barrier
S_b0b:
    s_waitcnt vmcnt(6)
    s_barrier
    s_cmp_eq_u32 s65, 2
    s_cbranch_scc1 S_h1_ok
    s_mov_b32 s50, 0
S_h1:
    buffer_load_dword v16, v15, s[36:39], 0 offen sc1
    s_add_u32 s50, s50, 1
    s_waitcnt vmcnt(0)
    v_subrev_u32 v16, v6, v16
    v_subrev_u32 v16, 1, v16
    v_cmp_lt_u32 vcc, 1, v16
    s_cmp_ge_u32 s50, 131072
    s_cbranch_scc1 S_h1_e
    s_cbranch_vccz S_h1_e
    s_mov_b64 exec, vcc
    s_sleep 2
    s_branch S_h1
S_h1_e:
    s_mov_b64 exec, -1
S_h1_ok:
    v_readlane_b32 s47, v208, 9
    s_add_u32 m0, s63, 0
    s_lshl_b32 s64, s47, 11
    s_add_u32 s64, s64, s61
    buffer_load_dwordx4 v2, s[28:31], s64 offen sc1 lds
    buffer_load_dwordx4 v2, s[28:31], s64 offen offset:1024 sc1 lds
    v_readlane_b32 s47, v208, 10
    s_add_u32 m0, s63, 2048
    s_lshl_b32 s64, s47, 11
    s_add_u32 s64, s64, s61
    buffer_load_dwordx4 v2, s[28:31], s64 offen sc1 lds
    buffer_load_dwordx4 v2, s[28:31], s64 offen offset:1024 sc1 lds
    v_readlane_b32 s47, v208, 11
    s_add_u32 m0, s63, 4096
    s_lshl_b32 s64, s47, 11
    s_add_u32 s64, s64, s61
    buffer_load_dwordx4 v2, s[28:31], s64 offen sc1 lds
    buffer_load_dwordx4 v2, s[28:31], s64 offen offset:1024 sc1 lds
    buffer_load_dword v17, v15, s[36:39], 0 offen sc1
    v_readlane_b32 s47, v208, 9
    s_add_u32 m0, s62, 0
    s_mul_i32 s64, s47, 40960
    s_add_u32 s64, s64, s60
    s_add_u32 s48, s64, 9216
    buffer_load_dwordx4 v14, s[24:27], s64 offen lds
    buffer_load_dwordx4 v14, s[24:27], s48 offen offset:1024 lds
    v_readlane_b32 s47, v208, 10
    s_add_u32 m0, s62, 4096
    s_mul_i32 s64, s47, 40960
    s_add_u32 s64, s64, s60
    s_add_u32 s48, s64, 9216
    buffer_load_dwordx4 v14, s[24:27], s64 offen lds
    buffer_load_dwordx4 v14, s[24:27], s48 offen offset:1024 lds
    v_readlane_b32 s47, v208, 11
    s_add_u32 m0, s62, 8192
    s_mul_i32 s64, s47, 40960
    s_add_u32 s64, s64, s60
    s_add_u32 s48, s64, 9216
    buffer_load_dwordx4 v14, s[24:27], s64 offen lds
    buffer_load_dwordx4 v14, s[24:27], s48 offen offset:1024 lds
    s_waitcnt vmcnt(13)
    s_barrier
    v_readlane_b32 s47, v208, 12
    s_add_u32 m0, s62, 49152
    s_mul_i32 s64, s47, 40960
    s_add_u32 s64, s64, s60
    s_add_u32 s48, s64, 9216
    buffer_load_dwordx4 v14, s[24:27], s64 offen lds
    buffer_load_dwordx4 v14, s[24:27], s48 offen offset:1024 lds
    v_readlane_b32 s47, v208, 13
    s_add_u32 m0, s62, 53248
    s_mul_i32 s64, s47, 40960
    s_add_u32 s64, s64, s60
    s_add_u32 s48, s64, 9216
    buffer_load_dwordx4 v14, s[24:27], s64 offen lds
    buffer_load_dwordx4 v14, s[24:27], s48 offen offset:1024 lds
    v_readlane_b32 s47, v208, 14
    s_add_u32 m0, s62, 57344
    s_mul_i32 s64, s47, 40960
    s_add_u32 s64, s64, s60
    s_add_u32 s48, s64, 9216
    buffer_load_dwordx4 v14, s[24:27], s64 offen lds
    buffer_load_dwordx4 v14, s[24:27], s48 offen offset:1024 lds
    s_waitcnt vmcnt(12)
    v_subrev_u32 v17, v6, v17
    v_subrev_u32 v17, 1, v17
    v_cmp_lt_u32 vcc, 1, v17
    s_cbranch_vccz S_hs2_ok
    s_mov_b32 s50, 0
S_hs2:
    buffer_load_dword v16, v15, s[36:39], 0 offen sc1
    s_add_u32 s50, s50, 1
    s_waitcnt vmcnt(0)
    v_subrev_u32 v16, v6, v16
    v_subrev_u32 v16, 1, v16
    v_cmp_lt_u32 vcc, 1, v16
    s_cmp_ge_u32 s50, 131072
    s_cbranch_scc1 S_hs2_e
    s_cbranch_vccz S_hs2_e
    s_mov_b64 exec, vcc
    s_sleep 2
    s_branch S_hs2
S_hs2_e:
    s_mov_b64 exec, -1
S_hs2_ok:
    v_readlane_b32 s47, v208, 12
    s_add_u32 m0, s63, 49152
    s_lshl_b32 s64, s47, 11
    s_add_u32 s64, s64, s61
    buffer_load_dwordx4 v2, s[28:31], s64 offen sc1 lds
    buffer_load_dwordx4 v2, s[28:31], s64 offen offset:1024 sc1 lds
    v_readlane_b32 s47, v208, 13
    s_add_u32 m0, s63, 51200
    s_lshl_b32 s64, s47, 11
    s_add_u32 s64, s64, s61
    buffer_load_dwordx4 v2, s[28:31], s64 offen sc1 lds
    buffer_load_dwordx4 v2, s[28:31], s64 offen offset:1024 sc1 lds
    v_readlane_b32 s47, v208, 14
    s_add_u32 m0, s63, 53248
    s_lshl_b32 s64, s47, 11
    s_add_u32 s64, s64, s61
    buffer_load_dwordx4 v2, s[28:31], s64 offen sc1 lds
    buffer_load_dwordx4 v2, s[28:31], s64 offen offset:1024 sc1 lds
    s_waitcnt vmcnt(12)
    s_barrier
    v_readlane_b32 s47, v208, 15
    s_add_u32 m0, s63, 98304
    s_lshl_b32 s64, s47, 11
    s_add_u32 s64, s64, s61
    buffer_load_dwordx4 v2, s[28:31], s64 offen sc1 lds
    buffer_load_dwordx4 v2, s[28:31], s64 offen offset:1024 sc1 lds
    v_readlane_b32 s47, v208, 16
    s_add_u32 m0, s63, 100352
    s_lshl_b32 s64, s47, 11
    s_add_u32 s64, s64, s61
    buffer_load_dwordx4 v2, s[28:31], s64 offen sc1 lds
    buffer_load_dwordx4 v2, s[28:31], s64 offen offset:1024 sc1 lds
    v_readlane_b32 s47, v208, 17
    s_add_u32 m0, s63, 102400
    s_lshl_b32 s64, s47, 11
    s_add_u32 s64, s64, s61
    buffer_load_dwordx4 v2, s[28:31], s64 offen sc1 lds
    buffer_load_dwordx4 v2, s[28:31], s64 offen offset:1024 sc1 lds
    buffer_load_dword v17, v15, s[36:39], 0 offen sc1
    v_readlane_b32 s47, v208, 15
    s_add_u32 m0, s62, 98304
    s_mul_i32 s64, s47, 40960
    s_add_u32 s64, s64, s60
    s_add_u32 s48, s64, 9216
    buffer_load_dwordx4 v14, s[24:27], s64 offen lds
    buffer_load_dwordx4 v14, s[24:27], s48 offen offset:1024 lds
    v_readlane_b32 s47, v208, 16
    s_add_u32 m0, s62, 102400
    s_mul_i32 s64, s47, 40960
    s_add_u32 s64, s64, s60
    s_add_u32 s48, s64, 9216
    buffer_load_dwordx4 v14, s[24:27], s64 offen lds
    buffer_load_dwordx4 v14, s[24:27], s48 offen offset:1024 lds
    v_readlane_b32 s47, v208, 17
    s_add_u32 m0, s62, 106496
    s_mul_i32 s64, s47, 40960
    s_add_u32 s64, s64, s60
    s_add_u32 s48, s64, 9216
    buffer_load_dwordx4 v14, s[24:27], s64 offen lds
    buffer_load_dwordx4 v14, s[24:27], s48 offen offset:1024 lds
    s_waitcnt vmcnt(13)
    s_barrier
    v_readlane_b32 s47, v208, 18
    s_add_u32 m0, s62, 0
    s_mul_i32 s64, s47, 40960
    s_add_u32 s64, s64, s60
    s_add_u32 s48, s64, 9216
    buffer_load_dwordx4 v14, s[24:27], s64 offen lds
    buffer_load_dwordx4 v14, s[24:27], s48 offen offset:1024 lds
    v_readlane_b32 s47, v208, 19
    s_add_u32 m0, s62, 4096
    s_mul_i32 s64, s47, 40960
    s_add_u32 s64, s64, s60
    s_add_u32 s48, s64, 9216
    buffer_load_dwordx4 v14, s[24:27], s64 offen lds
    buffer_load_dwordx4 v14, s[24:27], s48 offen offset:1024 lds
    v_readlane_b32 s47, v208, 20
    s_add_u32 m0, s62, 8192
    s_mul_i32 s64, s47, 40960
    s_add_u32 s64, s64, s60
    s_add_u32 s48, s64, 9216
    buffer_load_dwordx4 v14, s[24:27], s64 offen lds
    buffer_load_dwordx4 v14, s[24:27], s48 offen offset:1024 lds
    s_waitcnt vmcnt(12)
    v_subrev_u32 v17, v6, v17
    v_subrev_u32 v17, 2, v17
    v_cmp_lt_u32 vcc, 0, v17
    s_cbranch_vccz S_hs4_ok
    s_mov_b32 s50, 0
S_hs4:
    buffer_load_dword v16, v15, s[36:39], 0 offen sc1
    s_add_u32 s50, s50, 1
    s_waitcnt vmcnt(0)
    v_subrev_u32 v16, v6, v16
    v_subrev_u32 v16, 2, v16
    v_cmp_lt_u32 vcc, 0, v16
    s_cmp_ge_u32 s50, 131072
    s_cbranch_scc1 S_hs4_e
    s_cbranch_vccz S_hs4_e
    s_mov_b64 exec, vcc
    s_sleep 2
    s_branch S_hs4
S_hs4_e:
    s_mov_b64 exec, -1
S_hs4_ok:
    v_readlane_b32 s47, v208, 18
    s_add_u32 m0, s63, 0
    s_lshl_b32 s64, s47, 11
    s_add_u32 s64, s64, s61
    buffer_load_dwordx4 v2, s[28:31], s64 offen sc1 lds
    buffer_load_dwordx4 v2, s[28:31], s64 offen offset:1024 sc1 lds
    v_readlane_b32 s47, v208, 19
    s_add_u32 m0, s63, 2048
    s_lshl_b32 s64, s47, 11
    s_add_u32 s64, s64, s61
    buffer_load_dwordx4 v2, s[28:31], s64 offen sc1 lds
    buffer_load_dwordx4 v2, s[28:31], s64 offen offset:1024 sc1 lds
    v_readlane_b32 s47, v208, 20
    s_add_u32 m0, s63, 4096
    s_lshl_b32 s64, s47, 11
    s_add_u32 s64, s64, s61
    buffer_load_dwordx4 v2, s[28:31], s64 offen sc1 lds
    buffer_load_dwordx4 v2, s[28:31], s64 offen offset:1024 sc1 lds
    s_waitcnt vmcnt(12)
    s_barrier
    s_mul_i32 s47, s41, 22
    s_add_u32 s47, s47, 1152
    v_min_u32 v3, 21, v1
    v_add_lshl_u32 v15, v3, s47, 7
    v_readlane_b32 s47, v208, 21
    s_add_u32 m0, s63, 49152
    s_lshl_b32 s64, s47, 11
    s_add_u32 s64, s64, s61
    buffer_load_dwordx4 v2, s[28:31], s64 offen sc1 lds
    buffer_load_dwordx4 v2, s[28:31], s64 offen offset:1024 sc1 lds
    v_readlane_b32 s47, v208, 22
    s_add_u32 m0, s63, 51200
    s_lshl_b32 s64, s47, 11
    s_add_u32 s64, s64, s61
    buffer_load_dwordx4 v2, s[28:31], s64 offen sc1 lds
    buffer_load_dwordx4 v2, s[28:31], s64 offen offset:1024 sc1 lds
    v_readlane_b32 s47, v208, 23
    s_add_u32 m0, s63, 53248
    s_lshl_b32 s64, s47, 11
    s_add_u32 s64, s64, s61
    buffer_load_dwordx4 v2, s[28:31], s64 offen sc1 lds
    buffer_load_dwordx4 v2, s[28:31], s64 offen offset:1024 sc1 lds
    buffer_load_dword v17, v15, s[36:39], 0 offen sc1
    v_readlane_b32 s47, v208, 21
    s_add_u32 m0, s62, 49152
    s_mul_i32 s64, s47, 40960
    s_add_u32 s64, s64, s60
    s_add_u32 s48, s64, 9216
    buffer_load_dwordx4 v14, s[24:27], s64 offen lds
    buffer_load_dwordx4 v14, s[24:27], s48 offen offset:1024 lds
    v_readlane_b32 s47, v208, 22
    s_add_u32 m0, s62, 53248
    s_mul_i32 s64, s47, 40960
    s_add_u32 s64, s64, s60
    s_add_u32 s48, s64, 9216
    buffer_load_dwordx4 v14, s[24:27], s64 offen lds
    buffer_load_dwordx4 v14, s[24:27], s48 offen offset:1024 lds
    v_readlane_b32 s47, v208, 23
    s_add_u32 m0, s62, 57344
    s_mul_i32 s64, s47, 40960
    s_add_u32 s64, s64, s60
    s_add_u32 s48, s64, 9216
    buffer_load_dwordx4 v14, s[24:27], s64 offen lds
    buffer_load_dwordx4 v14, s[24:27], s48 offen offset:1024 lds
    s_waitcnt vmcnt(13)
    s_barrier
    v_readlane_b32 s47, v208, 24
    s_add_u32 m0, s63, 98304
    s_lshl_b32 s64, s47, 11
    s_add_u32 s64, s64, s61
    buffer_load_dwordx4 v2, s[28:31], s64 offen sc1 lds
    buffer_load_dwordx4 v2, s[28:31], s64 offen offset:1024 sc1 lds
    v_readlane_b32 s47, v208, 25
    s_add_u32 m0, s63, 100352
    s_lshl_b32 s64, s47, 11
    s_add_u32 s64, s64, s61
    buffer_load_dwordx4 v2, s[28:31], s64 offen sc1 lds
    buffer_load_dwordx4 v2, s[28:31], s64 offen offset:1024 sc1 lds
    v_readlane_b32 s47, v208, 26
    s_add_u32 m0, s63, 102400
    s_lshl_b32 s64, s47, 11
    s_add_u32 s64, s64, s61
    buffer_load_dwordx4 v2, s[28:31], s64 offen sc1 lds
    buffer_load_dwordx4 v2, s[28:31], s64 offen offset:1024 sc1 lds
    v_readlane_b32 s47, v208, 24
    s_add_u32 m0, s62, 98304
    s_mul_i32 s64, s47, 40960
    s_add_u32 s64, s64, s60
    s_add_u32 s48, s64, 9216
    buffer_load_dwordx4 v14, s[24:27], s64 offen lds
    buffer_load_dwordx4 v14, s[24:27], s48 offen offset:1024 lds
    v_readlane_b32 s47, v208, 25
    s_add_u32 m0, s62, 102400
    s_mul_i32 s64, s47, 40960
    s_add_u32 s64, s64, s60
    s_add_u32 s48, s64, 9216
    buffer_load_dwordx4 v14, s[24:27], s64 offen lds
    buffer_load_dwordx4 v14, s[24:27], s48 offen offset:1024 lds
    v_readlane_b32 s47, v208, 26
    s_add_u32 m0, s62, 106496
    s_mul_i32 s64, s47, 40960
    s_add_u32 s64, s64, s60
    s_add_u32 s48, s64, 9216
    buffer_load_dwordx4 v14, s[24:27], s64 offen lds
    buffer_load_dwordx4 v14, s[24:27], s48 offen offset:1024 lds
    s_waitcnt vmcnt(12)
    v_cmp_ne_u32 vcc, s45, v17
    s_cbranch_vccz S_pp_ok
    s_mov_b32 s50, 0
S_pp:
    buffer_load_dword v16, v15, s[36:39], 0 offen sc1
    s_add_u32 s50, s50, 1
    s_waitcnt vmcnt(0)
    v_xor_b32 v16, v16, v6
    v_cmp_ne_u32 vcc, 0, v16
    s_cmp_ge_u32 s50, 131072
    s_cbranch_scc1 S_pp_e
    s_cbranch_vccz S_pp_e
    s_mov_b64 exec, vcc
    s_sleep 2
    s_branch S_pp
S_pp_e:
    s_mov_b64 exec, -1
S_pp_ok:
    s_barrier
    s_add_u32 s48, s67, 0
    s_mul_i32 s48, s48, 45056
    s_add_u32 s47, s48, s68
    s_cmp_lg_u32 s41, 2
    s_cbranch_scc1 S_nox0
    s_mov_b32 m0, 20480
    s_add_u32 s48, s48, 20480
    buffer_load_dwordx4 v2, s[32:35], s48 offen offset:0 sc1 lds
    buffer_load_dwordx4 v2, s[32:35], s48 offen offset:1024 sc1 lds
S_nox0:
    s_add_u32 m0, s68, 0
    s_nop 0
    buffer_load_dwordx4 v2, s[32:35], s47 offen offset:0 sc1 lds
    buffer_load_dwordx4 v2, s[32:35], s47 offen offset:1024 sc1 lds
    buffer_load_dwordx4 v2, s[32:35], s47 offen offset:2048 sc1 lds
    buffer_load_dwordx4 v2, s[32:35], s47 offen offset:3072 sc1 lds
    s_add_u32 m0, m0, 4096
    s_add_u32 s47, s47, 4096
    buffer_load_dwordx4 v2, s[32:35], s47 offen offset:0 sc1 lds
    buffer_load_dwordx4 v2, s[32:35], s47 offen offset:1024 sc1 lds
    buffer_load_dwordx4 v2, s[32:35], s47 offen offset:2048 sc1 lds
    buffer_load_dwordx4 v2, s[32:35], s47 offen offset:3072 sc1 lds
    s_add_u32 m0, m0, 4096
    s_add_u32 s47, s47, 4096
    buffer_load_dwordx4 v2, s[32:35], s47 offen offset:0 sc1 lds
    buffer_load_dwordx4 v2, s[32:35], s47 offen offset:1024 sc1 lds
    s_waitcnt vmcnt(10)
    s_barrier
    s_add_u32 s48, s67, 1
    s_mul_i32 s48, s48, 45056
    s_add_u32 s47, s48, s68
    s_cmp_lg_u32 s41, 2
    s_cbranch_scc1 S_nox1
    s_mov_b32 m0, 69632
    s_add_u32 s48, s48, 20480
    buffer_load_dwordx4 v2, s[32:35], s48 offen offset:0 sc1 lds
    buffer_load_dwordx4 v2, s[32:35], s48 offen offset:1024 sc1 lds
S_nox1:
    s_add_u32 m0, s68, 49152
    s_nop 0
    buffer_load_dwordx4 v2, s[32:35], s47 offen offset:0 sc1 lds
    buffer_load_dwordx4 v2, s[32:35], s47 offen offset:1024 sc1 lds
    buffer_load_dwordx4 v2, s[32:35], s47 offen offset:2048 sc1 lds
    buffer_load_dwordx4 v2, s[32:35], s47 offen offset:3072 sc1 lds
    s_add_u32 m0, m0, 4096
    s_add_u32 s47, s47, 4096
    buffer_load_dwordx4 v2, s[32:35], s47 offen offset:0 sc1 lds
    buffer_load_dwordx4 v2, s[32:35], s47 offen offset:1024 sc1 lds
    buffer_load_dwordx4 v2, s[32:35], s47 offen offset:2048 sc1 lds
    buffer_load_dwordx4 v2, s[32:35], s47 offen offset:3072 sc1 lds
    s_add_u32 m0, m0, 4096
    s_add_u32 s47, s47, 4096
    buffer_load_dwordx4 v2, s[32:35], s47 offen offset:0 sc1 lds
    buffer_load_dwordx4 v2, s[32:35], s47 offen offset:1024 sc1 lds
    v_add_u32 v15, s68, v2
    s_setprio 0
    s_waitcnt vmcnt(10)
    ds_read_b128 v[160:163], v22 offset:0
    ds_read_b128 v[164:167], v22 offset:1024
    ds_read_b128 v[168:171], v22 offset:2048
    ds_read_b128 v[172:175], v22 offset:3072
    ds_read_b128 v[176:179], v22 offset:4096
    ds_read_b128 v[180:183], v22 offset:5120
    ds_read_b128 v[184:187], v22 offset:6144
    ds_read_b128 v[188:191], v22 offset:7168
    ds_read_b128 v[192:195], v22 offset:8192
    ds_read_b128 v[196:199], v22 offset:9216
    ds_read_b128 v[200:203], v22 offset:10240
    ds_read_b128 v[204:207], v22 offset:11264
    s_waitcnt lgkmcnt(10)
    v_mfma_f32_16x16x32_bf16 v[128:131], v[160:163], v[28:31], 0
    v_mfma_f32_16x16x32_bf16 v[132:135], v[164:167], v[28:31], 0
    v_mfma_f32_16x16x32_bf16 v[136:139], v[160:163], v[48:51], 0
    v_mfma_f32_16x16x32_bf16 v[140:143], v[164:167], v[48:51], 0
    v_mfma_f32_16x16x32_bf16 v[144:147], v[160:163], v[68:71], 0
    v_mfma_f32_16x16x32_bf16 v[148:151], v[164:167], v[68:71], 0
    v_mfma_f32_16x16x32_bf16 v[152:155], v[160:163], v[88:91], 0
    v_mfma_f32_16x16x32_bf16 v[156:159], v[164:167], v[88:91], 0
    s_waitcnt lgkmcnt(8)
    v_mfma_f32_16x16x32_bf16 v[128:131], v[168:171], v[32:35], v[128:131]
    v_mfma_f32_16x16x32_bf16 v[132:135], v[172:175], v[32:35], v[132:135]
    v_mfma_f32_16x16x32_bf16 v[136:139], v[168:171], v[52:55], v[136:139]
    v_mfma_f32_16x16x32_bf16 v[140:143], v[172:175], v[52:55], v[140:143]
    v_mfma_f32_16x16x32_bf16 v[144:147], v[168:171], v[72:75], v[144:147]
    v_mfma_f32_16x16x32_bf16 v[148:151], v[172:175], v[72:75], v[148:151]
    v_mfma_f32_16x16x32_bf16 v[152:155], v[168:171], v[92:95], v[152:155]
    v_mfma_f32_16x16x32_bf16 v[156:159], v[172:175], v[92:95], v[156:159]
    s_waitcnt lgkmcnt(6)
    v_mfma_f32_16x16x32_bf16 v[128:131], v[176:179], v[36:39], v[128:131]
    v_mfma_f32_16x16x32_bf16 v[132:135], v[180:183], v[36:39], v[132:135]
    v_mfma_f32_16x16x32_bf16 v[136:139], v[176:179], v[56:59], v[136:139]
    v_mfma_f32_16x16x32_bf16 v[140:143], v[180:183], v[56:59], v[140:143]
    v_mfma_f32_16x16x32_bf16 v[144:147], v[176:179], v[76:79], v[144:147]
    v_mfma_f32_16x16x32_bf16 v[148:151], v[180:183], v[76:79], v[148:151]
    v_mfma_f32_16x16x32_bf16 v[152:155], v[176:179], v[96:99], v[152:155]
    v_mfma_f32_16x16x32_bf16 v[156:159], v[180:183], v[96:99], v[156:159]
    s_waitcnt lgkmcnt(4)
    v_mfma_f32_16x16x32_bf16 v[128:131], v[184:187], v[40:43], v[128:131]
    v_mfma_f32_16x16x32_bf16 v[132:135], v[188:191], v[40:43], v[132:135]
    v_mfma_f32_16x16x32_bf16 v[136:139], v[184:187], v[60:63], v[136:139]
    v_mfma_f32_16x16x32_bf16 v[140:143], v[188:191], v[60:63], v[140:143]
    v_mfma_f32_16x16x32_bf16 v[144:147], v[184:187], v[80:83], v[144:147]
    v_mfma_f32_16x16x32_bf16 v[148:151], v[188:191], v[80:83], v[148:151]
    v_mfma_f32_16x16x32_bf16 v[152:155], v[184:187], v[100:103], v[152:155]
    v_mfma_f32_16x16x32_bf16 v[156:159], v[188:191], v[100:103], v[156:159]
    s_waitcnt lgkmcnt(2)
    v_mfma_f32_16x16x32_bf16 v[128:131], v[192:195], v[44:47], v[128:131]
    v_mfma_f32_16x16x32_bf16 v[132:135], v[196:199], v[44:47], v[132:135]
    v_mfma_f32_16x16x32_bf16 v[136:139], v[192:195], v[64:67], v[136:139]
    v_mfma_f32_16x16x32_bf16 v[140:143], v[196:199], v[64:67], v[140:143]
    v_mfma_f32_16x16x32_bf16 v[144:147], v[192:195], v[84:87], v[144:147]
    v_mfma_f32_16x16x32_bf16 v[148:151], v[196:199], v[84:87], v[148:151]
    v_mfma_f32_16x16x32_bf16 v[152:155], v[192:195], v[104:107], v[152:155]
    v_mfma_f32_16x16x32_bf16 v[156:159], v[196:199], v[104:107], v[156:159]
    s_cmp_lg_u32 s41, 2
    s_cbranch_scc1 S_noy0
    s_waitcnt lgkmcnt(0)
    v_mfma_f32_16x16x32_bf16 v[128:131], v[200:203], v[108:111], v[128:131]
    v_mfma_f32_16x16x32_bf16 v[132:135], v[204:207], v[108:111], v[132:135]
    v_mfma_f32_16x16x32_bf16 v[136:139], v[200:203], v[108:111], v[136:139]
    v_mfma_f32_16x16x32_bf16 v[140:143], v[204:207], v[108:111], v[140:143]
    v_mfma_f32_16x16x32_bf16 v[144:147], v[200:203], v[108:111], v[144:147]
    v_mfma_f32_16x16x32_bf16 v[148:151], v[204:207], v[108:111], v[148:151]
    v_mfma_f32_16x16x32_bf16 v[152:155], v[200:203], v[108:111], v[152:155]
    v_mfma_f32_16x16x32_bf16 v[156:159], v[204:207], v[108:111], v[156:159]
S_noy0:
    v_nop
    s_nop 7
    s_waitcnt lgkmcnt(0)
    v_cvt_pk_bf16_f32 v112, v128, v129
    v_cvt_pk_bf16_f32 v113, v130, v131
    v_cvt_pk_bf16_f32 v114, v132, v133
    v_cvt_pk_bf16_f32 v115, v134, v135
    ds_write_b128 v15, v[112:115] offset:0
    v_cvt_pk_bf16_f32 v116, v136, v137
    v_cvt_pk_bf16_f32 v117, v138, v139
    v_cvt_pk_bf16_f32 v118, v140, v141
    v_cvt_pk_bf16_f32 v119, v142, v143
    ds_write_b128 v15, v[116:119] offset:1024
    v_cvt_pk_bf16_f32 v120, v144, v145
    v_cvt_pk_bf16_f32 v121, v146, v147
    v_cvt_pk_bf16_f32 v122, v148, v149
    v_cvt_pk_bf16_f32 v123, v150, v151
    ds_write_b128 v15, v[120:123] offset:2048
    v_cvt_pk_bf16_f32 v124, v152, v153
    v_cvt_pk_bf16_f32 v125, v154, v155
    v_cvt_pk_bf16_f32 v126, v156, v157
    v_cvt_pk_bf16_f32 v127, v158, v159
    ds_write_b128 v15, v[124:127] offset:3072
    s_waitcnt vmcnt(0)
    ds_read_b128 v[160:163], v22 offset:49152
    ds_read_b128 v[164:167], v22 offset:50176
    ds_read_b128 v[168:171], v22 offset:51200
    ds_read_b128 v[172:175], v22 offset:52224
    ds_read_b128 v[176:179], v22 offset:53248
    ds_read_b128 v[180:183], v22 offset:54272
    ds_read_b128 v[184:187], v22 offset:55296
    ds_read_b128 v[188:191], v22 offset:56320
    ds_read_b128 v[192:195], v22 offset:57344
    ds_read_b128 v[196:199], v22 offset:58368
    ds_read_b128 v[200:203], v22 offset:59392
    ds_read_b128 v[204:207], v22 offset:60416
    s_waitcnt lgkmcnt(10)
    v_mfma_f32_16x16x32_bf16 v[128:131], v[160:163], v[28:31], 0
    v_mfma_f32_16x16x32_bf16 v[132:135], v[164:167], v[28:31], 0
    v_mfma_f32_16x16x32_bf16 v[136:139], v[160:163], v[48:51], 0
    v_mfma_f32_16x16x32_bf16 v[140:143], v[164:167], v[48:51], 0
    v_mfma_f32_16x16x32_bf16 v[144:147], v[160:163], v[68:71], 0
    v_mfma_f32_16x16x32_bf16 v[148:151], v[164:167], v[68:71], 0
    v_mfma_f32_16x16x32_bf16 v[152:155], v[160:163], v[88:91], 0
    v_mfma_f32_16x16x32_bf16 v[156:159], v[164:167], v[88:91], 0
    s_waitcnt lgkmcnt(8)
    v_mfma_f32_16x16x32_bf16 v[128:131], v[168:171], v[32:35], v[128:131]
    v_mfma_f32_16x16x32_bf16 v[132:135], v[172:175], v[32:35], v[132:135]
    v_mfma_f32_16x16x32_bf16 v[136:139], v[168:171], v[52:55], v[136:139]
    v_mfma_f32_16x16x32_bf16 v[140:143], v[172:175], v[52:55], v[140:143]
    v_mfma_f32_16x16x32_bf16 v[144:147], v[168:171], v[72:75], v[144:147]
    v_mfma_f32_16x16x32_bf16 v[148:151], v[172:175], v[72:75], v[148:151]
    v_mfma_f32_16x16x32_bf16 v[152:155], v[168:171], v[92:95], v[152:155]
    v_mfma_f32_16x16x32_bf16 v[156:159], v[172:175], v[92:95], v[156:159]
    s_waitcnt lgkmcnt(6)
    v_mfma_f32_16x16x32_bf16 v[128:131], v[176:179], v[36:39], v[128:131]
    v_mfma_f32_16x16x32_bf16 v[132:135], v[180:183], v[36:39], v[132:135]
    v_mfma_f32_16x16x32_bf16 v[136:139], v[176:179], v[56:59], v[136:139]
    v_mfma_f32_16x16x32_bf16 v[140:143], v[180:183], v[56:59], v[140:143]
    v_mfma_f32_16x16x32_bf16 v[144:147], v[176:179], v[76:79], v[144:147]
    v_mfma_f32_16x16x32_bf16 v[148:151], v[180:183], v[76:79], v[148:151]
    v_mfma_f32_16x16x32_bf16 v[152:155], v[176:179], v[96:99], v[152:155]
    v_mfma_f32_16x16x32_bf16 v[156:159], v[180:183], v[96:99], v[156:159]
    s_waitcnt lgkmcnt(4)
    v_mfma_f32_16x16x32_bf16 v[128:131], v[184:187], v[40:43], v[128:131]
    v_mfma_f32_16x16x32_bf16 v[132:135], v[188:191], v[40:43], v[132:135]
    v_mfma_f32_16x16x32_bf16 v[136:139], v[184:187], v[60:63], v[136:139]
    v_mfma_f32_16x16x32_bf16 v[140:143], v[188:191], v[60:63], v[140:143]
    v_mfma_f32_16x16x32_bf16 v[144:147], v[184:187], v[80:83], v[144:147]
    v_mfma_f32_16x16x32_bf16 v[148:151], v[188:191], v[80:83], v[148:151]
    v_mfma_f32_16x16x32_bf16 v[152:155], v[184:187], v[100:103], v[152:155]
    v_mfma_f32_16x16x32_bf16 v[156:159], v[188:191], v[100:103], v[156:159]
    s_waitcnt lgkmcnt(2)
    v_mfma_f32_16x16x32_bf16 v[128:131], v[192:195], v[44:47], v[128:131]
    v_mfma_f32_16x16x32_bf16 v[132:135], v[196:199], v[44:47], v[132:135]
    v_mfma_f32_16x16x32_bf16 v[136:139], v[192:195], v[64:67], v[136:139]
    v_mfma_f32_16x16x32_bf16 v[140:143], v[196:199], v[64:67], v[140:143]
    v_mfma_f32_16x16x32_bf16 v[144:147], v[192:195], v[84:87], v[144:147]
    v_mfma_f32_16x16x32_bf16 v[148:151], v[196:199], v[84:87], v[148:151]
    v_mfma_f32_16x16x32_bf16 v[152:155], v[192:195], v[104:107], v[152:155]
    v_mfma_f32_16x16x32_bf16 v[156:159], v[196:199], v[104:107], v[156:159]
    s_cmp_lg_u32 s41, 2
    s_cbranch_scc1 S_noy1
    s_waitcnt lgkmcnt(0)
    v_mfma_f32_16x16x32_bf16 v[128:131], v[200:203], v[108:111], v[128:131]
    v_mfma_f32_16x16x32_bf16 v[132:135], v[204:207], v[108:111], v[132:135]
    v_mfma_f32_16x16x32_bf16 v[136:139], v[200:203], v[108:111], v[136:139]
    v_mfma_f32_16x16x32_bf16 v[140:143], v[204:207], v[108:111], v[140:143]
    v_mfma_f32_16x16x32_bf16 v[144:147], v[200:203], v[108:111], v[144:147]
    v_mfma_f32_16x16x32_bf16 v[148:151], v[204:207], v[108:111], v[148:151]
    v_mfma_f32_16x16x32_bf16 v[152:155], v[200:203], v[108:111], v[152:155]
    v_mfma_f32_16x16x32_bf16 v[156:159], v[204:207], v[108:111], v[156:159]
S_noy1:
    v_nop
    s_nop 7
    s_waitcnt lgkmcnt(0)
    v_cvt_pk_bf16_f32 v112, v128, v129
    v_cvt_pk_bf16_f32 v113, v130, v131
    v_cvt_pk_bf16_f32 v114, v132, v133
    v_cvt_pk_bf16_f32 v115, v134, v135
    ds_write_b128 v15, v[112:115] offset:49152
    v_cvt_pk_bf16_f32 v116, v136, v137
    v_cvt_pk_bf16_f32 v117, v138, v139
    v_cvt_pk_bf16_f32 v118, v140, v141
    v_cvt_pk_bf16_f32 v119, v142, v143
    ds_write_b128 v15, v[116:119] offset:50176
    v_cvt_pk_bf16_f32 v120, v144, v145
    v_cvt_pk_bf16_f32 v121, v146, v147
    v_cvt_pk_bf16_f32 v122, v148, v149
    v_cvt_pk_bf16_f32 v123, v150, v151
    ds_write_b128 v15, v[120:123] offset:51200
    v_cvt_pk_bf16_f32 v124, v152, v153
    v_cvt_pk_bf16_f32 v125, v154, v155
    v_cvt_pk_bf16_f32 v126, v156, v157
    v_cvt_pk_bf16_f32 v127, v158, v159
    ds_write_b128 v15, v[124:127] offset:52224
    s_waitcnt lgkmcnt(0)
    s_barrier
    s_endpgm
S_tab0:
    v_and_b32 v18, 15, v1
    v_lshrrev_b32 v19, 4, v1
    s_lshl_b32 s49, s42, 1
    s_lshl_b32 s67, s43, 2
    s_add_u32 s67, s67, s49
    s_lshl_b32 s49, s44, 6
    v_add_u32 v3, s49, v18
    v_cvt_f32_u32 v25, v3
    s_sub_u32 s49, 164, s41
    s_cmp_lt_u32 s41, 2
    s_cselect_b32 s49, s41, s49
    v_lshrrev_b32 v3, 5, v1
    v_lshl_add_u32 v3, v3, 3, s49
    v_cvt_f32_u32 v23, v3
    v_and_b32 v4, 1, v19
    v_cvt_f32_u32 v4, v4
    v_mul_f32 v24, 0x3e800000, v4
    v_add_u32 v3, s41, v19
    v_cmp_eq_u32 s[52:53], 0, v3
    v_add_u32 v3, v18, v19
    v_cvt_f32_u32 v3, v3
    v_mul_f32 v3, 0x3e800000, v3
    v_cos_f32 v3, v3
    s_mov_b32 vcc_lo, -1
    s_mov_b32 vcc_hi, 0
    v_cvt_pk_bf16_f32 v3, v3, 0
    v_cndmask_b32 v108, 0, v3, vcc
    v_mov_b32 v109, 0
    v_mov_b32 v110, 0
    v_mov_b32 v111, 0
    s_and_b32 s68, s41, 1
    s_mul_i32 s68, s68, 11
    s_lshr_b32 s49, s41, 1
    s_mul_i32 s49, s49, 5
    s_add_u32 s68, s68, s49
    s_lshl_b32 s68, s68, 11
    v_lshrrev_b32 v3, 1, v18
    v_lshl_add_u32 v3, v3, 7, s68
    v_lshrrev_b32 v4, 2, v18
    v_and_b32 v4, 2, v4
    v_xor_b32 v4, v4, v19
    v_lshl_add_u32 v3, v4, 4, v3
    v_and_b32 v4, 1, v18
    v_lshl_add_u32 v22, v4, 6, v3
    s_cmp_eq_u32 s41, 2
    s_mov_b32 vcc_lo, 0
    s_cselect_b32 vcc_hi, -1, 0
    v_add_f32 v20, 0x00000000, v25
    v_mul_f32 v3, 0x3d4ccccd, v20
    v_mul_f32 v20, 0x3acccccd, v20
    v_cos_f32 v3, v3
    v_fma_f32 v21, v23, v20, v24
    v_add_f32 v26, v3, v3
    v_add_f32 v27, v3, v3
    v_fmamk_f32 v113, v20, 0x40000000, v21
    v_fmamk_f32 v114, v20, 0x40800000, v21
    v_fmamk_f32 v115, v20, 0x40c00000, v21
    v_fmamk_f32 v116, v20, 0x41800000, v21
    v_fmamk_f32 v117, v20, 0x41900000, v21
    v_fmamk_f32 v118, v20, 0x41a00000, v21
    v_fmamk_f32 v119, v20, 0x41b00000, v21
    v_fmamk_f32 v120, v20, 0x42000000, v21
    v_fmamk_f32 v121, v20, 0x42080000, v21
    v_fmamk_f32 v122, v20, 0x42100000, v21
    v_fmamk_f32 v123, v20, 0x42180000, v21
    v_fmamk_f32 v124, v20, 0x42400000, v21
    v_fmamk_f32 v125, v20, 0x42480000, v21
    v_fmamk_f32 v126, v20, 0x42500000, v21
    v_fmamk_f32 v127, v20, 0x42580000, v21
    v_cos_f32 v112, v21
    v_cos_f32 v113, v113
    v_cos_f32 v114, v114
    v_cos_f32 v115, v115
    v_cos_f32 v116, v116
    v_cos_f32 v117, v117
    v_cos_f32 v118, v118
    v_cos_f32 v119, v119
    v_cos_f32 v120, v120
    v_cos_f32 v121, v121
    v_cos_f32 v122, v122
    v_cos_f32 v123, v123
    v_cos_f32 v124, v124
    v_cos_f32 v125, v125
    v_cos_f32 v126, v126
    v_cos_f32 v127, v127
    v_cndmask_b32 v3, v112, 0.5, s[52:53]
    v_cvt_pk_bf16_f32 v28, v3, v113
    v_cvt_pk_bf16_f32 v29, v114, v115
    v_cvt_pk_bf16_f32 v30, v116, v117
    v_cvt_pk_bf16_f32 v31, v118, v119
    v_cvt_pk_bf16_f32 v32, v120, v121
    v_cvt_pk_bf16_f32 v33, v122, v123
    v_cvt_pk_bf16_f32 v34, v124, v125
    v_cvt_pk_bf16_f32 v35, v126, v127
    v_pk_fma_f32 v[112:113], v[120:121], v[26:27], v[112:113] neg_lo:[0,0,1] neg_hi:[0,0,1]
    v_pk_fma_f32 v[114:115], v[122:123], v[26:27], v[114:115] neg_lo:[0,0,1] neg_hi:[0,0,1]
    v_pk_fma_f32 v[116:117], v[124:125], v[26:27], v[116:117] neg_lo:[0,0,1] neg_hi:[0,0,1]
    v_pk_fma_f32 v[118:119], v[126:127], v[26:27], v[118:119] neg_lo:[0,0,1] neg_hi:[0,0,1]
    v_cvt_pk_bf16_f32 v36, v112, v113
    v_cvt_pk_bf16_f32 v37, v114, v115
    v_cvt_pk_bf16_f32 v38, v116, v117
    v_cvt_pk_bf16_f32 v39, v118, v119
    v_pk_fma_f32 v[120:121], v[112:113], v[26:27], v[120:121] neg_lo:[0,0,1] neg_hi:[0,0,1]
    v_pk_fma_f32 v[122:123], v[114:115], v[26:27], v[122:123] neg_lo:[0,0,1] neg_hi:[0,0,1]
    v_pk_fma_f32 v[124:125], v[116:117], v[26:27], v[124:125] neg_lo:[0,0,1] neg_hi:[0,0,1]
    v_pk_fma_f32 v[126:127], v[118:119], v[26:27], v[126:127] neg_lo:[0,0,1] neg_hi:[0,0,1]
    v_cvt_pk_bf16_f32 v40, v120, v121
    v_cvt_pk_bf16_f32 v41, v122, v123
    v_cvt_pk_bf16_f32 v42, v124, v125
    v_cvt_pk_bf16_f32 v43, v126, v127
    v_pk_fma_f32 v[112:113], v[120:121], v[26:27], v[112:113] neg_lo:[0,0,1] neg_hi:[0,0,1]
    v_pk_fma_f32 v[114:115], v[122:123], v[26:27], v[114:115] neg_lo:[0,0,1] neg_hi:[0,0,1]
    v_pk_fma_f32 v[116:117], v[124:125], v[26:27], v[116:117] neg_lo:[0,0,1] neg_hi:[0,0,1]
    v_pk_fma_f32 v[118:119], v[126:127], v[26:27], v[118:119] neg_lo:[0,0,1] neg_hi:[0,0,1]
    v_cvt_pk_bf16_f32 v44, v112, v113
    v_cvt_pk_bf16_f32 v45, v114, v115
    v_cvt_pk_bf16_f32 v46, v116, v117
    v_mul_f32 v3, 0.5, v119
    v_cndmask_b32 v3, v119, v3, vcc
    v_cvt_pk_bf16_f32 v47, v118, v3
    s_setpc_b64 s[58:59]
S_tab1:
    v_add_f32 v20, 0x41800000, v25
    v_mul_f32 v3, 0x3d4ccccd, v20
    v_mul_f32 v20, 0x3acccccd, v20
    v_cos_f32 v3, v3
    v_fma_f32 v21, v23, v20, v24
    v_add_f32 v26, v3, v3
    v_add_f32 v27, v3, v3
    v_fmamk_f32 v113, v20, 0x40000000, v21
    v_fmamk_f32 v114, v20, 0x40800000, v21
    v_fmamk_f32 v115, v20, 0x40c00000, v21
    v_fmamk_f32 v116, v20, 0x41800000, v21
    v_fmamk_f32 v117, v20, 0x41900000, v21
    v_fmamk_f32 v118, v20, 0x41a00000, v21
    v_fmamk_f32 v119, v20, 0x41b00000, v21
    v_fmamk_f32 v120, v20, 0x42000000, v21
    v_fmamk_f32 v121, v20, 0x42080000, v21
    v_fmamk_f32 v122, v20, 0x42100000, v21
    v_fmamk_f32 v123, v20, 0x42180000, v21
    v_fmamk_f32 v124, v20, 0x42400000, v21
    v_fmamk_f32 v125, v20, 0x42480000, v21
    v_fmamk_f32 v126, v20, 0x42500000, v21
    v_fmamk_f32 v127, v20, 0x42580000, v21
    v_cos_f32 v112, v21
    v_cos_f32 v113, v113
    v_cos_f32 v114, v114
    v_cos_f32 v115, v115
    v_cos_f32 v116, v116
    v_cos_f32 v117, v117
    v_cos_f32 v118, v118
    v_cos_f32 v119, v119
    v_cos_f32 v120, v120
    v_cos_f32 v121, v121
    v_cos_f32 v122, v122
    v_cos_f32 v123, v123
    v_cos_f32 v124, v124
    v_cos_f32 v125, v125
    v_cos_f32 v126, v126
    v_cos_f32 v127, v127
    v_cndmask_b32 v3, v112, 0.5, s[52:53]
    v_cvt_pk_bf16_f32 v48, v3, v113
    v_cvt_pk_bf16_f32 v49, v114, v115
    v_cvt_pk_bf16_f32 v50, v116, v117
    v_cvt_pk_bf16_f32 v51, v118, v119
    v_cvt_pk_bf16_f32 v52, v120, v121
    v_cvt_pk_bf16_f32 v53, v122, v123
    v_cvt_pk_bf16_f32 v54, v124, v125
    v_cvt_pk_bf16_f32 v55, v126, v127
    v_pk_fma_f32 v[112:113], v[120:121], v[26:27], v[112:113] neg_lo:[0,0,1] neg_hi:[0,0,1]
    v_pk_fma_f32 v[114:115], v[122:123], v[26:27], v[114:115] neg_lo:[0,0,1] neg_hi:[0,0,1]
    v_pk_fma_f32 v[116:117], v[124:125], v[26:27], v[116:117] neg_lo:[0,0,1] neg_hi:[0,0,1]
    v_pk_fma_f32 v[118:119], v[126:127], v[26:27], v[118:119] neg_lo:[0,0,1] neg_hi:[0,0,1]
    v_cvt_pk_bf16_f32 v56, v112, v113
    v_cvt_pk_bf16_f32 v57, v114, v115
    v_cvt_pk_bf16_f32 v58, v116, v117
    v_cvt_pk_bf16_f32 v59, v118, v119
    v_pk_fma_f32 v[120:121], v[112:113], v[26:27], v[120:121] neg_lo:[0,0,1] neg_hi:[0,0,1]
    v_pk_fma_f32 v[122:123], v[114:115], v[26:27], v[122:123] neg_lo:[0,0,1] neg_hi:[0,0,1]
    v_pk_fma_f32 v[124:125], v[116:117], v[26:27], v[124:125] neg_lo:[0,0,1] neg_hi:[0,0,1]
    v_pk_fma_f32 v[126:127], v[118:119], v[26:27], v[126:127] neg_lo:[0,0,1] neg_hi:[0,0,1]
    v_cvt_pk_bf16_f32 v60, v120, v121
    v_cvt_pk_bf16_f32 v61, v122, v123
    v_cvt_pk_bf16_f32 v62, v124, v125
    v_cvt_pk_bf16_f32 v63, v126, v127
    v_pk_fma_f32 v[112:113], v[120:121], v[26:27], v[112:113] neg_lo:[0,0,1] neg_hi:[0,0,1]
    v_pk_fma_f32 v[114:115], v[122:123], v[26:27], v[114:115] neg_lo:[0,0,1] neg_hi:[0,0,1]
    v_pk_fma_f32 v[116:117], v[124:125], v[26:27], v[116:117] neg_lo:[0,0,1] neg_hi:[0,0,1]
    v_pk_fma_f32 v[118:119], v[126:127], v[26:27], v[118:119] neg_lo:[0,0,1] neg_hi:[0,0,1]
    v_cvt_pk_bf16_f32 v64, v112, v113
    v_cvt_pk_bf16_f32 v65, v114, v115
    v_cvt_pk_bf16_f32 v66, v116, v117
    v_mul_f32 v3, 0.5, v119
    v_cndmask_b32 v3, v119, v3, vcc
    v_cvt_pk_bf16_f32 v67, v118, v3
    s_setpc_b64 s[58:59]
S_tab2:
    v_add_f32 v20, 0x42000000, v25
    v_mul_f32 v3, 0x3d4ccccd, v20
    v_mul_f32 v20, 0x3acccccd, v20
    v_cos_f32 v3, v3
    v_fma_f32 v21, v23, v20, v24
    v_add_f32 v26, v3, v3
    v_add_f32 v27, v3, v3
    v_fmamk_f32 v113, v20, 0x40000000, v21
    v_fmamk_f32 v114, v20, 0x40800000, v21
    v_fmamk_f32 v115, v20, 0x40c00000, v21
    v_fmamk_f32 v116, v20, 0x41800000, v21
    v_fmamk_f32 v117, v20, 0x41900000, v21
    v_fmamk_f32 v118, v20, 0x41a00000, v21
    v_fmamk_f32 v119, v20, 0x41b00000, v21
    v_fmamk_f32 v120, v20, 0x42000000, v21
    v_fmamk_f32 v121, v20, 0x42080000, v21
    v_fmamk_f32 v122, v20, 0x42100000, v21
    v_fmamk_f32 v123, v20, 0x42180000, v21
    v_fmamk_f32 v124, v20, 0x42400000, v21
    v_fmamk_f32 v125, v20, 0x42480000, v21
    v_fmamk_f32 v126, v20, 0x42500000, v21
    v_fmamk_f32 v127, v20, 0x42580000, v21
    v_cos_f32 v112, v21
    v_cos_f32 v113, v113
    v_cos_f32 v114, v114
    v_cos_f32 v115, v115
    v_cos_f32 v116, v116
    v_cos_f32 v117, v117
    v_cos_f32 v118, v118
    v_cos_f32 v119, v119
    v_cos_f32 v120, v120
    v_cos_f32 v121, v121
    v_cos_f32 v122, v122
    v_cos_f32 v123, v123
    v_cos_f32 v124, v124
    v_cos_f32 v125, v125
    v_cos_f32 v126, v126
    v_cos_f32 v127, v127
    v_cndmask_b32 v3, v112, 0.5, s[52:53]
    v_cvt_pk_bf16_f32 v68, v3, v113
    v_cvt_pk_bf16_f32 v69, v114, v115
    v_cvt_pk_bf16_f32 v70, v116, v117
    v_cvt_pk_bf16_f32 v71, v118, v119
    v_cvt_pk_bf16_f32 v72, v120, v121
    v_cvt_pk_bf16_f32 v73, v122, v123
    v_cvt_pk_bf16_f32 v74, v124, v125
    v_cvt_pk_bf16_f32 v75, v126, v127
    v_pk_fma_f32 v[112:113], v[120:121], v[26:27], v[112:113] neg_lo:[0,0,1] neg_hi:[0,0,1]
    v_pk_fma_f32 v[114:115], v[122:123], v[26:27], v[114:115] neg_lo:[0,0,1] neg_hi:[0,0,1]
    v_pk_fma_f32 v[116:117], v[124:125], v[26:27], v[116:117] neg_lo:[0,0,1] neg_hi:[0,0,1]
    v_pk_fma_f32 v[118:119], v[126:127], v[26:27], v[118:119] neg_lo:[0,0,1] neg_hi:[0,0,1]
    v_cvt_pk_bf16_f32 v76, v112, v113
    v_cvt_pk_bf16_f32 v77, v114, v115
    v_cvt_pk_bf16_f32 v78, v116, v117
    v_cvt_pk_bf16_f32 v79, v118, v119
    v_pk_fma_f32 v[120:121], v[112:113], v[26:27], v[120:121] neg_lo:[0,0,1] neg_hi:[0,0,1]
    v_pk_fma_f32 v[122:123], v[114:115], v[26:27], v[122:123] neg_lo:[0,0,1] neg_hi:[0,0,1]
    v_pk_fma_f32 v[124:125], v[116:117], v[26:27], v[124:125] neg_lo:[0,0,1] neg_hi:[0,0,1]
    v_pk_fma_f32 v[126:127], v[118:119], v[26:27], v[126:127] neg_lo:[0,0,1] neg_hi:[0,0,1]
    v_cvt_pk_bf16_f32 v80, v120, v121
    v_cvt_pk_bf16_f32 v81, v122, v123
    v_cvt_pk_bf16_f32 v82, v124, v125
    v_cvt_pk_bf16_f32 v83, v126, v127
    v_pk_fma_f32 v[112:113], v[120:121], v[26:27], v[112:113] neg_lo:[0,0,1] neg_hi:[0,0,1]
    v_pk_fma_f32 v[114:115], v[122:123], v[26:27], v[114:115] neg_lo:[0,0,1] neg_hi:[0,0,1]
    v_pk_fma_f32 v[116:117], v[124:125], v[26:27], v[116:117] neg_lo:[0,0,1] neg_hi:[0,0,1]
    v_pk_fma_f32 v[118:119], v[126:127], v[26:27], v[118:119] neg_lo:[0,0,1] neg_hi:[0,0,1]
    v_cvt_pk_bf16_f32 v84, v112, v113
    v_cvt_pk_bf16_f32 v85, v114, v115
    v_cvt_pk_bf16_f32 v86, v116, v117
    v_mul_f32 v3, 0.5, v119
    v_cndmask_b32 v3, v119, v3, vcc
    v_cvt_pk_bf16_f32 v87, v118, v3
    s_setpc_b64 s[58:59]
S_tab3:
    v_add_f32 v20, 0x42400000, v25
    v_mul_f32 v3, 0x3d4ccccd, v20
    v_mul_f32 v20, 0x3acccccd, v20
    v_cos_f32 v3, v3
    v_fma_f32 v21, v23, v20, v24
    v_add_f32 v26, v3, v3
    v_add_f32 v27, v3, v3
    v_fmamk_f32 v113, v20, 0x40000000, v21
    v_fmamk_f32 v114, v20, 0x40800000, v21
    v_fmamk_f32 v115, v20, 0x40c00000, v21
    v_fmamk_f32 v116, v20, 0x41800000, v21
    v_fmamk_f32 v117, v20, 0x41900000, v21
    v_fmamk_f32 v118, v20, 0x41a00000, v21
    v_fmamk_f32 v119, v20, 0x41b00000, v21
    v_fmamk_f32 v120, v20, 0x42000000, v21
    v_fmamk_f32 v121, v20, 0x42080000, v21
    v_fmamk_f32 v122, v20, 0x42100000, v21
    v_fmamk_f32 v123, v20, 0x42180000, v21
    v_fmamk_f32 v124, v20, 0x42400000, v21
    v_fmamk_f32 v125, v20, 0x42480000, v21
    v_fmamk_f32 v126, v20, 0x42500000, v21
    v_fmamk_f32 v127, v20, 0x42580000, v21
    v_cos_f32 v112, v21
    v_cos_f32 v113, v113
    v_cos_f32 v114, v114
    v_cos_f32 v115, v115
    v_cos_f32 v116, v116
    v_cos_f32 v117, v117
    v_cos_f32 v118, v118
    v_cos_f32 v119, v119
    v_cos_f32 v120, v120
    v_cos_f32 v121, v121
    v_cos_f32 v122, v122
    v_cos_f32 v123, v123
    v_cos_f32 v124, v124
    v_cos_f32 v125, v125
    v_cos_f32 v126, v126
    v_cos_f32 v127, v127
    v_cndmask_b32 v3, v112, 0.5, s[52:53]
    v_cvt_pk_bf16_f32 v88, v3, v113
    v_cvt_pk_bf16_f32 v89, v114, v115
    v_cvt_pk_bf16_f32 v90, v116, v117
    v_cvt_pk_bf16_f32 v91, v118, v119
    v_cvt_pk_bf16_f32 v92, v120, v121
    v_cvt_pk_bf16_f32 v93, v122, v123
    v_cvt_pk_bf16_f32 v94, v124, v125
    v_cvt_pk_bf16_f32 v95, v126, v127
    v_pk_fma_f32 v[112:113], v[120:121], v[26:27], v[112:113] neg_lo:[0,0,1] neg_hi:[0,0,1]
    v_pk_fma_f32 v[114:115], v[122:123], v[26:27], v[114:115] neg_lo:[0,0,1] neg_hi:[0,0,1]
    v_pk_fma_f32 v[116:117], v[124:125], v[26:27], v[116:117] neg_lo:[0,0,1] neg_hi:[0,0,1]
    v_pk_fma_f32 v[118:119], v[126:127], v[26:27], v[118:119] neg_lo:[0,0,1] neg_hi:[0,0,1]
    v_cvt_pk_bf16_f32 v96, v112, v113
    v_cvt_pk_bf16_f32 v97, v114, v115
    v_cvt_pk_bf16_f32 v98, v116, v117
    v_cvt_pk_bf16_f32 v99, v118, v119
    v_pk_fma_f32 v[120:121], v[112:113], v[26:27], v[120:121] neg_lo:[0,0,1] neg_hi:[0,0,1]
    v_pk_fma_f32 v[122:123], v[114:115], v[26:27], v[122:123] neg_lo:[0,0,1] neg_hi:[0,0,1]
    v_pk_fma_f32 v[124:125], v[116:117], v[26:27], v[124:125] neg_lo:[0,0,1] neg_hi:[0,0,1]
    v_pk_fma_f32 v[126:127], v[118:119], v[26:27], v[126:127] neg_lo:[0,0,1] neg_hi:[0,0,1]
    v_cvt_pk_bf16_f32 v100, v120, v121
    v_cvt_pk_bf16_f32 v101, v122, v123
    v_cvt_pk_bf16_f32 v102, v124, v125
    v_cvt_pk_bf16_f32 v103, v126, v127
    v_pk_fma_f32 v[112:113], v[120:121], v[26:27], v[112:113] neg_lo:[0,0,1] neg_hi:[0,0,1]
    v_pk_fma_f32 v[114:115], v[122:123], v[26:27], v[114:115] neg_lo:[0,0,1] neg_hi:[0,0,1]
    v_pk_fma_f32 v[116:117], v[124:125], v[26:27], v[116:117] neg_lo:[0,0,1] neg_hi:[0,0,1]
    v_pk_fma_f32 v[118:119], v[126:127], v[26:27], v[118:119] neg_lo:[0,0,1] neg_hi:[0,0,1]
    v_cvt_pk_bf16_f32 v104, v112, v113
    v_cvt_pk_bf16_f32 v105, v114, v115
    v_cvt_pk_bf16_f32 v106, v116, v117
    v_mul_f32 v3, 0.5, v119
    v_cndmask_b32 v3, v119, v3, vcc
    v_cvt_pk_bf16_f32 v107, v118, v3
    s_setpc_b64 s[58:59]
S_t1load:
    s_add_u32 m0, s56, 0
    s_add_u32 s46, s46, 1
    buffer_load_dwordx4 v8, s[24:27], s54 offen offset:0 lds
    buffer_load_dwordx4 v9, s[24:27], s54 offen offset:1024 lds
    buffer_load_dwordx4 v10, s[24:27], s54 offen offset:2048 lds
    buffer_load_dwordx4 v11, s[24:27], s54 offen offset:3072 lds
    s_cmp_eq_u32 s46, 10
    s_cselect_b32 s47, -9, 1
    s_lshl_b32 s48, s47, 7
    s_add_u32 s54, s54, s48
    s_add_u32 m0, s56, 16384
    s_add_u32 s46, s46, 1
    buffer_load_dwordx4 v8, s[24:27], s54 offen offset:0 lds
    buffer_load_dwordx4 v9, s[24:27], s54 offen offset:1024 lds
    buffer_load_dwordx4 v10, s[24:27], s54 offen offset:2048 lds
    buffer_load_dwordx4 v11, s[24:27], s54 offen offset:3072 lds
    s_cmp_eq_u32 s46, 10
    s_cselect_b32 s47, -9, 1
    s_lshl_b32 s48, s47, 7
    s_add_u32 s54, s54, s48
    s_add_u32 m0, s56, 32768
    s_add_u32 s46, s46, 1
    buffer_load_dwordx4 v8, s[24:27], s54 offen offset:0 lds
    buffer_load_dwordx4 v9, s[24:27], s54 offen offset:1024 lds
    buffer_load_dwordx4 v10, s[24:27], s54 offen offset:2048 lds
    buffer_load_dwordx4 v11, s[24:27], s54 offen offset:3072 lds
    s_cmp_eq_u32 s46, 10
    s_cselect_b32 s47, -9, 1
    s_lshl_b32 s48, s47, 7
    s_add_u32 s54, s54, s48
    s_add_u32 s36, s22, 20578304
    s_addc_u32 s37, s23, 0
    s_mov_b32 s38, 289920
    s_mov_b32 s39, 0x20000
    s_load_dword s45, s[36:37], 289792
    s_waitcnt vmcnt(8)
    s_barrier
    s_add_u32 m0, s56, 49152
    s_add_u32 s46, s46, 1
    buffer_load_dwordx4 v8, s[24:27], s54 offen offset:0 lds
    buffer_load_dwordx4 v9, s[24:27], s54 offen offset:1024 lds
    buffer_load_dwordx4 v10, s[24:27], s54 offen offset:2048 lds
    buffer_load_dwordx4 v11, s[24:27], s54 offen offset:3072 lds
    s_cmp_eq_u32 s46, 10
    s_cselect_b32 s47, -9, 1
    s_lshl_b32 s48, s47, 7
    s_add_u32 s54, s54, s48
    s_waitcnt vmcnt(8) lgkmcnt(0)
    s_barrier
    s_add_u32 s45, s45, 2654435769
    v_mov_b32 v6, s45
    s_lshl_b32 s47, s2, 7
    s_cmp_lg_u32 s40, 4
    s_cselect_b32 s47, 2130706432, s47
    v_mov_b32 v3, s47
    s_mov_b64 exec, 1
    buffer_store_dword v6, v3, s[36:39], 0 offen sc1
    s_mov_b64 exec, -1
    s_add_u32 m0, s56, 0
    s_add_u32 s46, s46, 1
    buffer_load_dwordx4 v8, s[24:27], s54 offen offset:0 lds
    buffer_load_dwordx4 v9, s[24:27], s54 offen offset:1024 lds
    buffer_load_dwordx4 v10, s[24:27], s54 offen offset:2048 lds
    buffer_load_dwordx4 v11, s[24:27], s54 offen offset:3072 lds
    s_cmp_eq_u32 s46, 10
    s_cselect_b32 s47, -9, 1
    s_lshl_b32 s48, s47, 7
    s_add_u32 s54, s54, s48
    s_waitcnt vmcnt(9) lgkmcnt(0)
    s_barrier
    s_add_u32 m0, s56, 16384
    s_add_u32 s46, s46, 1
    buffer_load_dwordx4 v8, s[24:27], s54 offen offset:0 lds
    buffer_load_dwordx4 v9, s[24:27], s54 offen offset:1024 lds
    buffer_load_dwordx4 v10, s[24:27], s54 offen offset:2048 lds
    buffer_load_dwordx4 v11, s[24:27], s54 offen offset:3072 lds
    s_cmp_eq_u32 s46, 10
    s_cselect_b32 s47, -9, 1
    s_lshl_b32 s48, s47, 7
    s_add_u32 s54, s54, s48
    s_mov_b32 s28, s16
    s_mov_b32 s29, s17
    s_mov_b32 s30, 2211840
    s_mov_b32 s31, 0x20000
    s_mul_i32 s47, s42, 3
    s_add_u32 s47, s47, s44
    s_sub_u32 s47, s47, 5
    s_lshl_b32 s47, s47, 4
    s_add_u32 s47, s47, s43
    s_lshl_b32 s47, s47, 2
    s_add_u32 s47, s47, s41
    s_mul_i32 s47, s47, 6912
    v_min_u32 v3, 53, v1
    v_lshlrev_b32 v3, 7, v3
    buffer_load_dword v7, v3, s[28:31], s47 offen
    s_mov_b32 s28, s6
    s_mov_b32 s29, s7
    s_mov_b32 s30, 1314816
    s_mov_b32 s31, 0x20000
    s_mov_b32 s32, s8
    s_mov_b32 s33, s9
    s_mov_b32 s34, 1314816
    s_mov_b32 s35, 0x20000
    s_and_b32 s47, s2, 7
    s_lshl_b32 s47, s47, 1
    s_lshr_b32 s48, s41, 1
    s_add_u32 s47, s47, s48
    s_sub_u32 s48, 32, s47
    s_cmp_eq_u32 s47, 0
    s_cselect_b32 s48, 16, s48
    s_bitcmp1_b32 s41, 0
    s_cselect_b32 s47, s48, s47
    s_lshr_b32 s48, s2, 3
    s_sub_u32 s48, s48, 20
    s_mul_i32 s48, s48, 192
    s_add_u32 s47, s47, s48
    s_mul_i32 s47, s47, 642
    v_and_b32 v3, 7, v1
    v_min_u32 v3, 5, v3
    v_lshl_add_u32 v3, v3, 7, s47
    v_lshrrev_b32 v4, 3, v1
    v_min_u32 v4, 5, v4
    v_mul_u32_u24 v4, 20544, v4
    v_add_u32 v3, v3, v4
    buffer_load_ushort v7, v3, s[28:31], 0 offen
    buffer_load_ushort v7, v3, s[32:35], 0 offen
    s_waitcnt vmcnt(12) lgkmcnt(0)
    s_barrier
    s_add_u32 m0, s56, 32768
    s_add_u32 s46, s46, 1
    buffer_load_dwordx4 v8, s[24:27], s54 offen offset:0 lds
    buffer_load_dwordx4 v9, s[24:27], s54 offen offset:1024 lds
    buffer_load_dwordx4 v10, s[24:27], s54 offen offset:2048 lds
    buffer_load_dwordx4 v11, s[24:27], s54 offen offset:3072 lds
    s_cmp_eq_u32 s46, 10
    s_cselect_b32 s47, -9, 1
    s_lshl_b32 s48, s47, 7
    s_add_u32 s54, s54, s48
    s_waitcnt vmcnt(11) lgkmcnt(0)
    s_barrier
    s_add_u32 m0, s56, 49152
    s_add_u32 s46, s46, 1
    buffer_load_dwordx4 v8, s[24:27], s54 offen offset:0 lds
    buffer_load_dwordx4 v9, s[24:27], s54 offen offset:1024 lds
    buffer_load_dwordx4 v10, s[24:27], s54 offen offset:2048 lds
    buffer_load_dwordx4 v11, s[24:27], s54 offen offset:3072 lds
    s_cmp_eq_u32 s46, 10
    s_cselect_b32 s47, -9, 1
    s_lshl_b32 s48, s47, 7
    s_add_u32 s54, s54, s48
    s_waitcnt vmcnt(11) lgkmcnt(0)
    s_barrier
    s_add_u32 m0, s56, 0
    s_add_u32 s46, s46, 1
    buffer_load_dwordx4 v8, s[24:27], s54 offen offset:0 lds
    buffer_load_dwordx4 v9, s[24:27], s54 offen offset:1024 lds
    buffer_load_dwordx4 v10, s[24:27], s54 offen offset:2048 lds
    buffer_load_dwordx4 v11, s[24:27], s54 offen offset:3072 lds
    s_cmp_eq_u32 s46, 10
    s_cselect_b32 s47, -9, 1
    s_lshl_b32 s48, s47, 7
    s_add_u32 s54, s54, s48
    s_waitcnt vmcnt(8) lgkmcnt(0)
    s_barrier
    s_add_u32 m0, s56, 16384
    s_add_u32 s46, s46, 1
    buffer_load_dwordx4 v8, s[24:27], s54 offen offset:0 lds
    buffer_load_dwordx4 v9, s[24:27], s54 offen offset:1024 lds
    buffer_load_dwordx4 v10, s[24:27], s54 offen offset:2048 lds
    buffer_load_dwordx4 v11, s[24:27], s54 offen offset:3072 lds
    s_cmp_eq_u32 s46, 10
    s_cselect_b32 s47, -9, 1
    s_lshl_b32 s48, s47, 7
    s_add_u32 s54, s54, s48
    s_lshr_b32 s49, s2, 3
    s_sub_u32 s49, s49, 20
    s_min_u32 s49, s49, 10
    s_cmp_gt_u32 s49, 5
    s_cselect_b32 s48, 62, 0
    s_lshl_b32 s49, s49, 6
    s_sub_u32 s49, s49, s48
    s_lshl_b32 s47, s41, 12
    s_add_u32 m0, s47, 114688
    v_lshrrev_b32 v4, 2, v1
    s_and_b32 s47, s2, 7
    s_lshl_b32 s47, s47, 1
    s_add_u32 s47, s47, 0
    s_lshl_b32 s48, s41, 9
    s_add_u32 s47, s47, s48
    v_lshl_add_u32 v3, v4, 5, s47
    v_and_b32 v3, 2047, v3
    v_mul_u32_u24 v3, 642, v3
    v_and_b32 v5, 48, v2
    v_add_u32 v3, v3, v5
    buffer_load_dwordx4 v3, s[28:31], s49 offen lds
    s_add_u32 m0, m0, 1024
    s_nop 0
    buffer_load_dwordx4 v3, s[32:35], s49 offen lds
    s_waitcnt vmcnt(10) lgkmcnt(0)
    s_barrier
    s_lshr_b32 s49, s2, 3
    s_sub_u32 s49, s49, 20
    s_min_u32 s49, s49, 10
    s_cmp_gt_u32 s49, 5
    s_cselect_b32 s48, 62, 0
    s_lshl_b32 s49, s49, 6
    s_sub_u32 s49, s49, s48
    s_lshl_b32 s47, s41, 12
    s_add_u32 m0, s47, 116736
    v_lshrrev_b32 v4, 2, v1
    s_and_b32 s47, s2, 7
    s_lshl_b32 s47, s47, 1
    s_add_u32 s47, s47, 0
    s_sub_u32 s48, 0, s47
    s_cmp_eq_u32 s47, 0
    s_cselect_b32 s47, 16, s48
    s_lshl_b32 s48, s41, 9
    s_add_u32 s47, s47, s48
    v_lshl_add_u32 v3, v4, 5, s47
    v_and_b32 v3, 2047, v3
    v_mul_u32_u24 v3, 642, v3
    v_and_b32 v5, 48, v2
    v_add_u32 v3, v3, v5
    buffer_load_dwordx4 v3, s[28:31], s49 offen lds
    s_add_u32 m0, m0, 1024
    s_nop 0
    buffer_load_dwordx4 v3, s[32:35], s49 offen lds
    s_waitcnt vmcnt(8) lgkmcnt(0)
    s_barrier
    s_lshr_b32 s49, s2, 3
    s_sub_u32 s49, s49, 20
    s_min_u32 s49, s49, 10
    s_cmp_gt_u32 s49, 5
    s_cselect_b32 s48, 62, 0
    s_lshl_b32 s49, s49, 6
    s_sub_u32 s49, s49, s48
    s_lshl_b32 s47, s41, 12
    s_add_u32 m0, s47, 131072
    v_lshrrev_b32 v4, 2, v1
    s_and_b32 s47, s2, 7
    s_lshl_b32 s47, s47, 1
    s_add_u32 s47, s47, 1
    s_lshl_b32 s48, s41, 9
    s_add_u32 s47, s47, s48
    v_lshl_add_u32 v3, v4, 5, s47
    v_and_b32 v3, 2047, v3
    v_mul_u32_u24 v3, 642, v3
    v_and_b32 v5, 48, v2
    v_add_u32 v3, v3, v5
    buffer_load_dwordx4 v3, s[28:31], s49 offen lds
    s_add_u32 m0, m0, 1024
    s_nop 0
    buffer_load_dwordx4 v3, s[32:35], s49 offen lds
    s_waitcnt vmcnt(6) lgkmcnt(0)
    s_barrier
    s_lshr_b32 s49, s2, 3
    s_sub_u32 s49, s49, 20
    s_min_u32 s49, s49, 10
    s_cmp_gt_u32 s49, 5
    s_cselect_b32 s48, 62, 0
    s_lshl_b32 s49, s49, 6
    s_sub_u32 s49, s49, s48
    s_lshl_b32 s47, s41, 12
    s_add_u32 m0, s47, 133120
    v_lshrrev_b32 v4, 2, v1
    s_and_b32 s47, s2, 7
    s_lshl_b32 s47, s47, 1
    s_add_u32 s47, s47, 1
    s_sub_u32 s48, 0, s47
    s_cmp_eq_u32 s47, 0
    s_cselect_b32 s47, 16, s48
    s_lshl_b32 s48, s41, 9
    s_add_u32 s47, s47, s48
    v_lshl_add_u32 v3, v4, 5, s47
    v_and_b32 v3, 2047, v3
    v_mul_u32_u24 v3, 642, v3
    v_and_b32 v5, 48, v2
    v_add_u32 v3, v3, v5
    buffer_load_dwordx4 v3, s[28:31], s49 offen lds
    s_add_u32 m0, m0, 1024
    s_nop 0
    buffer_load_dwordx4 v3, s[32:35], s49 offen lds
    s_setprio 0
    s_branch S_t2
S_colsum:
    s_lshl_b32 s54, s43, 1
    s_add_u32 s54, s54, s42
    s_lshl_b32 s47, s54, 1
    s_lshr_b32 s48, s40, 2
    s_add_u32 s47, s47, s48
    s_lshl_b32 s48, s41, 9
    s_add_u32 s47, s47, s48
    s_mul_i32 s47, s47, 1280
    v_lshrrev_b32 v5, 3, v1
    v_mul_u32_u24 v3, 81920, v5
    v_and_b32 v4, 0x70, v2
    v_add_u32 v3, v3, v4
    v_mov_b32 v52, 0x3f803f80
    v_mov_b32 v48, 0
    v_mov_b32 v49, 0
    v_mov_b32 v50, 0
    v_mov_b32 v51, 0
    s_waitcnt lgkmcnt(0)
    s_mov_b32 s24, s4
    s_mov_b32 s25, s5
    s_mov_b32 s26, 2621440
    s_mov_b32 s27, 0x20000
    buffer_load_dwordx4 v[8:11], v3, s[24:27], s47 offen offset:0
    buffer_load_dwordx4 v[12:15], v3, s[24:27], s47 offen offset:128
    buffer_load_dwordx4 v[16:19], v3, s[24:27], s47 offen offset:256
    buffer_load_dwordx4 v[20:23], v3, s[24:27], s47 offen offset:384
    buffer_load_dwordx4 v[24:27], v3, s[24:27], s47 offen offset:512
    buffer_load_dwordx4 v[28:31], v3, s[24:27], s47 offen offset:640
    buffer_load_dwordx4 v[32:35], v3, s[24:27], s47 offen offset:768
    buffer_load_dwordx4 v[36:39], v3, s[24:27], s47 offen offset:896
    buffer_load_dwordx4 v[40:43], v3, s[24:27], s47 offen offset:1024
    buffer_load_dwordx4 v[44:47], v3, s[24:27], s47 offen offset:1152
    s_add_u32 s36, s22, 20578304
    s_addc_u32 s37, s23, 0
    s_mov_b32 s38, 289920
    s_mov_b32 s39, 0x20000
    s_load_dword s45, s[36:37], 289792
    s_add_u32 s28, s22, 20447232
    s_addc_u32 s29, s23, 0
    s_mov_b32 s30, 16384
    s_mov_b32 s31, 0x20000
    s_waitcnt vmcnt(9)
    v_dot2c_f32_bf16 v48, v8, v52
    v_dot2c_f32_bf16 v50, v8, v8
    v_dot2c_f32_bf16 v49, v9, v52
    v_dot2c_f32_bf16 v51, v9, v9
    v_dot2c_f32_bf16 v48, v10, v52
    v_dot2c_f32_bf16 v50, v10, v10
    v_dot2c_f32_bf16 v49, v11, v52
    v_dot2c_f32_bf16 v51, v11, v11
    s_waitcnt vmcnt(8)
    v_dot2c_f32_bf16 v48, v12, v52
    v_dot2c_f32_bf16 v50, v12, v12
    v_dot2c_f32_bf16 v49, v13, v52
    v_dot2c_f32_bf16 v51, v13, v13
    v_dot2c_f32_bf16 v48, v14, v52
    v_dot2c_f32_bf16 v50, v14, v14
    v_dot2c_f32_bf16 v49, v15, v52
    v_dot2c_f32_bf16 v51, v15, v15
    s_waitcnt vmcnt(7)
    v_dot2c_f32_bf16 v48, v16, v52
    v_dot2c_f32_bf16 v50, v16, v16
    v_dot2c_f32_bf16 v49, v17, v52
    v_dot2c_f32_bf16 v51, v17, v17
    v_dot2c_f32_bf16 v48, v18, v52
    v_dot2c_f32_bf16 v50, v18, v18
    v_dot2c_f32_bf16 v49, v19, v52
    v_dot2c_f32_bf16 v51, v19, v19
    s_waitcnt vmcnt(6)
    v_dot2c_f32_bf16 v48, v20, v52
    v_dot2c_f32_bf16 v50, v20, v20
    v_dot2c_f32_bf16 v49, v21, v52
    v_dot2c_f32_bf16 v51, v21, v21
    v_dot2c_f32_bf16 v48, v22, v52
    v_dot2c_f32_bf16 v50, v22, v22
    v_dot2c_f32_bf16 v49, v23, v52
    v_dot2c_f32_bf16 v51, v23, v23
    s_waitcnt vmcnt(5)
    v_dot2c_f32_bf16 v48, v24, v52
    v_dot2c_f32_bf16 v50, v24, v24
    v_dot2c_f32_bf16 v49, v25, v52
    v_dot2c_f32_bf16 v51, v25, v25
    v_dot2c_f32_bf16 v48, v26, v52
    v_dot2c_f32_bf16 v50, v26, v26
    v_dot2c_f32_bf16 v49, v27, v52
    v_dot2c_f32_bf16 v51, v27, v27
    s_waitcnt vmcnt(4)
    v_dot2c_f32_bf16 v48, v28, v52
    v_dot2c_f32_bf16 v50, v28, v28
    v_dot2c_f32_bf16 v49, v29, v52
    v_dot2c_f32_bf16 v51, v29, v29
    v_dot2c_f32_bf16 v48, v30, v52
    v_dot2c_f32_bf16 v50, v30, v30
    v_dot2c_f32_bf16 v49, v31, v52
    v_dot2c_f32_bf16 v51, v31, v31
    s_waitcnt vmcnt(3)
    v_dot2c_f32_bf16 v48, v32, v52
    v_dot2c_f32_bf16 v50, v32, v32
    v_dot2c_f32_bf16 v49, v33, v52
    v_dot2c_f32_bf16 v51, v33, v33
    v_dot2c_f32_bf16 v48, v34, v52
    v_dot2c_f32_bf16 v50, v34, v34
    v_dot2c_f32_bf16 v49, v35, v52
    v_dot2c_f32_bf16 v51, v35, v35
    s_waitcnt vmcnt(2)
    v_dot2c_f32_bf16 v48, v36, v52
    v_dot2c_f32_bf16 v50, v36, v36
    v_dot2c_f32_bf16 v49, v37, v52
    v_dot2c_f32_bf16 v51, v37, v37
    v_dot2c_f32_bf16 v48, v38, v52
    v_dot2c_f32_bf16 v50, v38, v38
    v_dot2c_f32_bf16 v49, v39, v52
    v_dot2c_f32_bf16 v51, v39, v39
    s_waitcnt vmcnt(1)
    v_dot2c_f32_bf16 v48, v40, v52
    v_dot2c_f32_bf16 v50, v40, v40
    v_dot2c_f32_bf16 v49, v41, v52
    v_dot2c_f32_bf16 v51, v41, v41
    v_dot2c_f32_bf16 v48, v42, v52
    v_dot2c_f32_bf16 v50, v42, v42
    v_dot2c_f32_bf16 v49, v43, v52
    v_dot2c_f32_bf16 v51, v43, v43
    s_waitcnt vmcnt(0)
    v_dot2c_f32_bf16 v48, v44, v52
    v_dot2c_f32_bf16 v50, v44, v44
    v_dot2c_f32_bf16 v49, v45, v52
    v_dot2c_f32_bf16 v51, v45, v45
    v_dot2c_f32_bf16 v48, v46, v52
    v_dot2c_f32_bf16 v50, v46, v46
    v_dot2c_f32_bf16 v49, v47, v52
    v_dot2c_f32_bf16 v51, v47, v47
    s_nop 2
    v_add_f32 v48, v48, v49
    v_add_f32 v50, v50, v51
    s_nop 1
    v_add_f32_dpp v48, v48, v48 quad_perm:[1,0,3,2] row_mask:0xf bank_mask:0xf
    v_add_f32_dpp v50, v50, v50 quad_perm:[1,0,3,2] row_mask:0xf bank_mask:0xf
    s_nop 1
    v_add_f32_dpp v48, v48, v48 quad_perm:[2,3,0,1] row_mask:0xf bank_mask:0xf
    v_add_f32_dpp v50, v50, v50 quad_perm:[2,3,0,1] row_mask:0xf bank_mask:0xf
    s_nop 1
    v_add_f32_dpp v48, v48, v48 row_half_mirror row_mask:0xf bank_mask:0xf
    v_add_f32_dpp v50, v50, v50 row_half_mirror row_mask:0xf bank_mask:0xf
    v_mul_f32 v48, 0x3acccccd, v48
    v_mul_f32 v50, 0x3acccccd, v50
    v_fma_f32 v50, -v48, v48, v50
    v_max_f32 v50, 0, v50
    v_cvt_pk_bf16_f32 v3, v48, v50
    v_lshlrev_b32 v49, 16, v3
    v_and_b32 v50, 0xffff0000, v3
    v_add_f32 v50, 0x3727c5ac, v50
    v_cvt_pk_bf16_f32 v3, v50, v50
    v_and_b32 v50, 0xffff0000, v3
    v_sqrt_f32 v50, v50
    s_nop 0
    v_cvt_pk_bf16_f32 v3, v50, v50
    v_and_b32 v51, 0xffff0000, v3
    v_lshrrev_b32 v49, 16, v49
    v_or_b32 v49, v49, v51
    s_lshl_b32 s47, s40, 5
    v_lshl_add_u32 v3, v5, 2, s47
    ds_write_b32 v3, v49
    s_waitcnt lgkmcnt(0)
    s_barrier
    s_cmp_lg_u32 s40, 0
    s_cbranch_scc1 S_stb
    v_lshlrev_b32 v3, 2, v1
    ds_read_b32 v48, v3
    s_add_u32 s48, s45, 2654435769
    v_mov_b32 v49, s48
    v_lshlrev_b32 v3, 3, v1
    s_lshl_b32 s47, s54, 9
    s_waitcnt lgkmcnt(0)
    buffer_store_dwordx2 v[48:49], v3, s[28:31], s47 offen sc1
S_stb:
    s_barrier
    s_lshl_b32 s54, s42, 4
    s_add_u32 s54, s54, s43
    v_lshrrev_b32 v3, 3, v1
    v_mul_u32_u24 v3, 3456, v3
    v_and_b32 v4, 0x70, v2
    v_add_u32 v3, v3, v4
    s_mul_i32 s47, s40, 276480
    s_lshl_b32 s48, s54, 7
    s_add_u32 s47, s47, s48
    s_mov_b32 s24, s12
    s_mov_b32 s25, s13
    s_mov_b32 s26, 2211840
    s_mov_b32 s27, 0x20000
    s_mov_b32 s28, s14
    s_mov_b32 s29, s15
    s_mov_b32 s30, 3456
    s_mov_b32 s31, 0x20000
    s_add_u32 s32, s22, 20512768
    s_addc_u32 s33, s23, 0
    s_mov_b32 s34, 27648
    s_mov_b32 s35, 0x20000
    s_cmp_ge_u32 s54, 27
    s_cbranch_scc1 S_nocs
    buffer_load_dwordx4 v[8:11], v3, s[24:27], s47 offen
    s_add_u32 s47, s47, 27648
    buffer_load_dwordx4 v[12:15], v3, s[24:27], s47 offen
    s_add_u32 s47, s47, 27648
    buffer_load_dwordx4 v[16:19], v3, s[24:27], s47 offen
    s_add_u32 s47, s47, 27648
    buffer_load_dwordx4 v[20:23], v3, s[24:27], s47 offen
    s_add_u32 s47, s47, 27648
    buffer_load_dwordx4 v[24:27], v3, s[24:27], s47 offen
    s_add_u32 s47, s47, 27648
    buffer_load_dwordx4 v[28:31], v3, s[24:27], s47 offen
    s_add_u32 s47, s47, 27648
    buffer_load_dwordx4 v[32:35], v3, s[24:27], s47 offen
    s_add_u32 s47, s47, 27648
    buffer_load_dwordx4 v[36:39], v3, s[24:27], s47 offen
    s_add_u32 s47, s47, 27648
    buffer_load_dwordx4 v[40:43], v3, s[24:27], s47 offen
    s_add_u32 s47, s47, 27648
    buffer_load_dwordx4 v[44:47], v3, s[24:27], s47 offen
    s_add_u32 s47, s47, 27648
    v_lshlrev_b32 v5, 1, v1
    buffer_load_ushort v7, v5, s[28:31], s48 offen
    s_waitcnt vmcnt(10)
    v_lshlrev_b32 v48, 16, v8
    v_and_b32 v49, 0xffff0000, v8
    v_lshlrev_b32 v50, 16, v9
    v_and_b32 v51, 0xffff0000, v9
    v_lshlrev_b32 v52, 16, v10
    v_and_b32 v53, 0xffff0000, v10
    v_lshlrev_b32 v54, 16, v11
    v_and_b32 v55, 0xffff0000, v11
    s_waitcnt vmcnt(9)
    v_lshlrev_b32 v3, 16, v12
    v_and_b32 v4, 0xffff0000, v12
    v_add_f32 v48, v48, v3
    v_add_f32 v49, v49, v4
    v_lshlrev_b32 v3, 16, v13
    v_and_b32 v4, 0xffff0000, v13
    v_add_f32 v50, v50, v3
    v_add_f32 v51, v51, v4
    v_lshlrev_b32 v3, 16, v14
    v_and_b32 v4, 0xffff0000, v14
    v_add_f32 v52, v52, v3
    v_add_f32 v53, v53, v4
    v_lshlrev_b32 v3, 16, v15
    v_and_b32 v4, 0xffff0000, v15
    v_add_f32 v54, v54, v3
    v_add_f32 v55, v55, v4
    s_waitcnt vmcnt(8)
    v_lshlrev_b32 v3, 16, v16
    v_and_b32 v4, 0xffff0000, v16
    v_add_f32 v48, v48, v3
    v_add_f32 v49, v49, v4
    v_lshlrev_b32 v3, 16, v17
    v_and_b32 v4, 0xffff0000, v17
    v_add_f32 v50, v50, v3
    v_add_f32 v51, v51, v4
    v_lshlrev_b32 v3, 16, v18
    v_and_b32 v4, 0xffff0000, v18
    v_add_f32 v52, v52, v3
    v_add_f32 v53, v53, v4
    v_lshlrev_b32 v3, 16, v19
    v_and_b32 v4, 0xffff0000, v19
    v_add_f32 v54, v54, v3
    v_add_f32 v55, v55, v4
    s_waitcnt vmcnt(7)
    v_lshlrev_b32 v3, 16, v20
    v_and_b32 v4, 0xffff0000, v20
    v_add_f32 v48, v48, v3
    v_add_f32 v49, v49, v4
    v_lshlrev_b32 v3, 16, v21
    v_and_b32 v4, 0xffff0000, v21
    v_add_f32 v50, v50, v3
    v_add_f32 v51, v51, v4
    v_lshlrev_b32 v3, 16, v22
    v_and_b32 v4, 0xffff0000, v22
    v_add_f32 v52, v52, v3
    v_add_f32 v53, v53, v4
    v_lshlrev_b32 v3, 16, v23
    v_and_b32 v4, 0xffff0000, v23
    v_add_f32 v54, v54, v3
    v_add_f32 v55, v55, v4
    s_waitcnt vmcnt(6)
    v_lshlrev_b32 v3, 16, v24
    v_and_b32 v4, 0xffff0000, v24
    v_add_f32 v48, v48, v3
    v_add_f32 v49, v49, v4
    v_lshlrev_b32 v3, 16, v25
    v_and_b32 v4, 0xffff0000, v25
    v_add_f32 v50, v50, v3
    v_add_f32 v51, v51, v4
    v_lshlrev_b32 v3, 16, v26
    v_and_b32 v4, 0xffff0000, v26
    v_add_f32 v52, v52, v3
    v_add_f32 v53, v53, v4
    v_lshlrev_b32 v3, 16, v27
    v_and_b32 v4, 0xffff0000, v27
    v_add_f32 v54, v54, v3
    v_add_f32 v55, v55, v4
    s_waitcnt vmcnt(5)
    v_lshlrev_b32 v3, 16, v28
    v_and_b32 v4, 0xffff0000, v28
    v_add_f32 v48, v48, v3
    v_add_f32 v49, v49, v4
    v_lshlrev_b32 v3, 16, v29
    v_and_b32 v4, 0xffff0000, v29
    v_add_f32 v50, v50, v3
    v_add_f32 v51, v51, v4
    v_lshlrev_b32 v3, 16, v30
    v_and_b32 v4, 0xffff0000, v30
    v_add_f32 v52, v52, v3
    v_add_f32 v53, v53, v4
    v_lshlrev_b32 v3, 16, v31
    v_and_b32 v4, 0xffff0000, v31
    v_add_f32 v54, v54, v3
    v_add_f32 v55, v55, v4
    s_waitcnt vmcnt(4)
    v_lshlrev_b32 v3, 16, v32
    v_and_b32 v4, 0xffff0000, v32
    v_add_f32 v48, v48, v3
    v_add_f32 v49, v49, v4
    v_lshlrev_b32 v3, 16, v33
    v_and_b32 v4, 0xffff0000, v33
    v_add_f32 v50, v50, v3
    v_add_f32 v51, v51, v4
    v_lshlrev_b32 v3, 16, v34
    v_and_b32 v4, 0xffff0000, v34
    v_add_f32 v52, v52, v3
    v_add_f32 v53, v53, v4
    v_lshlrev_b32 v3, 16, v35
    v_and_b32 v4, 0xffff0000, v35
    v_add_f32 v54, v54, v3
    v_add_f32 v55, v55, v4
    s_waitcnt vmcnt(3)
    v_lshlrev_b32 v3, 16, v36
    v_and_b32 v4, 0xffff0000, v36
    v_add_f32 v48, v48, v3
    v_add_f32 v49, v49, v4
    v_lshlrev_b32 v3, 16, v37
    v_and_b32 v4, 0xffff0000, v37
    v_add_f32 v50, v50, v3
    v_add_f32 v51, v51, v4
    v_lshlrev_b32 v3, 16, v38
    v_and_b32 v4, 0xffff0000, v38
    v_add_f32 v52, v52, v3
    v_add_f32 v53, v53, v4
    v_lshlrev_b32 v3, 16, v39
    v_and_b32 v4, 0xffff0000, v39
    v_add_f32 v54, v54, v3
    v_add_f32 v55, v55, v4
    s_waitcnt vmcnt(2)
    v_lshlrev_b32 v3, 16, v40
    v_and_b32 v4, 0xffff0000, v40
    v_add_f32 v48, v48, v3
    v_add_f32 v49, v49, v4
    v_lshlrev_b32 v3, 16, v41
    v_and_b32 v4, 0xffff0000, v41
    v_add_f32 v50, v50, v3
    v_add_f32 v51, v51, v4
    v_lshlrev_b32 v3, 16, v42
    v_and_b32 v4, 0xffff0000, v42
    v_add_f32 v52, v52, v3
    v_add_f32 v53, v53, v4
    v_lshlrev_b32 v3, 16, v43
    v_and_b32 v4, 0xffff0000, v43
    v_add_f32 v54, v54, v3
    v_add_f32 v55, v55, v4
    s_waitcnt vmcnt(1)
    v_lshlrev_b32 v3, 16, v44
    v_and_b32 v4, 0xffff0000, v44
    v_add_f32 v48, v48, v3
    v_add_f32 v49, v49, v4
    v_lshlrev_b32 v3, 16, v45
    v_and_b32 v4, 0xffff0000, v45
    v_add_f32 v50, v50, v3
    v_add_f32 v51, v51, v4
    v_lshlrev_b32 v3, 16, v46
    v_and_b32 v4, 0xffff0000, v46
    v_add_f32 v52, v52, v3
    v_add_f32 v53, v53, v4
    v_lshlrev_b32 v3, 16, v47
    v_and_b32 v4, 0xffff0000, v47
    v_add_f32 v54, v54, v3
    v_add_f32 v55, v55, v4
    s_lshl_b32 s47, s40, 11
    v_lshl_add_u32 v3, v1, 5, s47
    ds_write_b128 v3, v[48:51]
    ds_write_b128 v3, v[52:55] offset:16
    s_waitcnt lgkmcnt(0)
    s_barrier
    s_cmp_lg_u32 s40, 0
    s_cbranch_scc1 S_csb
    v_lshlrev_b32 v3, 2, v1
    ds_read2st64_b32 v[8:9], v3 offset0:0 offset1:1
    ds_read2st64_b32 v[10:11], v3 offset0:2 offset1:3
    ds_read2st64_b32 v[12:13], v3 offset0:4 offset1:5
    ds_read2st64_b32 v[14:15], v3 offset0:6 offset1:7
    ds_read2st64_b32 v[16:17], v3 offset0:8 offset1:9
    ds_read2st64_b32 v[18:19], v3 offset0:10 offset1:11
    ds_read2st64_b32 v[20:21], v3 offset0:12 offset1:13
    ds_read2st64_b32 v[22:23], v3 offset0:14 offset1:15
    s_waitcnt lgkmcnt(0)
    v_mov_b32 v48, v8
    v_mov_b32 v49, v9
    v_add_f32 v48, v10, v48
    v_add_f32 v49, v11, v49
    v_add_f32 v48, v12, v48
    v_add_f32 v49, v13, v49
    v_add_f32 v48, v14, v48
    v_add_f32 v49, v15, v49
    v_add_f32 v48, v16, v48
    v_add_f32 v49, v17, v49
    v_add_f32 v48, v18, v48
    v_add_f32 v49, v19, v49
    v_add_f32 v48, v20, v48
    v_add_f32 v49, v21, v49
    v_add_f32 v48, v22, v48
    v_add_f32 v49, v23, v49
    ds_read2st64_b32 v[8:9], v3 offset0:16 offset1:17
    ds_read2st64_b32 v[10:11], v3 offset0:18 offset1:19
    ds_read2st64_b32 v[12:13], v3 offset0:20 offset1:21
    ds_read2st64_b32 v[14:15], v3 offset0:22 offset1:23
    ds_read2st64_b32 v[16:17], v3 offset0:24 offset1:25
    ds_read2st64_b32 v[18:19], v3 offset0:26 offset1:27
    ds_read2st64_b32 v[20:21], v3 offset0:28 offset1:29
    ds_read2st64_b32 v[22:23], v3 offset0:30 offset1:31
    s_waitcnt lgkmcnt(0)
    v_add_f32 v48, v8, v48
    v_add_f32 v49, v9, v49
    v_add_f32 v48, v10, v48
    v_add_f32 v49, v11, v49
    v_add_f32 v48, v12, v48
    v_add_f32 v49, v13, v49
    v_add_f32 v48, v14, v48
    v_add_f32 v49, v15, v49
    v_add_f32 v48, v16, v48
    v_add_f32 v49, v17, v49
    v_add_f32 v48, v18, v48
    v_add_f32 v49, v19, v49
    v_add_f32 v48, v20, v48
    v_add_f32 v49, v21, v49
    v_add_f32 v48, v22, v48
    v_add_f32 v49, v23, v49
    ds_read2st64_b32 v[8:9], v3 offset0:32 offset1:33
    ds_read2st64_b32 v[10:11], v3 offset0:34 offset1:35
    ds_read2st64_b32 v[12:13], v3 offset0:36 offset1:37
    ds_read2st64_b32 v[14:15], v3 offset0:38 offset1:39
    ds_read2st64_b32 v[16:17], v3 offset0:40 offset1:41
    ds_read2st64_b32 v[18:19], v3 offset0:42 offset1:43
    ds_read2st64_b32 v[20:21], v3 offset0:44 offset1:45
    ds_read2st64_b32 v[22:23], v3 offset0:46 offset1:47
    s_waitcnt lgkmcnt(0)
    v_add_f32 v48, v8, v48
    v_add_f32 v49, v9, v49
    v_add_f32 v48, v10, v48
    v_add_f32 v49, v11, v49
    v_add_f32 v48, v12, v48
    v_add_f32 v49, v13, v49
    v_add_f32 v48, v14, v48
    v_add_f32 v49, v15, v49
    v_add_f32 v48, v16, v48
    v_add_f32 v49, v17, v49
    v_add_f32 v48, v18, v48
    v_add_f32 v49, v19, v49
    v_add_f32 v48, v20, v48
    v_add_f32 v49, v21, v49
    v_add_f32 v48, v22, v48
    v_add_f32 v49, v23, v49
    ds_read2st64_b32 v[8:9], v3 offset0:48 offset1:49
    ds_read2st64_b32 v[10:11], v3 offset0:50 offset1:51
    ds_read2st64_b32 v[12:13], v3 offset0:52 offset1:53
    ds_read2st64_b32 v[14:15], v3 offset0:54 offset1:55
    ds_read2st64_b32 v[16:17], v3 offset0:56 offset1:57
    ds_read2st64_b32 v[18:19], v3 offset0:58 offset1:59
    ds_read2st64_b32 v[20:21], v3 offset0:60 offset1:61
    ds_read2st64_b32 v[22:23], v3 offset0:62 offset1:63
    s_waitcnt lgkmcnt(0)
    v_add_f32 v48, v8, v48
    v_add_f32 v49, v9, v49
    v_add_f32 v48, v10, v48
    v_add_f32 v49, v11, v49
    v_add_f32 v48, v12, v48
    v_add_f32 v49, v13, v49
    v_add_f32 v48, v14, v48
    v_add_f32 v49, v15, v49
    v_add_f32 v48, v16, v48
    v_add_f32 v49, v17, v49
    v_add_f32 v48, v18, v48
    v_add_f32 v49, v19, v49
    v_add_f32 v48, v20, v48
    v_add_f32 v49, v21, v49
    v_add_f32 v48, v22, v48
    v_add_f32 v49, v23, v49
    v_add_f32 v48, v48, v49
    v_cvt_pk_bf16_f32 v3, -v48, -v48
    v_and_b32 v4, 0xffff0000, v3
    v_sub_f32 v4, -v48, v4
    v_cvt_pk_bf16_f32 v52, -v48, v4
    v_mov_b32 v54, 0
    s_add_u32 s48, s45, 2654435769
    v_mov_b32 v55, s48
    s_lshl_b32 s47, s54, 10
    s_waitcnt vmcnt(0)
    v_mov_b32 v53, v7
    buffer_store_dwordx4 v[52:55], v2, s[32:35], s47 offen sc1
S_csb:
S_nocs:
    s_waitcnt vmcnt(0) lgkmcnt(0)
    s_barrier
    s_add_u32 s45, s45, 2654435769
    v_mov_b32 v6, s45
    s_lshl_b32 s47, s2, 7
    s_cmp_lg_u32 s40, 4
    s_cselect_b32 s47, 2130706432, s47
    v_mov_b32 v3, s47
    s_mov_b64 exec, 1
    buffer_store_dword v6, v3, s[36:39], 0 offen sc1
    s_mov_b64 exec, -1
    s_lshr_b32 s47, s40, 2
    s_and_b32 s47, s47, s42
    s_cbranch_scc0 S_nows
    s_mov_b32 s28, s6
    s_mov_b32 s29, s7
    s_mov_b32 s30, 1314816
    s_mov_b32 s31, 0x20000
    s_mov_b32 s32, s8
    s_mov_b32 s33, s9
    s_mov_b32 s34, 1314816
    s_mov_b32 s35, 0x20000
    s_and_b32 s47, s2, 7
    s_lshl_b32 s47, s47, 1
    s_lshr_b32 s48, s41, 1
    s_add_u32 s47, s47, s48
    s_sub_u32 s48, 32, s47
    s_cmp_eq_u32 s47, 0
    s_cselect_b32 s48, 16, s48
    s_bitcmp1_b32 s41, 0
    s_cselect_b32 s47, s48, s47
    s_lshr_b32 s48, s2, 3
    s_sub_u32 s48, s48, 20
    s_mul_i32 s48, s48, 192
    s_add_u32 s47, s47, s48
    s_mul_i32 s47, s47, 642
    v_and_b32 v3, 7, v1
    v_min_u32 v3, 5, v3
    v_lshl_add_u32 v3, v3, 7, s47
    v_lshrrev_b32 v4, 3, v1
    v_min_u32 v4, 5, v4
    v_mul_u32_u24 v4, 20544, v4
    v_add_u32 v3, v3, v4
    buffer_load_ushort v7, v3, s[28:31], 0 offen
    buffer_load_ushort v7, v3, s[32:35], 0 offen
    s_lshr_b32 s49, s2, 3
    s_sub_u32 s49, s49, 20
    s_min_u32 s49, s49, 10
    s_cmp_gt_u32 s49, 5
    s_cselect_b32 s48, 62, 0
    s_lshl_b32 s49, s49, 6
    s_sub_u32 s49, s49, s48
    s_lshl_b32 s47, s41, 12
    s_add_u32 m0, s47, 114688
    v_lshrrev_b32 v4, 2, v1
    s_and_b32 s47, s2, 7
    s_lshl_b32 s47, s47, 1
    s_add_u32 s47, s47, 0
    s_lshl_b32 s48, s41, 9
    s_add_u32 s47, s47, s48
    v_lshl_add_u32 v3, v4, 5, s47
    v_and_b32 v3, 2047, v3
    v_mul_u32_u24 v3, 642, v3
    v_and_b32 v5, 48, v2
    v_add_u32 v3, v3, v5
    buffer_load_dwordx4 v3, s[28:31], s49 offen lds
    s_add_u32 m0, m0, 1024
    s_nop 0
    buffer_load_dwordx4 v3, s[32:35], s49 offen lds
    s_lshr_b32 s49, s2, 3
    s_sub_u32 s49, s49, 20
    s_min_u32 s49, s49, 10
    s_cmp_gt_u32 s49, 5
    s_cselect_b32 s48, 62, 0
    s_lshl_b32 s49, s49, 6
    s_sub_u32 s49, s49, s48
    s_lshl_b32 s47, s41, 12
    s_add_u32 m0, s47, 116736
    v_lshrrev_b32 v4, 2, v1
    s_and_b32 s47, s2, 7
    s_lshl_b32 s47, s47, 1
    s_add_u32 s47, s47, 0
    s_sub_u32 s48, 0, s47
    s_cmp_eq_u32 s47, 0
    s_cselect_b32 s47, 16, s48
    s_lshl_b32 s48, s41, 9
    s_add_u32 s47, s47, s48
    v_lshl_add_u32 v3, v4, 5, s47
    v_and_b32 v3, 2047, v3
    v_mul_u32_u24 v3, 642, v3
    v_and_b32 v5, 48, v2
    v_add_u32 v3, v3, v5
    buffer_load_dwordx4 v3, s[28:31], s49 offen lds
    s_add_u32 m0, m0, 1024
    s_nop 0
    buffer_load_dwordx4 v3, s[32:35], s49 offen lds
    s_lshr_b32 s49, s2, 3
    s_sub_u32 s49, s49, 20
    s_min_u32 s49, s49, 10
    s_cmp_gt_u32 s49, 5
    s_cselect_b32 s48, 62, 0
    s_lshl_b32 s49, s49, 6
    s_sub_u32 s49, s49, s48
    s_lshl_b32 s47, s41, 12
    s_add_u32 m0, s47, 131072
    v_lshrrev_b32 v4, 2, v1
    s_and_b32 s47, s2, 7
    s_lshl_b32 s47, s47, 1
    s_add_u32 s47, s47, 1
    s_lshl_b32 s48, s41, 9
    s_add_u32 s47, s47, s48
    v_lshl_add_u32 v3, v4, 5, s47
    v_and_b32 v3, 2047, v3
    v_mul_u32_u24 v3, 642, v3
    v_and_b32 v5, 48, v2
    v_add_u32 v3, v3, v5
    buffer_load_dwordx4 v3, s[28:31], s49 offen lds
    s_add_u32 m0, m0, 1024
    s_nop 0
    buffer_load_dwordx4 v3, s[32:35], s49 offen lds
    s_lshr_b32 s49, s2, 3
    s_sub_u32 s49, s49, 20
    s_min_u32 s49, s49, 10
    s_cmp_gt_u32 s49, 5
    s_cselect_b32 s48, 62, 0
    s_lshl_b32 s49, s49, 6
    s_sub_u32 s49, s49, s48
    s_lshl_b32 s47, s41, 12
    s_add_u32 m0, s47, 133120
    v_lshrrev_b32 v4, 2, v1
    s_and_b32 s47, s2, 7
    s_lshl_b32 s47, s47, 1
    s_add_u32 s47, s47, 1
    s_sub_u32 s48, 0, s47
    s_cmp_eq_u32 s47, 0
    s_cselect_b32 s47, 16, s48
    s_lshl_b32 s48, s41, 9
    s_add_u32 s47, s47, s48
    v_lshl_add_u32 v3, v4, 5, s47
    v_and_b32 v3, 2047, v3
    v_mul_u32_u24 v3, 642, v3
    v_and_b32 v5, 48, v2
    v_add_u32 v3, v3, v5
    buffer_load_dwordx4 v3, s[28:31], s49 offen lds
    s_add_u32 m0, m0, 1024
    s_nop 0
    buffer_load_dwordx4 v3, s[32:35], s49 offen lds
S_nows:
    s_mov_b32 s24, s16
    s_mov_b32 s25, s17
    s_mov_b32 s26, 2211840
    s_mov_b32 s27, 0x20000
    s_and_b32 s47, s43, 3
    s_mul_i32 s47, s47, 8
    s_add_u32 s47, s47, s40
    s_mul_i32 s47, s47, 7040
    s_mul_i32 s48, s42, 1105920
    s_add_u32 s47, s47, s48
    v_min_u32 v3, 54, v1
    v_lshlrev_b32 v3, 7, v3
    buffer_load_dword v7, v3, s[24:27], s47 offen
    s_add_u32 s47, s47, 225280
    buffer_load_dword v7, v3, s[24:27], s47 offen
    s_add_u32 s47, s47, 225280
    s_mov_b32 s46, 2130706432
    s_cmp_eq_u32 s42, 1
    s_cbranch_scc1 S_t2
    s_mov_b32 s65, 0
    s_cmp_lt_u32 s40, 4
    s_cbranch_scc1 S_csc
    s_call_b64 s[58:59], S_tab0
    s_call_b64 s[58:59], S_tab1
    s_call_b64 s[58:59], S_tab2
    s_call_b64 s[58:59], S_tab3
    s_branch S_load2
S_csc:
    s_mov_b32 s51, 1
    s_branch S_comp1b
S_comp1:
    s_cmp_ge_u32 s44, 5
    s_cbranch_scc1 S_t1
    s_mov_b32 s51, 0
S_comp1b:
    s_and_b32 s54, s40, 1
    s_lshr_b32 s55, s40, 1
    v_and_b32 v8, 15, v1
    v_lshrrev_b32 v9, 4, v1
    s_mul_i32 s47, s54, 6144
    s_add_u32 s47, s47, 24576
    v_add_u32 v10, s47, v2
    v_lshrrev_b32 v3, 2, v1
    v_lshlrev_b32 v3, 7, v3
    v_and_b32 v4, 3, v1
    v_lshl_add_u32 v3, v4, 3, v3
    v_bfe_u32 v4, v1, 3, 2
    v_lshl_add_u32 v3, v4, 5, v3
    s_mul_i32 s47, s55, 12288
    v_add_u32 v12, s47, v3
    v_xor_b32 v13, 32, v12
    v_xor_b32 v14, 64, v12
    v_xor_b32 v15, 96, v12
    s_lshl_b32 s56, s2, 2
    s_add_u32 s56, s56, s40
    s_xor_b32 s57, s56, 4
    s_mul_i32 s56, s56, 5632
    s_mul_i32 s57, s57, 5632
    s_lshl_b32 s47, s43, 2
    s_lshl_b32 s48, s42, 1
    s_add_u32 s47, s47, s48
    s_add_u32 s47, s47, s54
    s_mul_i32 s58, s47, 1280
    s_lshl_b32 s59, s44, 7
    s_mul_i32 s47, s55, 640
    s_add_u32 s59, s59, s47
    s_add_u32 s58, s58, s59
    v_lshrrev_b32 v3, 3, v1
    v_and_b32 v4, 7, v1
    v_xor_b32 v5, v4, v3
    v_mul_u32_u24 v3, 81920, v3
    v_lshl_add_u32 v16, v5, 4, v3
    v_lshrrev_b32 v3, 1, v9
    v_xor_b32 v3, v3, v4
    v_lshlrev_b32 v3, 4, v3
    v_lshl_add_u32 v3, v8, 7, v3
    v_and_b32 v4, 1, v9
    v_lshl_add_u32 v3, v4, 3, v3
    s_lshl_b32 s47, s40, 12
    s_add_u32 s47, s47, 147456
    v_add_u32 v17, s47, v3
    s_mov_b32 s61, 2130706432
    s_cmp_eq_u32 s51, 1
    s_cbranch_scc1 S_comp2a
    s_sub_u32 s47, s44, s42
    s_subb_u32 s47, s55, 0
    s_cselect_b64 s[62:63], 0, -1
    s_max_i32 s47, s47, 0
    s_mul_i32 s47, s47, 49152
    s_xor_b32 s48, s54, s42
    s_mul_i32 s48, s48, 12288
    s_add_u32 s47, s47, s48
    s_add_u32 s47, s47, 24576
    v_add_u32 v18, s47, v2
    v_lshrrev_b32 v3, 1, v8
    v_xor_b32 v3, v3, v9
    v_lshlrev_b32 v3, 4, v3
    v_lshl_add_u32 v3, v8, 7, v3
    s_lshl_b32 s47, s54, 13
    v_add_u32 v20, s47, v3
    v_xor_b32 v21, 64, v20
    v_lshrrev_b32 v3, 2, v8
    v_lshl_add_u32 v3, v9, 3, v3
    v_lshlrev_b32 v3, 7, v3
    v_and_b32 v4, 3, v1
    v_lshl_add_u32 v3, v4, 3, v3
    v_bfe_u32 v4, v1, 3, 2
    v_lshl_add_u32 v3, v4, 5, v3
    s_mul_i32 s48, s55, 6
    s_add_u32 s47, s48, 0
    s_lshr_b32 s49, s47, 2
    s_lshl_b32 s49, s49, 13
    s_and_b32 s47, s47, 3
    s_lshl_b32 s47, s47, 5
    s_add_u32 s47, s47, s49
    s_add_u32 s47, s47, 16384
    v_xor_b32 v22, s47, v3
    s_add_u32 s47, s48, 1
    s_lshr_b32 s49, s47, 2
    s_lshl_b32 s49, s49, 13
    s_and_b32 s47, s47, 3
    s_lshl_b32 s47, s47, 5
    s_add_u32 s47, s47, s49
    s_add_u32 s47, s47, 16384
    v_xor_b32 v23, s47, v3
    s_add_u32 s47, s48, 2
    s_lshr_b32 s49, s47, 2
    s_lshl_b32 s49, s49, 13
    s_and_b32 s47, s47, 3
    s_lshl_b32 s47, s47, 5
    s_add_u32 s47, s47, s49
    s_add_u32 s47, s47, 16384
    v_xor_b32 v24, s47, v3
    s_add_u32 s47, s48, 3
    s_lshr_b32 s49, s47, 2
    s_lshl_b32 s49, s49, 13
    s_and_b32 s47, s47, 3
    s_lshl_b32 s47, s47, 5
    s_add_u32 s47, s47, s49
    s_add_u32 s47, s47, 16384
    v_xor_b32 v25, s47, v3
    s_add_u32 s47, s48, 4
    s_lshr_b32 s49, s47, 2
    s_lshl_b32 s49, s49, 13
    s_and_b32 s47, s47, 3
    s_lshl_b32 s47, s47, 5
    s_add_u32 s47, s47, s49
    s_add_u32 s47, s47, 16384
    v_xor_b32 v26, s47, v3
    s_add_u32 s47, s48, 5
    s_lshr_b32 s49, s47, 2
    s_lshl_b32 s49, s49, 13
    s_and_b32 s47, s47, 3
    s_lshl_b32 s47, s47, 5
    s_add_u32 s47, s47, s49
    s_add_u32 s47, s47, 16384
    v_xor_b32 v27, s47, v3
    s_lshl_b32 s47, s42, 2
    s_add_u32 s47, s47, s44
    s_lshl_b32 s47, s47, 1
    s_add_u32 s47, s47, s55
    s_lshl_b32 s61, s47, 1
    s_add_u32 s61, s61, s54
    s_mul_i32 s48, s43, 36
    s_add_u32 s61, s61, s48
    s_add_u32 s61, s61, 256
    s_lshl_b32 s61, s61, 7
    s_mul_i32 s49, s47, 1536
    v_lshl_add_u32 v252, v8, 4, s49
    s_lshl_b32 s48, s43, 1
    s_add_u32 s48, s48, s54
    s_mul_i32 s60, s48, 108
    s_mul_i32 s47, s47, 3
    s_add_u32 s60, s60, s47
    s_lshl_b32 s60, s60, 11
    s_lshl_b32 s48, s48, 9
    v_lshl_add_u32 v5, v8, 3, s48
    v_mov_b32 v238, 0
    v_mov_b32 v239, 0
    v_mov_b32 v242, 0
    v_mov_b32 v243, 0
    s_waitcnt lgkmcnt(0)
    s_add_u32 s36, s22, 20578304
    s_addc_u32 s37, s23, 0
    s_mov_b32 s38, 289920
    s_mov_b32 s39, 0x20000
    s_load_dword s45, s[36:37], 289792
    s_add_u32 s24, s22, 0
    s_addc_u32 s25, s23, 0
    s_mov_b32 s26, 7077888
    s_mov_b32 s27, 0x20000
    s_add_u32 s28, s22, 20447232
    s_addc_u32 s29, s23, 0
    s_mov_b32 s30, 16384
    s_mov_b32 s31, 0x20000
    s_add_u32 s32, s22, 20512768
    s_addc_u32 s33, s23, 0
    s_mov_b32 s34, 27648
    s_mov_b32 s35, 0x20000
    v_cmp_eq_u32 s[52:53], 0, v9
    s_mov_b32 s47, 0x01000100
    s_mov_b32 s50, 0
    .p2align 3
    s_waitcnt lgkmcnt(0)
    s_barrier
    ds_read_b128 v[124:127], v20 offset:0
    ds_read_b128 v[128:131], v20 offset:2048
    ds_read_b128 v[132:135], v20 offset:4096
    ds_read_b128 v[136:139], v20 offset:6144
    ds_read_b64_tr_b16 v[156:157], v22 offset:0
    ds_read_b64_tr_b16 v[158:159], v22 offset:512
    ds_read_b64_tr_b16 v[160:161], v23 offset:0
    ds_read_b64_tr_b16 v[162:163], v23 offset:512
    ds_read_b64_tr_b16 v[164:165], v24 offset:0
    ds_read_b64_tr_b16 v[166:167], v24 offset:512
    ds_read_b64_tr_b16 v[168:169], v25 offset:0
    ds_read_b64_tr_b16 v[170:171], v25 offset:512
    ds_read_b64_tr_b16 v[172:173], v26 offset:0
    ds_read_b64_tr_b16 v[174:175], v26 offset:512
    ds_read_b64_tr_b16 v[176:177], v27 offset:0
    ds_read_b64_tr_b16 v[178:179], v27 offset:512
    .p2align 3
    s_waitcnt lgkmcnt(0)
    s_nop 0
    s_add_u32 s45, s45, 2654435769
    v_mov_b32 v6, s45
    v_mfma_f32_16x16x32_bf16 v[28:31], v[156:159], v[124:127], 0
    ds_read_b128 v[140:143], v21 offset:0
    v_mfma_f32_16x16x32_bf16 v[52:55], v[156:159], v[128:131], 0
    ds_read_b128 v[144:147], v21 offset:2048
    v_mfma_f32_16x16x32_bf16 v[76:79], v[156:159], v[132:135], 0
    ds_read_b128 v[148:151], v21 offset:4096
    v_mfma_f32_16x16x32_bf16 v[100:103], v[156:159], v[136:139], 0
    ds_read_b128 v[152:155], v21 offset:6144
    v_mfma_f32_16x16x32_bf16 v[32:35], v[160:163], v[124:127], 0
    ds_read_b64_tr_b16 v[180:181], v22 offset:4096
    v_mfma_f32_16x16x32_bf16 v[56:59], v[160:163], v[128:131], 0
    ds_read_b64_tr_b16 v[182:183], v22 offset:4608
    v_mfma_f32_16x16x32_bf16 v[80:83], v[160:163], v[132:135], 0
    ds_read_b64_tr_b16 v[184:185], v23 offset:4096
    v_mfma_f32_16x16x32_bf16 v[104:107], v[160:163], v[136:139], 0
    ds_read_b64_tr_b16 v[186:187], v23 offset:4608
    v_mfma_f32_16x16x32_bf16 v[36:39], v[164:167], v[124:127], 0
    ds_read_b64_tr_b16 v[188:189], v24 offset:4096
    v_mfma_f32_16x16x32_bf16 v[60:63], v[164:167], v[128:131], 0
    ds_read_b64_tr_b16 v[190:191], v24 offset:4608
    v_mfma_f32_16x16x32_bf16 v[84:87], v[164:167], v[132:135], 0
    ds_read_b64_tr_b16 v[192:193], v25 offset:4096
    v_mfma_f32_16x16x32_bf16 v[108:111], v[164:167], v[136:139], 0
    ds_read_b64_tr_b16 v[194:195], v25 offset:4608
    v_mfma_f32_16x16x32_bf16 v[40:43], v[168:171], v[124:127], 0
    ds_read_b64_tr_b16 v[196:197], v26 offset:4096
    v_mfma_f32_16x16x32_bf16 v[64:67], v[168:171], v[128:131], 0
    ds_read_b64_tr_b16 v[198:199], v26 offset:4608
    v_mfma_f32_16x16x32_bf16 v[88:91], v[168:171], v[132:135], 0
    ds_read_b64_tr_b16 v[200:201], v27 offset:4096
    v_mfma_f32_16x16x32_bf16 v[112:115], v[168:171], v[136:139], 0
    ds_read_b64_tr_b16 v[202:203], v27 offset:4608
    v_mfma_f32_16x16x32_bf16 v[44:47], v[172:175], v[124:127], 0
    v_add_u32 v20, 40960, v20
    v_mfma_f32_16x16x32_bf16 v[68:71], v[172:175], v[128:131], 0
    v_add_u32 v21, 40960, v21
    v_mfma_f32_16x16x32_bf16 v[92:95], v[172:175], v[132:135], 0
    v_add_u32 v22, 40960, v22
    v_mfma_f32_16x16x32_bf16 v[116:119], v[172:175], v[136:139], 0
    v_add_u32 v23, 40960, v23
    v_mfma_f32_16x16x32_bf16 v[48:51], v[176:179], v[124:127], 0
    v_add_u32 v24, 40960, v24
    v_mfma_f32_16x16x32_bf16 v[72:75], v[176:179], v[128:131], 0
    v_add_u32 v25, 40960, v25
    v_mfma_f32_16x16x32_bf16 v[96:99], v[176:179], v[132:135], 0
    v_add_u32 v26, 40960, v26
    v_mfma_f32_16x16x32_bf16 v[120:123], v[176:179], v[136:139], 0
    v_add_u32 v27, 40960, v27
    s_waitcnt lgkmcnt(0)
    s_nop 0
    v_mfma_f32_16x16x32_bf16 v[28:31], v[180:183], v[140:143], v[28:31]
    v_mfma_f32_16x16x32_bf16 v[52:55], v[180:183], v[144:147], v[52:55]
    v_mfma_f32_16x16x32_bf16 v[76:79], v[180:183], v[148:151], v[76:79]
    v_mfma_f32_16x16x32_bf16 v[100:103], v[180:183], v[152:155], v[100:103]
    v_mfma_f32_16x16x32_bf16 v[32:35], v[184:187], v[140:143], v[32:35]
    v_mfma_f32_16x16x32_bf16 v[56:59], v[184:187], v[144:147], v[56:59]
    v_mfma_f32_16x16x32_bf16 v[80:83], v[184:187], v[148:151], v[80:83]
    v_mfma_f32_16x16x32_bf16 v[104:107], v[184:187], v[152:155], v[104:107]
    v_mfma_f32_16x16x32_bf16 v[36:39], v[188:191], v[140:143], v[36:39]
    v_mfma_f32_16x16x32_bf16 v[60:63], v[188:191], v[144:147], v[60:63]
    v_mfma_f32_16x16x32_bf16 v[84:87], v[188:191], v[148:151], v[84:87]
    v_mfma_f32_16x16x32_bf16 v[108:111], v[188:191], v[152:155], v[108:111]
    v_mfma_f32_16x16x32_bf16 v[40:43], v[192:195], v[140:143], v[40:43]
    v_mfma_f32_16x16x32_bf16 v[64:67], v[192:195], v[144:147], v[64:67]
    v_mfma_f32_16x16x32_bf16 v[88:91], v[192:195], v[148:151], v[88:91]
    v_mfma_f32_16x16x32_bf16 v[112:115], v[192:195], v[152:155], v[112:115]
    v_mfma_f32_16x16x32_bf16 v[44:47], v[196:199], v[140:143], v[44:47]
    v_mfma_f32_16x16x32_bf16 v[68:71], v[196:199], v[144:147], v[68:71]
    v_mfma_f32_16x16x32_bf16 v[92:95], v[196:199], v[148:151], v[92:95]
    v_mfma_f32_16x16x32_bf16 v[116:119], v[196:199], v[152:155], v[116:119]
    v_mfma_f32_16x16x32_bf16 v[48:51], v[200:203], v[140:143], v[48:51]
    v_mfma_f32_16x16x32_bf16 v[72:75], v[200:203], v[144:147], v[72:75]
    v_mfma_f32_16x16x32_bf16 v[96:99], v[200:203], v[148:151], v[96:99]
    v_mfma_f32_16x16x32_bf16 v[120:123], v[200:203], v[152:155], v[120:123]
    .p2align 3
    s_waitcnt lgkmcnt(0)
    s_barrier
    ds_read_b128 v[124:127], v20 offset:0
    ds_read_b128 v[128:131], v20 offset:2048
    ds_read_b128 v[132:135], v20 offset:4096
    ds_read_b128 v[136:139], v20 offset:6144
    ds_read_b64_tr_b16 v[156:157], v22 offset:0
    ds_read_b64_tr_b16 v[158:159], v22 offset:512
    ds_read_b64_tr_b16 v[160:161], v23 offset:0
    ds_read_b64_tr_b16 v[162:163], v23 offset:512
    ds_read_b64_tr_b16 v[164:165], v24 offset:0
    ds_read_b64_tr_b16 v[166:167], v24 offset:512
    ds_read_b64_tr_b16 v[168:169], v25 offset:0
    ds_read_b64_tr_b16 v[170:171], v25 offset:512
    ds_read_b64_tr_b16 v[172:173], v26 offset:0
    ds_read_b64_tr_b16 v[174:175], v26 offset:512
    ds_read_b64_tr_b16 v[176:177], v27 offset:0
    ds_read_b64_tr_b16 v[178:179], v27 offset:512
    .p2align 3
    s_waitcnt lgkmcnt(0)
    s_nop 0
    v_mfma_f32_16x16x32_bf16 v[28:31], v[156:159], v[124:127], v[28:31]
    ds_read_b128 v[140:143], v21 offset:0
    v_mfma_f32_16x16x32_bf16 v[52:55], v[156:159], v[128:131], v[52:55]
    ds_read_b128 v[144:147], v21 offset:2048
    v_mfma_f32_16x16x32_bf16 v[76:79], v[156:159], v[132:135], v[76:79]
    ds_read_b128 v[148:151], v21 offset:4096
    v_mfma_f32_16x16x32_bf16 v[100:103], v[156:159], v[136:139], v[100:103]
    ds_read_b128 v[152:155], v21 offset:6144
    v_mfma_f32_16x16x32_bf16 v[32:35], v[160:163], v[124:127], v[32:35]
    ds_read_b64_tr_b16 v[180:181], v22 offset:4096
    v_mfma_f32_16x16x32_bf16 v[56:59], v[160:163], v[128:131], v[56:59]
    ds_read_b64_tr_b16 v[182:183], v22 offset:4608
    v_mfma_f32_16x16x32_bf16 v[80:83], v[160:163], v[132:135], v[80:83]
    ds_read_b64_tr_b16 v[184:185], v23 offset:4096
    v_mfma_f32_16x16x32_bf16 v[104:107], v[160:163], v[136:139], v[104:107]
    ds_read_b64_tr_b16 v[186:187], v23 offset:4608
    v_mfma_f32_16x16x32_bf16 v[36:39], v[164:167], v[124:127], v[36:39]
    ds_read_b64_tr_b16 v[188:189], v24 offset:4096
    v_mfma_f32_16x16x32_bf16 v[60:63], v[164:167], v[128:131], v[60:63]
    ds_read_b64_tr_b16 v[190:191], v24 offset:4608
    v_mfma_f32_16x16x32_bf16 v[84:87], v[164:167], v[132:135], v[84:87]
    ds_read_b64_tr_b16 v[192:193], v25 offset:4096
    v_mfma_f32_16x16x32_bf16 v[108:111], v[164:167], v[136:139], v[108:111]
    ds_read_b64_tr_b16 v[194:195], v25 offset:4608
    v_mfma_f32_16x16x32_bf16 v[40:43], v[168:171], v[124:127], v[40:43]
    ds_read_b64_tr_b16 v[196:197], v26 offset:4096
    v_mfma_f32_16x16x32_bf16 v[64:67], v[168:171], v[128:131], v[64:67]
    ds_read_b64_tr_b16 v[198:199], v26 offset:4608
    v_mfma_f32_16x16x32_bf16 v[88:91], v[168:171], v[132:135], v[88:91]
    ds_read_b64_tr_b16 v[200:201], v27 offset:4096
    v_mfma_f32_16x16x32_bf16 v[112:115], v[168:171], v[136:139], v[112:115]
    ds_read_b64_tr_b16 v[202:203], v27 offset:4608
    v_mfma_f32_16x16x32_bf16 v[44:47], v[172:175], v[124:127], v[44:47]
    v_add_u32 v20, 40960, v20
    v_mfma_f32_16x16x32_bf16 v[68:71], v[172:175], v[128:131], v[68:71]
    v_add_u32 v21, 40960, v21
    v_mfma_f32_16x16x32_bf16 v[92:95], v[172:175], v[132:135], v[92:95]
    v_add_u32 v22, 40960, v22
    v_mfma_f32_16x16x32_bf16 v[116:119], v[172:175], v[136:139], v[116:119]
    v_add_u32 v23, 40960, v23
    v_mfma_f32_16x16x32_bf16 v[48:51], v[176:179], v[124:127], v[48:51]
    v_add_u32 v24, 40960, v24
    v_mfma_f32_16x16x32_bf16 v[72:75], v[176:179], v[128:131], v[72:75]
    v_add_u32 v25, 40960, v25
    v_mfma_f32_16x16x32_bf16 v[96:99], v[176:179], v[132:135], v[96:99]
    v_add_u32 v26, 40960, v26
    v_mfma_f32_16x16x32_bf16 v[120:123], v[176:179], v[136:139], v[120:123]
    v_add_u32 v27, 40960, v27
    s_waitcnt lgkmcnt(0)
    s_nop 0
    v_mfma_f32_16x16x32_bf16 v[28:31], v[180:183], v[140:143], v[28:31]
    v_mfma_f32_16x16x32_bf16 v[52:55], v[180:183], v[144:147], v[52:55]
    v_mfma_f32_16x16x32_bf16 v[76:79], v[180:183], v[148:151], v[76:79]
    v_mfma_f32_16x16x32_bf16 v[100:103], v[180:183], v[152:155], v[100:103]
    v_mfma_f32_16x16x32_bf16 v[32:35], v[184:187], v[140:143], v[32:35]
    v_mfma_f32_16x16x32_bf16 v[56:59], v[184:187], v[144:147], v[56:59]
    v_mfma_f32_16x16x32_bf16 v[80:83], v[184:187], v[148:151], v[80:83]
    v_mfma_f32_16x16x32_bf16 v[104:107], v[184:187], v[152:155], v[104:107]
    v_mfma_f32_16x16x32_bf16 v[36:39], v[188:191], v[140:143], v[36:39]
    v_mfma_f32_16x16x32_bf16 v[60:63], v[188:191], v[144:147], v[60:63]
    v_mfma_f32_16x16x32_bf16 v[84:87], v[188:191], v[148:151], v[84:87]
    v_mfma_f32_16x16x32_bf16 v[108:111], v[188:191], v[152:155], v[108:111]
    v_mfma_f32_16x16x32_bf16 v[40:43], v[192:195], v[140:143], v[40:43]
    v_mfma_f32_16x16x32_bf16 v[64:67], v[192:195], v[144:147], v[64:67]
    v_mfma_f32_16x16x32_bf16 v[88:91], v[192:195], v[148:151], v[88:91]
    v_mfma_f32_16x16x32_bf16 v[112:115], v[192:195], v[152:155], v[112:115]
    v_mfma_f32_16x16x32_bf16 v[44:47], v[196:199], v[140:143], v[44:47]
    v_mfma_f32_16x16x32_bf16 v[68:71], v[196:199], v[144:147], v[68:71]
    v_mfma_f32_16x16x32_bf16 v[92:95], v[196:199], v[148:151], v[92:95]
    v_mfma_f32_16x16x32_bf16 v[116:119], v[196:199], v[152:155], v[116:119]
    v_mfma_f32_16x16x32_bf16 v[48:51], v[200:203], v[140:143], v[48:51]
    v_mfma_f32_16x16x32_bf16 v[72:75], v[200:203], v[144:147], v[72:75]
    v_mfma_f32_16x16x32_bf16 v[96:99], v[200:203], v[148:151], v[96:99]
    v_mfma_f32_16x16x32_bf16 v[120:123], v[200:203], v[152:155], v[120:123]
    .p2align 3
    s_waitcnt lgkmcnt(0)
    s_barrier
    ds_read_b128 v[124:127], v20 offset:0
    ds_read_b128 v[128:131], v20 offset:2048
    ds_read_b128 v[132:135], v20 offset:4096
    ds_read_b128 v[136:139], v20 offset:6144
    ds_read_b64_tr_b16 v[156:157], v22 offset:0
    ds_read_b64_tr_b16 v[158:159], v22 offset:512
    ds_read_b64_tr_b16 v[160:161], v23 offset:0
    ds_read_b64_tr_b16 v[162:163], v23 offset:512
    ds_read_b64_tr_b16 v[164:165], v24 offset:0
    ds_read_b64_tr_b16 v[166:167], v24 offset:512
    ds_read_b64_tr_b16 v[168:169], v25 offset:0
    ds_read_b64_tr_b16 v[170:171], v25 offset:512
    ds_read_b64_tr_b16 v[172:173], v26 offset:0
    ds_read_b64_tr_b16 v[174:175], v26 offset:512
    ds_read_b64_tr_b16 v[176:177], v27 offset:0
    ds_read_b64_tr_b16 v[178:179], v27 offset:512
    .p2align 3
    s_waitcnt lgkmcnt(0)
    s_nop 0
    v_mfma_f32_16x16x32_bf16 v[28:31], v[156:159], v[124:127], v[28:31]
    ds_read_b128 v[140:143], v21 offset:0
    v_mfma_f32_16x16x32_bf16 v[52:55], v[156:159], v[128:131], v[52:55]
    ds_read_b128 v[144:147], v21 offset:2048
    v_mfma_f32_16x16x32_bf16 v[76:79], v[156:159], v[132:135], v[76:79]
    ds_read_b128 v[148:151], v21 offset:4096
    v_mfma_f32_16x16x32_bf16 v[100:103], v[156:159], v[136:139], v[100:103]
    ds_read_b128 v[152:155], v21 offset:6144
    v_mfma_f32_16x16x32_bf16 v[32:35], v[160:163], v[124:127], v[32:35]
    ds_read_b64_tr_b16 v[180:181], v22 offset:4096
    v_mfma_f32_16x16x32_bf16 v[56:59], v[160:163], v[128:131], v[56:59]
    ds_read_b64_tr_b16 v[182:183], v22 offset:4608
    v_mfma_f32_16x16x32_bf16 v[80:83], v[160:163], v[132:135], v[80:83]
    ds_read_b64_tr_b16 v[184:185], v23 offset:4096
    v_mfma_f32_16x16x32_bf16 v[104:107], v[160:163], v[136:139], v[104:107]
    ds_read_b64_tr_b16 v[186:187], v23 offset:4608
    v_mfma_f32_16x16x32_bf16 v[36:39], v[164:167], v[124:127], v[36:39]
    ds_read_b64_tr_b16 v[188:189], v24 offset:4096
    v_mfma_f32_16x16x32_bf16 v[60:63], v[164:167], v[128:131], v[60:63]
    ds_read_b64_tr_b16 v[190:191], v24 offset:4608
    v_mfma_f32_16x16x32_bf16 v[84:87], v[164:167], v[132:135], v[84:87]
    ds_read_b64_tr_b16 v[192:193], v25 offset:4096
    v_mfma_f32_16x16x32_bf16 v[108:111], v[164:167], v[136:139], v[108:111]
    ds_read_b64_tr_b16 v[194:195], v25 offset:4608
    v_mfma_f32_16x16x32_bf16 v[40:43], v[168:171], v[124:127], v[40:43]
    ds_read_b64_tr_b16 v[196:197], v26 offset:4096
    v_mfma_f32_16x16x32_bf16 v[64:67], v[168:171], v[128:131], v[64:67]
    ds_read_b64_tr_b16 v[198:199], v26 offset:4608
    v_mfma_f32_16x16x32_bf16 v[88:91], v[168:171], v[132:135], v[88:91]
    ds_read_b64_tr_b16 v[200:201], v27 offset:4096
    v_mfma_f32_16x16x32_bf16 v[112:115], v[168:171], v[136:139], v[112:115]
    ds_read_b64_tr_b16 v[202:203], v27 offset:4608
    v_mfma_f32_16x16x32_bf16 v[44:47], v[172:175], v[124:127], v[44:47]
    v_add_u32 v20, 4294885376, v20
    v_mfma_f32_16x16x32_bf16 v[68:71], v[172:175], v[128:131], v[68:71]
    v_add_u32 v21, 4294885376, v21
    v_mfma_f32_16x16x32_bf16 v[92:95], v[172:175], v[132:135], v[92:95]
    v_add_u32 v22, 4294885376, v22
    v_mfma_f32_16x16x32_bf16 v[116:119], v[172:175], v[136:139], v[116:119]
    v_add_u32 v23, 4294885376, v23
    v_mfma_f32_16x16x32_bf16 v[48:51], v[176:179], v[124:127], v[48:51]
    v_add_u32 v24, 4294885376, v24
    v_mfma_f32_16x16x32_bf16 v[72:75], v[176:179], v[128:131], v[72:75]
    v_add_u32 v25, 4294885376, v25
    v_mfma_f32_16x16x32_bf16 v[96:99], v[176:179], v[132:135], v[96:99]
    v_add_u32 v26, 4294885376, v26
    v_mfma_f32_16x16x32_bf16 v[120:123], v[176:179], v[136:139], v[120:123]
    v_add_u32 v27, 4294885376, v27
    s_waitcnt lgkmcnt(0)
    s_nop 0
    v_mfma_f32_16x16x32_bf16 v[28:31], v[180:183], v[140:143], v[28:31]
    v_mfma_f32_16x16x32_bf16 v[52:55], v[180:183], v[144:147], v[52:55]
    v_mfma_f32_16x16x32_bf16 v[76:79], v[180:183], v[148:151], v[76:79]
    v_mfma_f32_16x16x32_bf16 v[100:103], v[180:183], v[152:155], v[100:103]
    v_mfma_f32_16x16x32_bf16 v[32:35], v[184:187], v[140:143], v[32:35]
    v_mfma_f32_16x16x32_bf16 v[56:59], v[184:187], v[144:147], v[56:59]
    v_mfma_f32_16x16x32_bf16 v[80:83], v[184:187], v[148:151], v[80:83]
    v_mfma_f32_16x16x32_bf16 v[104:107], v[184:187], v[152:155], v[104:107]
    v_mfma_f32_16x16x32_bf16 v[36:39], v[188:191], v[140:143], v[36:39]
    v_mfma_f32_16x16x32_bf16 v[60:63], v[188:191], v[144:147], v[60:63]
    v_mfma_f32_16x16x32_bf16 v[84:87], v[188:191], v[148:151], v[84:87]
    v_mfma_f32_16x16x32_bf16 v[108:111], v[188:191], v[152:155], v[108:111]
    v_mfma_f32_16x16x32_bf16 v[40:43], v[192:195], v[140:143], v[40:43]
    v_mfma_f32_16x16x32_bf16 v[64:67], v[192:195], v[144:147], v[64:67]
    v_mfma_f32_16x16x32_bf16 v[88:91], v[192:195], v[148:151], v[88:91]
    v_mfma_f32_16x16x32_bf16 v[112:115], v[192:195], v[152:155], v[112:115]
    v_mfma_f32_16x16x32_bf16 v[44:47], v[196:199], v[140:143], v[44:47]
    v_mfma_f32_16x16x32_bf16 v[68:71], v[196:199], v[144:147], v[68:71]
    v_mfma_f32_16x16x32_bf16 v[92:95], v[196:199], v[148:151], v[92:95]
    v_mfma_f32_16x16x32_bf16 v[116:119], v[196:199], v[152:155], v[116:119]
    v_mfma_f32_16x16x32_bf16 v[48:51], v[200:203], v[140:143], v[48:51]
    v_mfma_f32_16x16x32_bf16 v[72:75], v[200:203], v[144:147], v[72:75]
    v_mfma_f32_16x16x32_bf16 v[96:99], v[200:203], v[148:151], v[96:99]
    v_mfma_f32_16x16x32_bf16 v[120:123], v[200:203], v[152:155], v[120:123]
    .p2align 3
    s_waitcnt lgkmcnt(0)
    s_barrier
    ds_read_b128 v[124:127], v20 offset:0
    ds_read_b128 v[128:131], v20 offset:2048
    ds_read_b128 v[132:135], v20 offset:4096
    ds_read_b128 v[136:139], v20 offset:6144
    ds_read_b64_tr_b16 v[156:157], v22 offset:0
    ds_read_b64_tr_b16 v[158:159], v22 offset:512
    ds_read_b64_tr_b16 v[160:161], v23 offset:0
    ds_read_b64_tr_b16 v[162:163], v23 offset:512
    ds_read_b64_tr_b16 v[164:165], v24 offset:0
    ds_read_b64_tr_b16 v[166:167], v24 offset:512
    ds_read_b64_tr_b16 v[168:169], v25 offset:0
    ds_read_b64_tr_b16 v[170:171], v25 offset:512
    ds_read_b64_tr_b16 v[172:173], v26 offset:0
    ds_read_b64_tr_b16 v[174:175], v26 offset:512
    ds_read_b64_tr_b16 v[176:177], v27 offset:0
    ds_read_b64_tr_b16 v[178:179], v27 offset:512
    .p2align 3
    s_waitcnt lgkmcnt(0)
    s_nop 0
    v_mfma_f32_16x16x32_bf16 v[28:31], v[156:159], v[124:127], v[28:31]
    ds_read_b128 v[140:143], v21 offset:0
    v_mfma_f32_16x16x32_bf16 v[52:55], v[156:159], v[128:131], v[52:55]
    ds_read_b128 v[144:147], v21 offset:2048
    v_mfma_f32_16x16x32_bf16 v[76:79], v[156:159], v[132:135], v[76:79]
    ds_read_b128 v[148:151], v21 offset:4096
    v_mfma_f32_16x16x32_bf16 v[100:103], v[156:159], v[136:139], v[100:103]
    ds_read_b128 v[152:155], v21 offset:6144
    v_mfma_f32_16x16x32_bf16 v[32:35], v[160:163], v[124:127], v[32:35]
    ds_read_b64_tr_b16 v[180:181], v22 offset:4096
    v_mfma_f32_16x16x32_bf16 v[56:59], v[160:163], v[128:131], v[56:59]
    ds_read_b64_tr_b16 v[182:183], v22 offset:4608
    v_mfma_f32_16x16x32_bf16 v[80:83], v[160:163], v[132:135], v[80:83]
    ds_read_b64_tr_b16 v[184:185], v23 offset:4096
    v_mfma_f32_16x16x32_bf16 v[104:107], v[160:163], v[136:139], v[104:107]
    ds_read_b64_tr_b16 v[186:187], v23 offset:4608
    v_mfma_f32_16x16x32_bf16 v[36:39], v[164:167], v[124:127], v[36:39]
    ds_read_b64_tr_b16 v[188:189], v24 offset:4096
    v_mfma_f32_16x16x32_bf16 v[60:63], v[164:167], v[128:131], v[60:63]
    ds_read_b64_tr_b16 v[190:191], v24 offset:4608
    v_mfma_f32_16x16x32_bf16 v[84:87], v[164:167], v[132:135], v[84:87]
    ds_read_b64_tr_b16 v[192:193], v25 offset:4096
    v_mfma_f32_16x16x32_bf16 v[108:111], v[164:167], v[136:139], v[108:111]
    ds_read_b64_tr_b16 v[194:195], v25 offset:4608
    v_mfma_f32_16x16x32_bf16 v[40:43], v[168:171], v[124:127], v[40:43]
    ds_read_b64_tr_b16 v[196:197], v26 offset:4096
    v_mfma_f32_16x16x32_bf16 v[64:67], v[168:171], v[128:131], v[64:67]
    ds_read_b64_tr_b16 v[198:199], v26 offset:4608
    v_mfma_f32_16x16x32_bf16 v[88:91], v[168:171], v[132:135], v[88:91]
    ds_read_b64_tr_b16 v[200:201], v27 offset:4096
    v_mfma_f32_16x16x32_bf16 v[112:115], v[168:171], v[136:139], v[112:115]
    ds_read_b64_tr_b16 v[202:203], v27 offset:4608
    v_mfma_f32_16x16x32_bf16 v[44:47], v[172:175], v[124:127], v[44:47]
    v_add_u32 v20, 40960, v20
    v_mfma_f32_16x16x32_bf16 v[68:71], v[172:175], v[128:131], v[68:71]
    v_add_u32 v21, 40960, v21
    v_mfma_f32_16x16x32_bf16 v[92:95], v[172:175], v[132:135], v[92:95]
    v_add_u32 v22, 40960, v22
    v_mfma_f32_16x16x32_bf16 v[116:119], v[172:175], v[136:139], v[116:119]
    v_add_u32 v23, 40960, v23
    v_mfma_f32_16x16x32_bf16 v[48:51], v[176:179], v[124:127], v[48:51]
    v_add_u32 v24, 40960, v24
    v_mfma_f32_16x16x32_bf16 v[72:75], v[176:179], v[128:131], v[72:75]
    v_add_u32 v25, 40960, v25
    v_mfma_f32_16x16x32_bf16 v[96:99], v[176:179], v[132:135], v[96:99]
    v_add_u32 v26, 40960, v26
    v_mfma_f32_16x16x32_bf16 v[120:123], v[176:179], v[136:139], v[120:123]
    v_add_u32 v27, 40960, v27
    s_waitcnt lgkmcnt(0)
    s_nop 0
    v_mfma_f32_16x16x32_bf16 v[28:31], v[180:183], v[140:143], v[28:31]
    v_mfma_f32_16x16x32_bf16 v[52:55], v[180:183], v[144:147], v[52:55]
    v_mfma_f32_16x16x32_bf16 v[76:79], v[180:183], v[148:151], v[76:79]
    v_mfma_f32_16x16x32_bf16 v[100:103], v[180:183], v[152:155], v[100:103]
    v_mfma_f32_16x16x32_bf16 v[32:35], v[184:187], v[140:143], v[32:35]
    v_mfma_f32_16x16x32_bf16 v[56:59], v[184:187], v[144:147], v[56:59]
    v_mfma_f32_16x16x32_bf16 v[80:83], v[184:187], v[148:151], v[80:83]
    v_mfma_f32_16x16x32_bf16 v[104:107], v[184:187], v[152:155], v[104:107]
    v_mfma_f32_16x16x32_bf16 v[36:39], v[188:191], v[140:143], v[36:39]
    v_mfma_f32_16x16x32_bf16 v[60:63], v[188:191], v[144:147], v[60:63]
    v_mfma_f32_16x16x32_bf16 v[84:87], v[188:191], v[148:151], v[84:87]
    v_mfma_f32_16x16x32_bf16 v[108:111], v[188:191], v[152:155], v[108:111]
    v_mfma_f32_16x16x32_bf16 v[40:43], v[192:195], v[140:143], v[40:43]
    v_mfma_f32_16x16x32_bf16 v[64:67], v[192:195], v[144:147], v[64:67]
    v_mfma_f32_16x16x32_bf16 v[88:91], v[192:195], v[148:151], v[88:91]
    v_mfma_f32_16x16x32_bf16 v[112:115], v[192:195], v[152:155], v[112:115]
    v_mfma_f32_16x16x32_bf16 v[44:47], v[196:199], v[140:143], v[44:47]
    v_mfma_f32_16x16x32_bf16 v[68:71], v[196:199], v[144:147], v[68:71]
    v_mfma_f32_16x16x32_bf16 v[92:95], v[196:199], v[148:151], v[92:95]
    v_mfma_f32_16x16x32_bf16 v[116:119], v[196:199], v[152:155], v[116:119]
    v_mfma_f32_16x16x32_bf16 v[48:51], v[200:203], v[140:143], v[48:51]
    v_mfma_f32_16x16x32_bf16 v[72:75], v[200:203], v[144:147], v[72:75]
    v_mfma_f32_16x16x32_bf16 v[96:99], v[200:203], v[148:151], v[96:99]
    v_mfma_f32_16x16x32_bf16 v[120:123], v[200:203], v[152:155], v[120:123]
    .p2align 3
    s_waitcnt lgkmcnt(0)
    s_barrier
    ds_read_b128 v[124:127], v20 offset:0
    ds_read_b128 v[128:131], v20 offset:2048
    ds_read_b128 v[132:135], v20 offset:4096
    ds_read_b128 v[136:139], v20 offset:6144
    ds_read_b64_tr_b16 v[156:157], v22 offset:0
    ds_read_b64_tr_b16 v[158:159], v22 offset:512
    ds_read_b64_tr_b16 v[160:161], v23 offset:0
    ds_read_b64_tr_b16 v[162:163], v23 offset:512
    ds_read_b64_tr_b16 v[164:165], v24 offset:0
    ds_read_b64_tr_b16 v[166:167], v24 offset:512
    ds_read_b64_tr_b16 v[168:169], v25 offset:0
    ds_read_b64_tr_b16 v[170:171], v25 offset:512
    ds_read_b64_tr_b16 v[172:173], v26 offset:0
    ds_read_b64_tr_b16 v[174:175], v26 offset:512
    ds_read_b64_tr_b16 v[176:177], v27 offset:0
    ds_read_b64_tr_b16 v[178:179], v27 offset:512
    .p2align 3
    s_waitcnt lgkmcnt(0)
    s_nop 0
    v_mfma_f32_16x16x32_bf16 v[28:31], v[156:159], v[124:127], v[28:31]
    ds_read_b128 v[140:143], v21 offset:0
    v_mfma_f32_16x16x32_bf16 v[52:55], v[156:159], v[128:131], v[52:55]
    ds_read_b128 v[144:147], v21 offset:2048
    v_mfma_f32_16x16x32_bf16 v[76:79], v[156:159], v[132:135], v[76:79]
    ds_read_b128 v[148:151], v21 offset:4096
    v_mfma_f32_16x16x32_bf16 v[100:103], v[156:159], v[136:139], v[100:103]
    ds_read_b128 v[152:155], v21 offset:6144
    v_mfma_f32_16x16x32_bf16 v[32:35], v[160:163], v[124:127], v[32:35]
    ds_read_b64_tr_b16 v[180:181], v22 offset:4096
    v_mfma_f32_16x16x32_bf16 v[56:59], v[160:163], v[128:131], v[56:59]
    ds_read_b64_tr_b16 v[182:183], v22 offset:4608
    v_mfma_f32_16x16x32_bf16 v[80:83], v[160:163], v[132:135], v[80:83]
    ds_read_b64_tr_b16 v[184:185], v23 offset:4096
    v_mfma_f32_16x16x32_bf16 v[104:107], v[160:163], v[136:139], v[104:107]
    ds_read_b64_tr_b16 v[186:187], v23 offset:4608
    v_mfma_f32_16x16x32_bf16 v[36:39], v[164:167], v[124:127], v[36:39]
    ds_read_b64_tr_b16 v[188:189], v24 offset:4096
    v_mfma_f32_16x16x32_bf16 v[60:63], v[164:167], v[128:131], v[60:63]
    ds_read_b64_tr_b16 v[190:191], v24 offset:4608
    v_mfma_f32_16x16x32_bf16 v[84:87], v[164:167], v[132:135], v[84:87]
    ds_read_b64_tr_b16 v[192:193], v25 offset:4096
    v_mfma_f32_16x16x32_bf16 v[108:111], v[164:167], v[136:139], v[108:111]
    ds_read_b64_tr_b16 v[194:195], v25 offset:4608
    v_mfma_f32_16x16x32_bf16 v[40:43], v[168:171], v[124:127], v[40:43]
    ds_read_b64_tr_b16 v[196:197], v26 offset:4096
    v_mfma_f32_16x16x32_bf16 v[64:67], v[168:171], v[128:131], v[64:67]
    ds_read_b64_tr_b16 v[198:199], v26 offset:4608
    v_mfma_f32_16x16x32_bf16 v[88:91], v[168:171], v[132:135], v[88:91]
    ds_read_b64_tr_b16 v[200:201], v27 offset:4096
    v_mfma_f32_16x16x32_bf16 v[112:115], v[168:171], v[136:139], v[112:115]
    ds_read_b64_tr_b16 v[202:203], v27 offset:4608
    v_mfma_f32_16x16x32_bf16 v[44:47], v[172:175], v[124:127], v[44:47]
    v_add_u32 v20, 40960, v20
    v_mfma_f32_16x16x32_bf16 v[68:71], v[172:175], v[128:131], v[68:71]
    v_add_u32 v21, 40960, v21
    v_mfma_f32_16x16x32_bf16 v[92:95], v[172:175], v[132:135], v[92:95]
    v_add_u32 v22, 40960, v22
    v_mfma_f32_16x16x32_bf16 v[116:119], v[172:175], v[136:139], v[116:119]
    v_add_u32 v23, 40960, v23
    v_mfma_f32_16x16x32_bf16 v[48:51], v[176:179], v[124:127], v[48:51]
    v_add_u32 v24, 40960, v24
    v_mfma_f32_16x16x32_bf16 v[72:75], v[176:179], v[128:131], v[72:75]
    v_add_u32 v25, 40960, v25
    v_mfma_f32_16x16x32_bf16 v[96:99], v[176:179], v[132:135], v[96:99]
    v_add_u32 v26, 40960, v26
    v_mfma_f32_16x16x32_bf16 v[120:123], v[176:179], v[136:139], v[120:123]
    v_add_u32 v27, 40960, v27
    .p2align 3
    s_waitcnt lgkmcnt(0)
    s_barrier
    v_mfma_f32_16x16x32_bf16 v[28:31], v[180:183], v[140:143], v[28:31]
    ds_read_b128 v[124:127], v20 offset:0
    v_mfma_f32_16x16x32_bf16 v[52:55], v[180:183], v[144:147], v[52:55]
    ds_read_b128 v[128:131], v20 offset:2048
    v_mfma_f32_16x16x32_bf16 v[76:79], v[180:183], v[148:151], v[76:79]
    ds_read_b128 v[132:135], v20 offset:4096
    v_mfma_f32_16x16x32_bf16 v[100:103], v[180:183], v[152:155], v[100:103]
    ds_read_b128 v[136:139], v20 offset:6144
    v_mfma_f32_16x16x32_bf16 v[32:35], v[184:187], v[140:143], v[32:35]
    ds_read_b64_tr_b16 v[156:157], v22 offset:0
    v_mfma_f32_16x16x32_bf16 v[56:59], v[184:187], v[144:147], v[56:59]
    ds_read_b64_tr_b16 v[158:159], v22 offset:512
    v_mfma_f32_16x16x32_bf16 v[80:83], v[184:187], v[148:151], v[80:83]
    ds_read_b64_tr_b16 v[160:161], v23 offset:0
    v_mfma_f32_16x16x32_bf16 v[104:107], v[184:187], v[152:155], v[104:107]
    ds_read_b64_tr_b16 v[162:163], v23 offset:512
    v_mfma_f32_16x16x32_bf16 v[36:39], v[188:191], v[140:143], v[36:39]
    ds_read_b64_tr_b16 v[164:165], v24 offset:0
    v_mfma_f32_16x16x32_bf16 v[60:63], v[188:191], v[144:147], v[60:63]
    ds_read_b64_tr_b16 v[166:167], v24 offset:512
    v_mfma_f32_16x16x32_bf16 v[84:87], v[188:191], v[148:151], v[84:87]
    ds_read_b64_tr_b16 v[168:169], v25 offset:0
    v_mfma_f32_16x16x32_bf16 v[108:111], v[188:191], v[152:155], v[108:111]
    ds_read_b64_tr_b16 v[170:171], v25 offset:512
    v_mfma_f32_16x16x32_bf16 v[40:43], v[192:195], v[140:143], v[40:43]
    ds_read_b64_tr_b16 v[172:173], v26 offset:0
    v_mfma_f32_16x16x32_bf16 v[64:67], v[192:195], v[144:147], v[64:67]
    ds_read_b64_tr_b16 v[174:175], v26 offset:512
    v_mfma_f32_16x16x32_bf16 v[88:91], v[192:195], v[148:151], v[88:91]
    ds_read_b64_tr_b16 v[176:177], v27 offset:0
    v_mfma_f32_16x16x32_bf16 v[112:115], v[192:195], v[152:155], v[112:115]
    ds_read_b64_tr_b16 v[178:179], v27 offset:512
    v_mfma_f32_16x16x32_bf16 v[44:47], v[196:199], v[140:143], v[44:47]
    v_mfma_f32_16x16x32_bf16 v[68:71], v[196:199], v[144:147], v[68:71]
    v_mfma_f32_16x16x32_bf16 v[92:95], v[196:199], v[148:151], v[92:95]
    v_mfma_f32_16x16x32_bf16 v[116:119], v[196:199], v[152:155], v[116:119]
    v_mfma_f32_16x16x32_bf16 v[48:51], v[200:203], v[140:143], v[48:51]
    v_mfma_f32_16x16x32_bf16 v[72:75], v[200:203], v[144:147], v[72:75]
    v_mfma_f32_16x16x32_bf16 v[96:99], v[200:203], v[148:151], v[96:99]
    v_mfma_f32_16x16x32_bf16 v[120:123], v[200:203], v[152:155], v[120:123]
    .p2align 3
    s_waitcnt lgkmcnt(0)
    s_nop 0
    v_mfma_f32_16x16x32_bf16 v[28:31], v[156:159], v[124:127], v[28:31]
    ds_read_b128 v[140:143], v21 offset:0
    v_mfma_f32_16x16x32_bf16 v[52:55], v[156:159], v[128:131], v[52:55]
    ds_read_b128 v[144:147], v21 offset:2048
    v_mfma_f32_16x16x32_bf16 v[76:79], v[156:159], v[132:135], v[76:79]
    ds_read_b128 v[148:151], v21 offset:4096
    v_mfma_f32_16x16x32_bf16 v[100:103], v[156:159], v[136:139], v[100:103]
    ds_read_b128 v[152:155], v21 offset:6144
    v_mfma_f32_16x16x32_bf16 v[32:35], v[160:163], v[124:127], v[32:35]
    ds_read_b64_tr_b16 v[180:181], v22 offset:4096
    v_mfma_f32_16x16x32_bf16 v[56:59], v[160:163], v[128:131], v[56:59]
    ds_read_b64_tr_b16 v[182:183], v22 offset:4608
    v_mfma_f32_16x16x32_bf16 v[80:83], v[160:163], v[132:135], v[80:83]
    ds_read_b64_tr_b16 v[184:185], v23 offset:4096
    v_mfma_f32_16x16x32_bf16 v[104:107], v[160:163], v[136:139], v[104:107]
    ds_read_b64_tr_b16 v[186:187], v23 offset:4608
    v_mfma_f32_16x16x32_bf16 v[36:39], v[164:167], v[124:127], v[36:39]
    ds_read_b64_tr_b16 v[188:189], v24 offset:4096
    v_mfma_f32_16x16x32_bf16 v[60:63], v[164:167], v[128:131], v[60:63]
    ds_read_b64_tr_b16 v[190:191], v24 offset:4608
    v_mfma_f32_16x16x32_bf16 v[84:87], v[164:167], v[132:135], v[84:87]
    ds_read_b64_tr_b16 v[192:193], v25 offset:4096
    v_mfma_f32_16x16x32_bf16 v[108:111], v[164:167], v[136:139], v[108:111]
    ds_read_b64_tr_b16 v[194:195], v25 offset:4608
    v_mfma_f32_16x16x32_bf16 v[40:43], v[168:171], v[124:127], v[40:43]
    ds_read_b64_tr_b16 v[196:197], v26 offset:4096
    v_mfma_f32_16x16x32_bf16 v[64:67], v[168:171], v[128:131], v[64:67]
    ds_read_b64_tr_b16 v[198:199], v26 offset:4608
    v_mfma_f32_16x16x32_bf16 v[88:91], v[168:171], v[132:135], v[88:91]
    ds_read_b64_tr_b16 v[200:201], v27 offset:4096
    v_mfma_f32_16x16x32_bf16 v[112:115], v[168:171], v[136:139], v[112:115]
    ds_read_b64_tr_b16 v[202:203], v27 offset:4608
    v_mfma_f32_16x16x32_bf16 v[44:47], v[172:175], v[124:127], v[44:47]
    v_add_u32 v20, 4294885376, v20
    v_mfma_f32_16x16x32_bf16 v[68:71], v[172:175], v[128:131], v[68:71]
    v_add_u32 v21, 4294885376, v21
    v_mfma_f32_16x16x32_bf16 v[92:95], v[172:175], v[132:135], v[92:95]
    v_add_u32 v22, 4294885376, v22
    v_mfma_f32_16x16x32_bf16 v[116:119], v[172:175], v[136:139], v[116:119]
    v_add_u32 v23, 4294885376, v23
    v_mfma_f32_16x16x32_bf16 v[48:51], v[176:179], v[124:127], v[48:51]
    v_add_u32 v24, 4294885376, v24
    v_mfma_f32_16x16x32_bf16 v[72:75], v[176:179], v[128:131], v[72:75]
    v_add_u32 v25, 4294885376, v25
    v_mfma_f32_16x16x32_bf16 v[96:99], v[176:179], v[132:135], v[96:99]
    v_add_u32 v26, 4294885376, v26
    v_mfma_f32_16x16x32_bf16 v[120:123], v[176:179], v[136:139], v[120:123]
    v_add_u32 v27, 4294885376, v27
    .p2align 3
    s_waitcnt lgkmcnt(0)
    s_barrier
    v_mfma_f32_16x16x32_bf16 v[28:31], v[180:183], v[140:143], v[28:31]
    ds_read_b128 v[124:127], v20 offset:0
    v_mfma_f32_16x16x32_bf16 v[52:55], v[180:183], v[144:147], v[52:55]
    ds_read_b128 v[128:131], v20 offset:2048
    v_mfma_f32_16x16x32_bf16 v[76:79], v[180:183], v[148:151], v[76:79]
    ds_read_b128 v[132:135], v20 offset:4096
    v_mfma_f32_16x16x32_bf16 v[100:103], v[180:183], v[152:155], v[100:103]
    ds_read_b128 v[136:139], v20 offset:6144
    v_mfma_f32_16x16x32_bf16 v[32:35], v[184:187], v[140:143], v[32:35]
    ds_read_b64_tr_b16 v[156:157], v22 offset:0
    v_mfma_f32_16x16x32_bf16 v[56:59], v[184:187], v[144:147], v[56:59]
    ds_read_b64_tr_b16 v[158:159], v22 offset:512
    v_mfma_f32_16x16x32_bf16 v[80:83], v[184:187], v[148:151], v[80:83]
    ds_read_b64_tr_b16 v[160:161], v23 offset:0
    v_mfma_f32_16x16x32_bf16 v[104:107], v[184:187], v[152:155], v[104:107]
    ds_read_b64_tr_b16 v[162:163], v23 offset:512
    v_mfma_f32_16x16x32_bf16 v[36:39], v[188:191], v[140:143], v[36:39]
    ds_read_b64_tr_b16 v[164:165], v24 offset:0
    v_mfma_f32_16x16x32_bf16 v[60:63], v[188:191], v[144:147], v[60:63]
    ds_read_b64_tr_b16 v[166:167], v24 offset:512
    v_mfma_f32_16x16x32_bf16 v[84:87], v[188:191], v[148:151], v[84:87]
    ds_read_b64_tr_b16 v[168:169], v25 offset:0
    v_mfma_f32_16x16x32_bf16 v[108:111], v[188:191], v[152:155], v[108:111]
    ds_read_b64_tr_b16 v[170:171], v25 offset:512
    v_mfma_f32_16x16x32_bf16 v[40:43], v[192:195], v[140:143], v[40:43]
    ds_read_b64_tr_b16 v[172:173], v26 offset:0
    v_mfma_f32_16x16x32_bf16 v[64:67], v[192:195], v[144:147], v[64:67]
    ds_read_b64_tr_b16 v[174:175], v26 offset:512
    v_mfma_f32_16x16x32_bf16 v[88:91], v[192:195], v[148:151], v[88:91]
    ds_read_b64_tr_b16 v[176:177], v27 offset:0
    v_mfma_f32_16x16x32_bf16 v[112:115], v[192:195], v[152:155], v[112:115]
    ds_read_b64_tr_b16 v[178:179], v27 offset:512
    v_mfma_f32_16x16x32_bf16 v[44:47], v[196:199], v[140:143], v[44:47]
    v_mfma_f32_16x16x32_bf16 v[68:71], v[196:199], v[144:147], v[68:71]
    v_mfma_f32_16x16x32_bf16 v[92:95], v[196:199], v[148:151], v[92:95]
    v_mfma_f32_16x16x32_bf16 v[116:119], v[196:199], v[152:155], v[116:119]
    v_mfma_f32_16x16x32_bf16 v[48:51], v[200:203], v[140:143], v[48:51]
    v_mfma_f32_16x16x32_bf16 v[72:75], v[200:203], v[144:147], v[72:75]
    v_mfma_f32_16x16x32_bf16 v[96:99], v[200:203], v[148:151], v[96:99]
    v_mfma_f32_16x16x32_bf16 v[120:123], v[200:203], v[152:155], v[120:123]
    .p2align 3
    s_waitcnt lgkmcnt(0)
    s_nop 0
    v_mfma_f32_16x16x32_bf16 v[28:31], v[156:159], v[124:127], v[28:31]
    ds_read_b128 v[140:143], v21 offset:0
    v_mfma_f32_16x16x32_bf16 v[52:55], v[156:159], v[128:131], v[52:55]
    ds_read_b128 v[144:147], v21 offset:2048
    v_mfma_f32_16x16x32_bf16 v[76:79], v[156:159], v[132:135], v[76:79]
    ds_read_b128 v[148:151], v21 offset:4096
    v_mfma_f32_16x16x32_bf16 v[100:103], v[156:159], v[136:139], v[100:103]
    ds_read_b128 v[152:155], v21 offset:6144
    v_mfma_f32_16x16x32_bf16 v[32:35], v[160:163], v[124:127], v[32:35]
    ds_read_b64_tr_b16 v[180:181], v22 offset:4096
    v_mfma_f32_16x16x32_bf16 v[56:59], v[160:163], v[128:131], v[56:59]
    ds_read_b64_tr_b16 v[182:183], v22 offset:4608
    v_mfma_f32_16x16x32_bf16 v[80:83], v[160:163], v[132:135], v[80:83]
    ds_read_b64_tr_b16 v[184:185], v23 offset:4096
    v_mfma_f32_16x16x32_bf16 v[104:107], v[160:163], v[136:139], v[104:107]
    ds_read_b64_tr_b16 v[186:187], v23 offset:4608
    v_mfma_f32_16x16x32_bf16 v[36:39], v[164:167], v[124:127], v[36:39]
    ds_read_b64_tr_b16 v[188:189], v24 offset:4096
    v_mfma_f32_16x16x32_bf16 v[60:63], v[164:167], v[128:131], v[60:63]
    ds_read_b64_tr_b16 v[190:191], v24 offset:4608
    v_mfma_f32_16x16x32_bf16 v[84:87], v[164:167], v[132:135], v[84:87]
    ds_read_b64_tr_b16 v[192:193], v25 offset:4096
    v_mfma_f32_16x16x32_bf16 v[108:111], v[164:167], v[136:139], v[108:111]
    ds_read_b64_tr_b16 v[194:195], v25 offset:4608
    v_mfma_f32_16x16x32_bf16 v[40:43], v[168:171], v[124:127], v[40:43]
    ds_read_b64_tr_b16 v[196:197], v26 offset:4096
    v_mfma_f32_16x16x32_bf16 v[64:67], v[168:171], v[128:131], v[64:67]
    ds_read_b64_tr_b16 v[198:199], v26 offset:4608
    v_mfma_f32_16x16x32_bf16 v[88:91], v[168:171], v[132:135], v[88:91]
    ds_read_b64_tr_b16 v[200:201], v27 offset:4096
    v_mfma_f32_16x16x32_bf16 v[112:115], v[168:171], v[136:139], v[112:115]
    ds_read_b64_tr_b16 v[202:203], v27 offset:4608
    v_mfma_f32_16x16x32_bf16 v[44:47], v[172:175], v[124:127], v[44:47]
    v_add_u32 v20, 40960, v20
    v_mfma_f32_16x16x32_bf16 v[68:71], v[172:175], v[128:131], v[68:71]
    v_add_u32 v21, 40960, v21
    v_mfma_f32_16x16x32_bf16 v[92:95], v[172:175], v[132:135], v[92:95]
    v_add_u32 v22, 40960, v22
    v_mfma_f32_16x16x32_bf16 v[116:119], v[172:175], v[136:139], v[116:119]
    v_add_u32 v23, 40960, v23
    v_mfma_f32_16x16x32_bf16 v[48:51], v[176:179], v[124:127], v[48:51]
    v_add_u32 v24, 40960, v24
    v_mfma_f32_16x16x32_bf16 v[72:75], v[176:179], v[128:131], v[72:75]
    v_add_u32 v25, 40960, v25
    v_mfma_f32_16x16x32_bf16 v[96:99], v[176:179], v[132:135], v[96:99]
    v_add_u32 v26, 40960, v26
    v_mfma_f32_16x16x32_bf16 v[120:123], v[176:179], v[136:139], v[120:123]
    v_add_u32 v27, 40960, v27
    .p2align 3
    s_waitcnt lgkmcnt(0)
    s_barrier
    v_mfma_f32_16x16x32_bf16 v[28:31], v[180:183], v[140:143], v[28:31]
    ds_read_b128 v[124:127], v20 offset:0
    v_mfma_f32_16x16x32_bf16 v[52:55], v[180:183], v[144:147], v[52:55]
    ds_read_b128 v[128:131], v20 offset:2048
    v_mfma_f32_16x16x32_bf16 v[76:79], v[180:183], v[148:151], v[76:79]
    ds_read_b128 v[132:135], v20 offset:4096
    v_mfma_f32_16x16x32_bf16 v[100:103], v[180:183], v[152:155], v[100:103]
    ds_read_b128 v[136:139], v20 offset:6144
    v_mfma_f32_16x16x32_bf16 v[32:35], v[184:187], v[140:143], v[32:35]
    ds_read_b64_tr_b16 v[156:157], v22 offset:0
    v_mfma_f32_16x16x32_bf16 v[56:59], v[184:187], v[144:147], v[56:59]
    ds_read_b64_tr_b16 v[158:159], v22 offset:512
    v_mfma_f32_16x16x32_bf16 v[80:83], v[184:187], v[148:151], v[80:83]
    ds_read_b64_tr_b16 v[160:161], v23 offset:0
    v_mfma_f32_16x16x32_bf16 v[104:107], v[184:187], v[152:155], v[104:107]
    ds_read_b64_tr_b16 v[162:163], v23 offset:512
    v_mfma_f32_16x16x32_bf16 v[36:39], v[188:191], v[140:143], v[36:39]
    ds_read_b64_tr_b16 v[164:165], v24 offset:0
    v_mfma_f32_16x16x32_bf16 v[60:63], v[188:191], v[144:147], v[60:63]
    ds_read_b64_tr_b16 v[166:167], v24 offset:512
    v_mfma_f32_16x16x32_bf16 v[84:87], v[188:191], v[148:151], v[84:87]
    ds_read_b64_tr_b16 v[168:169], v25 offset:0
    v_mfma_f32_16x16x32_bf16 v[108:111], v[188:191], v[152:155], v[108:111]
    ds_read_b64_tr_b16 v[170:171], v25 offset:512
    v_mfma_f32_16x16x32_bf16 v[40:43], v[192:195], v[140:143], v[40:43]
    ds_read_b64_tr_b16 v[172:173], v26 offset:0
    v_mfma_f32_16x16x32_bf16 v[64:67], v[192:195], v[144:147], v[64:67]
    ds_read_b64_tr_b16 v[174:175], v26 offset:512
    v_mfma_f32_16x16x32_bf16 v[88:91], v[192:195], v[148:151], v[88:91]
    ds_read_b64_tr_b16 v[176:177], v27 offset:0
    v_mfma_f32_16x16x32_bf16 v[112:115], v[192:195], v[152:155], v[112:115]
    ds_read_b64_tr_b16 v[178:179], v27 offset:512
    v_mfma_f32_16x16x32_bf16 v[44:47], v[196:199], v[140:143], v[44:47]
    v_mfma_f32_16x16x32_bf16 v[68:71], v[196:199], v[144:147], v[68:71]
    v_mfma_f32_16x16x32_bf16 v[92:95], v[196:199], v[148:151], v[92:95]
    v_mfma_f32_16x16x32_bf16 v[116:119], v[196:199], v[152:155], v[116:119]
    v_mfma_f32_16x16x32_bf16 v[48:51], v[200:203], v[140:143], v[48:51]
    v_mfma_f32_16x16x32_bf16 v[72:75], v[200:203], v[144:147], v[72:75]
    v_mfma_f32_16x16x32_bf16 v[96:99], v[200:203], v[148:151], v[96:99]
    v_mfma_f32_16x16x32_bf16 v[120:123], v[200:203], v[152:155], v[120:123]
    .p2align 3
    s_waitcnt lgkmcnt(0)
    s_nop 0
    v_mfma_f32_16x16x32_bf16 v[28:31], v[156:159], v[124:127], v[28:31]
    ds_read_b128 v[140:143], v21 offset:0
    v_mfma_f32_16x16x32_bf16 v[52:55], v[156:159], v[128:131], v[52:55]
    ds_read_b128 v[144:147], v21 offset:2048
    v_mfma_f32_16x16x32_bf16 v[76:79], v[156:159], v[132:135], v[76:79]
    ds_read_b128 v[148:151], v21 offset:4096
    v_mfma_f32_16x16x32_bf16 v[100:103], v[156:159], v[136:139], v[100:103]
    ds_read_b128 v[152:155], v21 offset:6144
    v_mfma_f32_16x16x32_bf16 v[32:35], v[160:163], v[124:127], v[32:35]
    ds_read_b64_tr_b16 v[180:181], v22 offset:4096
    v_mfma_f32_16x16x32_bf16 v[56:59], v[160:163], v[128:131], v[56:59]
    ds_read_b64_tr_b16 v[182:183], v22 offset:4608
    v_mfma_f32_16x16x32_bf16 v[80:83], v[160:163], v[132:135], v[80:83]
    ds_read_b64_tr_b16 v[184:185], v23 offset:4096
    v_mfma_f32_16x16x32_bf16 v[104:107], v[160:163], v[136:139], v[104:107]
    ds_read_b64_tr_b16 v[186:187], v23 offset:4608
    v_mfma_f32_16x16x32_bf16 v[36:39], v[164:167], v[124:127], v[36:39]
    ds_read_b64_tr_b16 v[188:189], v24 offset:4096
    v_mfma_f32_16x16x32_bf16 v[60:63], v[164:167], v[128:131], v[60:63]
    ds_read_b64_tr_b16 v[190:191], v24 offset:4608
    v_mfma_f32_16x16x32_bf16 v[84:87], v[164:167], v[132:135], v[84:87]
    ds_read_b64_tr_b16 v[192:193], v25 offset:4096
    v_mfma_f32_16x16x32_bf16 v[108:111], v[164:167], v[136:139], v[108:111]
    ds_read_b64_tr_b16 v[194:195], v25 offset:4608
    v_mfma_f32_16x16x32_bf16 v[40:43], v[168:171], v[124:127], v[40:43]
    ds_read_b64_tr_b16 v[196:197], v26 offset:4096
    v_mfma_f32_16x16x32_bf16 v[64:67], v[168:171], v[128:131], v[64:67]
    ds_read_b64_tr_b16 v[198:199], v26 offset:4608
    v_mfma_f32_16x16x32_bf16 v[88:91], v[168:171], v[132:135], v[88:91]
    ds_read_b64_tr_b16 v[200:201], v27 offset:4096
    v_mfma_f32_16x16x32_bf16 v[112:115], v[168:171], v[136:139], v[112:115]
    ds_read_b64_tr_b16 v[202:203], v27 offset:4608
    v_mfma_f32_16x16x32_bf16 v[44:47], v[172:175], v[124:127], v[44:47]
    v_add_u32 v20, 40960, v20
    v_mfma_f32_16x16x32_bf16 v[68:71], v[172:175], v[128:131], v[68:71]
    v_add_u32 v21, 40960, v21
    v_mfma_f32_16x16x32_bf16 v[92:95], v[172:175], v[132:135], v[92:95]
    v_add_u32 v22, 40960, v22
    v_mfma_f32_16x16x32_bf16 v[116:119], v[172:175], v[136:139], v[116:119]
    v_add_u32 v23, 40960, v23
    v_mfma_f32_16x16x32_bf16 v[48:51], v[176:179], v[124:127], v[48:51]
    v_add_u32 v24, 40960, v24
    v_mfma_f32_16x16x32_bf16 v[72:75], v[176:179], v[128:131], v[72:75]
    v_add_u32 v25, 40960, v25
    v_mfma_f32_16x16x32_bf16 v[96:99], v[176:179], v[132:135], v[96:99]
    v_add_u32 v26, 40960, v26
    v_mfma_f32_16x16x32_bf16 v[120:123], v[176:179], v[136:139], v[120:123]
    v_add_u32 v27, 40960, v27
    .p2align 3
    s_waitcnt lgkmcnt(0)
    s_barrier
    v_mfma_f32_16x16x32_bf16 v[28:31], v[180:183], v[140:143], v[28:31]
    ds_read_b128 v[124:127], v20 offset:0
    v_mfma_f32_16x16x32_bf16 v[52:55], v[180:183], v[144:147], v[52:55]
    ds_read_b128 v[128:131], v20 offset:2048
    v_mfma_f32_16x16x32_bf16 v[76:79], v[180:183], v[148:151], v[76:79]
    ds_read_b128 v[132:135], v20 offset:4096
    v_mfma_f32_16x16x32_bf16 v[100:103], v[180:183], v[152:155], v[100:103]
    ds_read_b128 v[136:139], v20 offset:6144
    v_mfma_f32_16x16x32_bf16 v[32:35], v[184:187], v[140:143], v[32:35]
    ds_read_b64_tr_b16 v[156:157], v22 offset:0
    v_mfma_f32_16x16x32_bf16 v[56:59], v[184:187], v[144:147], v[56:59]
    ds_read_b64_tr_b16 v[158:159], v22 offset:512
    v_mfma_f32_16x16x32_bf16 v[80:83], v[184:187], v[148:151], v[80:83]
    ds_read_b64_tr_b16 v[160:161], v23 offset:0
    v_mfma_f32_16x16x32_bf16 v[104:107], v[184:187], v[152:155], v[104:107]
    ds_read_b64_tr_b16 v[162:163], v23 offset:512
    v_mfma_f32_16x16x32_bf16 v[36:39], v[188:191], v[140:143], v[36:39]
    ds_read_b64_tr_b16 v[164:165], v24 offset:0
    v_mfma_f32_16x16x32_bf16 v[60:63], v[188:191], v[144:147], v[60:63]
    ds_read_b64_tr_b16 v[166:167], v24 offset:512
    v_mfma_f32_16x16x32_bf16 v[84:87], v[188:191], v[148:151], v[84:87]
    ds_read_b64_tr_b16 v[168:169], v25 offset:0
    v_mfma_f32_16x16x32_bf16 v[108:111], v[188:191], v[152:155], v[108:111]
    ds_read_b64_tr_b16 v[170:171], v25 offset:512
    v_mfma_f32_16x16x32_bf16 v[40:43], v[192:195], v[140:143], v[40:43]
    ds_read_b64_tr_b16 v[172:173], v26 offset:0
    v_mfma_f32_16x16x32_bf16 v[64:67], v[192:195], v[144:147], v[64:67]
    ds_read_b64_tr_b16 v[174:175], v26 offset:512
    v_mfma_f32_16x16x32_bf16 v[88:91], v[192:195], v[148:151], v[88:91]
    ds_read_b64_tr_b16 v[176:177], v27 offset:0
    buffer_load_dwordx2 v[204:205], v5, s[28:31], 0 offen offset:0 sc1
    v_mfma_f32_16x16x32_bf16 v[112:115], v[192:195], v[152:155], v[112:115]
    ds_read_b64_tr_b16 v[178:179], v27 offset:512
    buffer_load_dwordx2 v[206:207], v5, s[28:31], 0 offen offset:128 sc1
    v_mfma_f32_16x16x32_bf16 v[44:47], v[196:199], v[140:143], v[44:47]
    buffer_load_dwordx2 v[208:209], v5, s[28:31], 0 offen offset:256 sc1
    v_mfma_f32_16x16x32_bf16 v[68:71], v[196:199], v[144:147], v[68:71]
    buffer_load_dwordx2 v[210:211], v5, s[28:31], 0 offen offset:384 sc1
    v_mfma_f32_16x16x32_bf16 v[92:95], v[196:199], v[148:151], v[92:95]
    buffer_load_dwordx4 v[212:215], v252, s[32:35], 0 offen offset:0 sc1
    v_mfma_f32_16x16x32_bf16 v[116:119], v[196:199], v[152:155], v[116:119]
    buffer_load_dwordx4 v[216:219], v252, s[32:35], 0 offen offset:256 sc1
    v_mfma_f32_16x16x32_bf16 v[48:51], v[200:203], v[140:143], v[48:51]
    buffer_load_dwordx4 v[220:223], v252, s[32:35], 0 offen offset:512 sc1
    v_mfma_f32_16x16x32_bf16 v[72:75], v[200:203], v[144:147], v[72:75]
    buffer_load_dwordx4 v[224:227], v252, s[32:35], 0 offen offset:768 sc1
    v_mfma_f32_16x16x32_bf16 v[96:99], v[200:203], v[148:151], v[96:99]
    buffer_load_dwordx4 v[228:231], v252, s[32:35], 0 offen offset:1024 sc1
    v_mfma_f32_16x16x32_bf16 v[120:123], v[200:203], v[152:155], v[120:123]
    buffer_load_dwordx4 v[232:235], v252, s[32:35], 0 offen offset:1280 sc1
    .p2align 3
    s_waitcnt lgkmcnt(0)
    s_nop 0
    v_mfma_f32_16x16x32_bf16 v[28:31], v[156:159], v[124:127], v[28:31]
    ds_read_b128 v[140:143], v21 offset:0
    v_mfma_f32_16x16x32_bf16 v[52:55], v[156:159], v[128:131], v[52:55]
    ds_read_b128 v[144:147], v21 offset:2048
    v_mfma_f32_16x16x32_bf16 v[76:79], v[156:159], v[132:135], v[76:79]
    ds_read_b128 v[148:151], v21 offset:4096
    v_mfma_f32_16x16x32_bf16 v[100:103], v[156:159], v[136:139], v[100:103]
    ds_read_b128 v[152:155], v21 offset:6144
    v_mfma_f32_16x16x32_bf16 v[32:35], v[160:163], v[124:127], v[32:35]
    ds_read_b64_tr_b16 v[180:181], v22 offset:4096
    v_mfma_f32_16x16x32_bf16 v[56:59], v[160:163], v[128:131], v[56:59]
    ds_read_b64_tr_b16 v[182:183], v22 offset:4608
    v_mfma_f32_16x16x32_bf16 v[80:83], v[160:163], v[132:135], v[80:83]
    ds_read_b64_tr_b16 v[184:185], v23 offset:4096
    v_mfma_f32_16x16x32_bf16 v[104:107], v[160:163], v[136:139], v[104:107]
    ds_read_b64_tr_b16 v[186:187], v23 offset:4608
    v_mfma_f32_16x16x32_bf16 v[36:39], v[164:167], v[124:127], v[36:39]
    ds_read_b64_tr_b16 v[188:189], v24 offset:4096
    v_mfma_f32_16x16x32_bf16 v[60:63], v[164:167], v[128:131], v[60:63]
    ds_read_b64_tr_b16 v[190:191], v24 offset:4608
    v_mfma_f32_16x16x32_bf16 v[84:87], v[164:167], v[132:135], v[84:87]
    ds_read_b64_tr_b16 v[192:193], v25 offset:4096
    v_mfma_f32_16x16x32_bf16 v[108:111], v[164:167], v[136:139], v[108:111]
    ds_read_b64_tr_b16 v[194:195], v25 offset:4608
    v_mfma_f32_16x16x32_bf16 v[40:43], v[168:171], v[124:127], v[40:43]
    ds_read_b64_tr_b16 v[196:197], v26 offset:4096
    v_mfma_f32_16x16x32_bf16 v[64:67], v[168:171], v[128:131], v[64:67]
    ds_read_b64_tr_b16 v[198:199], v26 offset:4608
    v_mfma_f32_16x16x32_bf16 v[88:91], v[168:171], v[132:135], v[88:91]
    ds_read_b64_tr_b16 v[200:201], v27 offset:4096
    v_mfma_f32_16x16x32_bf16 v[112:115], v[168:171], v[136:139], v[112:115]
    ds_read_b64_tr_b16 v[202:203], v27 offset:4608
    v_mfma_f32_16x16x32_bf16 v[44:47], v[172:175], v[124:127], v[44:47]
    v_add_u32 v20, 4294885376, v20
    v_mfma_f32_16x16x32_bf16 v[68:71], v[172:175], v[128:131], v[68:71]
    v_add_u32 v21, 4294885376, v21
    v_mfma_f32_16x16x32_bf16 v[92:95], v[172:175], v[132:135], v[92:95]
    v_add_u32 v22, 4294885376, v22
    v_mfma_f32_16x16x32_bf16 v[116:119], v[172:175], v[136:139], v[116:119]
    v_add_u32 v23, 4294885376, v23
    v_mfma_f32_16x16x32_bf16 v[48:51], v[176:179], v[124:127], v[48:51]
    v_add_u32 v24, 4294885376, v24
    v_mfma_f32_16x16x32_bf16 v[72:75], v[176:179], v[128:131], v[72:75]
    v_add_u32 v25, 4294885376, v25
    v_mfma_f32_16x16x32_bf16 v[96:99], v[176:179], v[132:135], v[96:99]
    v_add_u32 v26, 4294885376, v26
    v_mfma_f32_16x16x32_bf16 v[120:123], v[176:179], v[136:139], v[120:123]
    v_add_u32 v27, 4294885376, v27
    .p2align 3
    s_waitcnt lgkmcnt(0)
    s_barrier
    v_mfma_f32_16x16x32_bf16 v[28:31], v[180:183], v[140:143], v[28:31]
    ds_read_b128 v[124:127], v20 offset:0
    v_mfma_f32_16x16x32_bf16 v[52:55], v[180:183], v[144:147], v[52:55]
    ds_read_b128 v[128:131], v20 offset:2048
    v_mfma_f32_16x16x32_bf16 v[76:79], v[180:183], v[148:151], v[76:79]
    ds_read_b128 v[132:135], v20 offset:4096
    v_mfma_f32_16x16x32_bf16 v[100:103], v[180:183], v[152:155], v[100:103]
    ds_read_b128 v[136:139], v20 offset:6144
    v_mfma_f32_16x16x32_bf16 v[32:35], v[184:187], v[140:143], v[32:35]
    ds_read_b64_tr_b16 v[156:157], v22 offset:0
    v_mfma_f32_16x16x32_bf16 v[56:59], v[184:187], v[144:147], v[56:59]
    ds_read_b64_tr_b16 v[158:159], v22 offset:512
    v_mfma_f32_16x16x32_bf16 v[80:83], v[184:187], v[148:151], v[80:83]
    ds_read_b64_tr_b16 v[160:161], v23 offset:0
    v_mfma_f32_16x16x32_bf16 v[104:107], v[184:187], v[152:155], v[104:107]
    ds_read_b64_tr_b16 v[162:163], v23 offset:512
    v_mfma_f32_16x16x32_bf16 v[36:39], v[188:191], v[140:143], v[36:39]
    ds_read_b64_tr_b16 v[164:165], v24 offset:0
    v_mfma_f32_16x16x32_bf16 v[60:63], v[188:191], v[144:147], v[60:63]
    ds_read_b64_tr_b16 v[166:167], v24 offset:512
    v_mfma_f32_16x16x32_bf16 v[84:87], v[188:191], v[148:151], v[84:87]
    ds_read_b64_tr_b16 v[168:169], v25 offset:0
    v_mfma_f32_16x16x32_bf16 v[108:111], v[188:191], v[152:155], v[108:111]
    ds_read_b64_tr_b16 v[170:171], v25 offset:512
    v_mfma_f32_16x16x32_bf16 v[40:43], v[192:195], v[140:143], v[40:43]
    ds_read_b64_tr_b16 v[172:173], v26 offset:0
    v_mfma_f32_16x16x32_bf16 v[64:67], v[192:195], v[144:147], v[64:67]
    ds_read_b64_tr_b16 v[174:175], v26 offset:512
    v_mfma_f32_16x16x32_bf16 v[88:91], v[192:195], v[148:151], v[88:91]
    ds_read_b64_tr_b16 v[176:177], v27 offset:0
    v_mfma_f32_16x16x32_bf16 v[112:115], v[192:195], v[152:155], v[112:115]
    ds_read_b64_tr_b16 v[178:179], v27 offset:512
    s_waitcnt vmcnt(0)
    v_mfma_f32_16x16x32_bf16 v[44:47], v[196:199], v[140:143], v[44:47]
    v_xor_b32 v3, v6, v205
    v_xor_b32 v4, v6, v207
    v_mfma_f32_16x16x32_bf16 v[68:71], v[196:199], v[144:147], v[68:71]
    v_xor_b32 v244, v6, v209
    v_or3_b32 v3, v3, v4, v244
    v_mfma_f32_16x16x32_bf16 v[92:95], v[196:199], v[148:151], v[92:95]
    v_xor_b32 v4, v6, v211
    v_xor_b32 v244, v6, v215
    v_mfma_f32_16x16x32_bf16 v[116:119], v[196:199], v[152:155], v[116:119]
    v_or3_b32 v3, v3, v4, v244
    v_xor_b32 v4, v6, v219
    v_mfma_f32_16x16x32_bf16 v[48:51], v[200:203], v[140:143], v[48:51]
    v_xor_b32 v244, v6, v223
    v_or3_b32 v3, v3, v4, v244
    v_mfma_f32_16x16x32_bf16 v[72:75], v[200:203], v[144:147], v[72:75]
    v_xor_b32 v4, v6, v227
    v_xor_b32 v244, v6, v231
    v_mfma_f32_16x16x32_bf16 v[96:99], v[200:203], v[148:151], v[96:99]
    v_or3_b32 v3, v3, v4, v244
    v_xor_b32 v4, v6, v235
    v_mfma_f32_16x16x32_bf16 v[120:123], v[200:203], v[152:155], v[120:123]
    v_or_b32 v3, v3, v4
    v_cmp_ne_u32 vcc, 0, v3
    s_cbranch_vccnz S_sretry
S_sok:
    .p2align 3
    s_waitcnt lgkmcnt(0)
    s_nop 0
    v_mfma_f32_16x16x32_bf16 v[28:31], v[156:159], v[124:127], v[28:31]
    ds_read_b128 v[140:143], v21 offset:0
    v_mov_b32 v215, 0
    v_mfma_f32_16x16x32_bf16 v[52:55], v[156:159], v[128:131], v[52:55]
    ds_read_b128 v[144:147], v21 offset:2048
    v_mov_b32 v219, 0
    v_mfma_f32_16x16x32_bf16 v[76:79], v[156:159], v[132:135], v[76:79]
    ds_read_b128 v[148:151], v21 offset:4096
    v_mov_b32 v223, 0
    v_mfma_f32_16x16x32_bf16 v[100:103], v[156:159], v[136:139], v[100:103]
    ds_read_b128 v[152:155], v21 offset:6144
    v_mov_b32 v227, 0
    v_mfma_f32_16x16x32_bf16 v[32:35], v[160:163], v[124:127], v[32:35]
    ds_read_b64_tr_b16 v[180:181], v22 offset:4096
    v_mov_b32 v231, 0
    v_mfma_f32_16x16x32_bf16 v[56:59], v[160:163], v[128:131], v[56:59]
    ds_read_b64_tr_b16 v[182:183], v22 offset:4608
    v_mov_b32 v235, 0
    v_mfma_f32_16x16x32_bf16 v[80:83], v[160:163], v[132:135], v[80:83]
    ds_read_b64_tr_b16 v[184:185], v23 offset:4096
    v_perm_b32 v3, v204, v204, s47
    v_mfma_f32_16x16x32_bf16 v[104:107], v[160:163], v[136:139], v[104:107]
    ds_read_b64_tr_b16 v[186:187], v23 offset:4608
    v_lshrrev_b32 v4, 16, v204
    v_mfma_f32_16x16x32_bf16 v[36:39], v[164:167], v[124:127], v[36:39]
    ds_read_b64_tr_b16 v[188:189], v24 offset:4096
    v_cndmask_b32 v244, 0, v3, s[52:53]
    v_mfma_f32_16x16x32_bf16 v[60:63], v[164:167], v[128:131], v[60:63]
    ds_read_b64_tr_b16 v[190:191], v24 offset:4608
    v_cndmask_b32 v245, 0, v4, s[52:53]
    v_mfma_f32_16x16x32_bf16 v[84:87], v[164:167], v[132:135], v[84:87]
    ds_read_b64_tr_b16 v[192:193], v25 offset:4096
    v_and_b32 v204, 0xffff0000, v204
    v_mfma_f32_16x16x32_bf16 v[108:111], v[164:167], v[136:139], v[108:111]
    ds_read_b64_tr_b16 v[194:195], v25 offset:4608
    v_rcp_f32 v205, v204
    v_mfma_f32_16x16x32_bf16 v[40:43], v[168:171], v[124:127], v[40:43]
    ds_read_b64_tr_b16 v[196:197], v26 offset:4096
    v_perm_b32 v3, v206, v206, s47
    v_mfma_f32_16x16x32_bf16 v[64:67], v[168:171], v[128:131], v[64:67]
    ds_read_b64_tr_b16 v[198:199], v26 offset:4608
    v_lshrrev_b32 v4, 16, v206
    v_mfma_f32_16x16x32_bf16 v[88:91], v[168:171], v[132:135], v[88:91]
    ds_read_b64_tr_b16 v[200:201], v27 offset:4096
    v_cndmask_b32 v246, 0, v3, s[52:53]
    v_mfma_f32_16x16x32_bf16 v[112:115], v[168:171], v[136:139], v[112:115]
    ds_read_b64_tr_b16 v[202:203], v27 offset:4608
    v_cndmask_b32 v247, 0, v4, s[52:53]
    v_mfma_f32_16x16x32_bf16 v[44:47], v[172:175], v[124:127], v[44:47]
    v_and_b32 v206, 0xffff0000, v206
    v_mfma_f32_16x16x32_bf16 v[68:71], v[172:175], v[128:131], v[68:71]
    v_rcp_f32 v207, v206
    v_mfma_f32_16x16x32_bf16 v[92:95], v[172:175], v[132:135], v[92:95]
    v_perm_b32 v3, v208, v208, s47
    v_lshrrev_b32 v4, 16, v208
    v_mfma_f32_16x16x32_bf16 v[116:119], v[172:175], v[136:139], v[116:119]
    v_cndmask_b32 v248, 0, v3, s[52:53]
    v_cndmask_b32 v249, 0, v4, s[52:53]
    v_mfma_f32_16x16x32_bf16 v[48:51], v[176:179], v[124:127], v[48:51]
    v_and_b32 v208, 0xffff0000, v208
    v_rcp_f32 v209, v208
    v_mfma_f32_16x16x32_bf16 v[72:75], v[176:179], v[128:131], v[72:75]
    v_perm_b32 v3, v210, v210, s47
    v_lshrrev_b32 v4, 16, v210
    v_mfma_f32_16x16x32_bf16 v[96:99], v[176:179], v[132:135], v[96:99]
    v_cndmask_b32 v250, 0, v3, s[52:53]
    v_cndmask_b32 v251, 0, v4, s[52:53]
    v_mfma_f32_16x16x32_bf16 v[120:123], v[176:179], v[136:139], v[120:123]
    v_and_b32 v210, 0xffff0000, v210
    v_rcp_f32 v211, v210
    s_waitcnt lgkmcnt(0)
    s_barrier
    v_mov_b32 v236, v244
    v_mov_b32 v237, v245
    s_nop 1
    v_mfma_f32_16x16x32_bf16 v[28:31], v[212:215], v[236:239], v[28:31]
    v_mov_b32 v240, v246
    v_mfma_f32_16x16x32_bf16 v[32:35], v[216:219], v[236:239], v[32:35]
    v_mov_b32 v241, v247
    v_mfma_f32_16x16x32_bf16 v[36:39], v[220:223], v[236:239], v[36:39]
    v_mfma_f32_16x16x32_bf16 v[40:43], v[224:227], v[236:239], v[40:43]
    v_mfma_f32_16x16x32_bf16 v[44:47], v[228:231], v[236:239], v[44:47]
    v_mfma_f32_16x16x32_bf16 v[48:51], v[232:235], v[236:239], v[48:51]
    v_mfma_f32_16x16x32_bf16 v[52:55], v[212:215], v[240:243], v[52:55]
    v_mov_b32 v236, v248
    v_mfma_f32_16x16x32_bf16 v[56:59], v[216:219], v[240:243], v[56:59]
    v_mov_b32 v237, v249
    v_mfma_f32_16x16x32_bf16 v[60:63], v[220:223], v[240:243], v[60:63]
    v_mfma_f32_16x16x32_bf16 v[64:67], v[224:227], v[240:243], v[64:67]
    v_mfma_f32_16x16x32_bf16 v[68:71], v[228:231], v[240:243], v[68:71]
    v_mfma_f32_16x16x32_bf16 v[72:75], v[232:235], v[240:243], v[72:75]
    v_mfma_f32_16x16x32_bf16 v[76:79], v[212:215], v[236:239], v[76:79]
    v_mov_b32 v240, v250
    v_mfma_f32_16x16x32_bf16 v[80:83], v[216:219], v[236:239], v[80:83]
    v_mov_b32 v241, v251
    v_mfma_f32_16x16x32_bf16 v[84:87], v[220:223], v[236:239], v[84:87]
    v_mfma_f32_16x16x32_bf16 v[88:91], v[224:227], v[236:239], v[88:91]
    v_mfma_f32_16x16x32_bf16 v[92:95], v[228:231], v[236:239], v[92:95]
    v_mfma_f32_16x16x32_bf16 v[96:99], v[232:235], v[236:239], v[96:99]
    v_mfma_f32_16x16x32_bf16 v[100:103], v[212:215], v[240:243], v[100:103]
    v_mfma_f32_16x16x32_bf16 v[104:107], v[216:219], v[240:243], v[104:107]
    v_mfma_f32_16x16x32_bf16 v[108:111], v[220:223], v[240:243], v[108:111]
    v_mfma_f32_16x16x32_bf16 v[112:115], v[224:227], v[240:243], v[112:115]
    v_mfma_f32_16x16x32_bf16 v[116:119], v[228:231], v[240:243], v[116:119]
    v_mfma_f32_16x16x32_bf16 v[120:123], v[232:235], v[240:243], v[120:123]
    v_mfma_f32_16x16x32_bf16 v[28:31], v[180:183], v[140:143], v[28:31]
    v_mul_f32 v244, 0xc0135761, v205
    v_mfma_f32_16x16x32_bf16 v[52:55], v[180:183], v[144:147], v[52:55]
    v_mul_f32 v4, v205, v205
    v_mfma_f32_16x16x32_bf16 v[76:79], v[180:183], v[148:151], v[76:79]
    v_mul_f32 v4, v4, v205
    v_mfma_f32_16x16x32_bf16 v[100:103], v[180:183], v[152:155], v[100:103]
    v_mul_f32 v245, 0xbdd2d3e8, v4
    v_mfma_f32_16x16x32_bf16 v[32:35], v[184:187], v[140:143], v[32:35]
    v_mul_f32 v246, 0xc0135761, v207
    v_mfma_f32_16x16x32_bf16 v[56:59], v[184:187], v[144:147], v[56:59]
    v_mul_f32 v4, v207, v207
    v_mfma_f32_16x16x32_bf16 v[80:83], v[184:187], v[148:151], v[80:83]
    v_mul_f32 v4, v4, v207
    v_mfma_f32_16x16x32_bf16 v[104:107], v[184:187], v[152:155], v[104:107]
    v_mul_f32 v247, 0xbdd2d3e8, v4
    v_mfma_f32_16x16x32_bf16 v[36:39], v[188:191], v[140:143], v[36:39]
    v_mul_f32 v248, 0xc0135761, v209
    v_mfma_f32_16x16x32_bf16 v[60:63], v[188:191], v[144:147], v[60:63]
    v_mul_f32 v4, v209, v209
    v_mfma_f32_16x16x32_bf16 v[84:87], v[188:191], v[148:151], v[84:87]
    v_mul_f32 v4, v4, v209
    v_mfma_f32_16x16x32_bf16 v[108:111], v[188:191], v[152:155], v[108:111]
    v_mul_f32 v249, 0xbdd2d3e8, v4
    v_mfma_f32_16x16x32_bf16 v[40:43], v[192:195], v[140:143], v[40:43]
    v_mul_f32 v250, 0xc0135761, v211
    v_mfma_f32_16x16x32_bf16 v[64:67], v[192:195], v[144:147], v[64:67]
    v_mul_f32 v4, v211, v211
    v_mfma_f32_16x16x32_bf16 v[88:91], v[192:195], v[148:151], v[88:91]
    v_mul_f32 v4, v4, v211
    v_mfma_f32_16x16x32_bf16 v[112:115], v[192:195], v[152:155], v[112:115]
    v_mul_f32 v251, 0xbdd2d3e8, v4
    v_mfma_f32_16x16x32_bf16 v[44:47], v[196:199], v[140:143], v[44:47]
    v_mfma_f32_16x16x32_bf16 v[68:71], v[196:199], v[144:147], v[68:71]
    v_mfma_f32_16x16x32_bf16 v[92:95], v[196:199], v[148:151], v[92:95]
    v_mfma_f32_16x16x32_bf16 v[116:119], v[196:199], v[152:155], v[116:119]
    v_mfma_f32_16x16x32_bf16 v[48:51], v[200:203], v[140:143], v[48:51]
    v_mfma_f32_16x16x32_bf16 v[72:75], v[200:203], v[144:147], v[72:75]
    v_mfma_f32_16x16x32_bf16 v[96:99], v[200:203], v[148:151], v[96:99]
    v_mfma_f32_16x16x32_bf16 v[120:123], v[200:203], v[152:155], v[120:123]
    s_mov_b32 s28, s18
    s_mov_b32 s29, s19
    s_mov_b32 s30, 1280
    s_mov_b32 s31, 0x20000
    v_lshlrev_b32 v5, 3, v9
    buffer_load_dwordx2 v[228:229], v5, s[28:31], s59 offen offset:0
    buffer_load_dwordx2 v[230:231], v5, s[28:31], s59 offen offset:32
    buffer_load_dwordx2 v[232:233], v5, s[28:31], s59 offen offset:64
    buffer_load_dwordx2 v[234:235], v5, s[28:31], s59 offen offset:96
    v_mov_b32 v3, s61
    v_mov_b32 v4, v6
    s_add_u32 s47, s60, 110592
    .p2align 3
    v_pk_mul_f32 v[156:157], v[28:29], v[28:29]
    v_pk_mul_f32 v[158:159], v[30:31], v[30:31]
    v_pk_mul_f32 v[160:161], v[32:33], v[32:33]
    v_pk_mul_f32 v[162:163], v[34:35], v[34:35]
    v_pk_mul_f32 v[164:165], v[52:53], v[52:53]
    v_pk_mul_f32 v[166:167], v[54:55], v[54:55]
    v_pk_mul_f32 v[168:169], v[56:57], v[56:57]
    v_pk_mul_f32 v[170:171], v[58:59], v[58:59]
    v_pk_mul_f32 v[172:173], v[76:77], v[76:77]
    v_pk_mul_f32 v[174:175], v[78:79], v[78:79]
    v_pk_mul_f32 v[176:177], v[80:81], v[80:81]
    v_pk_mul_f32 v[178:179], v[82:83], v[82:83]
    v_pk_mul_f32 v[124:125], v[100:101], v[100:101]
    v_pk_mul_f32 v[126:127], v[102:103], v[102:103]
    v_pk_mul_f32 v[128:129], v[104:105], v[104:105]
    v_pk_mul_f32 v[130:131], v[106:107], v[106:107]
    v_pk_fma_f32 v[156:157], v[156:157], v[244:245], v[244:245] op_sel:[0,1,0] op_sel_hi:[1,1,0]
    v_pk_fma_f32 v[158:159], v[158:159], v[244:245], v[244:245] op_sel:[0,1,0] op_sel_hi:[1,1,0]
    v_pk_fma_f32 v[160:161], v[160:161], v[244:245], v[244:245] op_sel:[0,1,0] op_sel_hi:[1,1,0]
    v_pk_fma_f32 v[162:163], v[162:163], v[244:245], v[244:245] op_sel:[0,1,0] op_sel_hi:[1,1,0]
    v_pk_fma_f32 v[164:165], v[164:165], v[246:247], v[246:247] op_sel:[0,1,0] op_sel_hi:[1,1,0]
    v_pk_fma_f32 v[166:167], v[166:167], v[246:247], v[246:247] op_sel:[0,1,0] op_sel_hi:[1,1,0]
    v_pk_fma_f32 v[168:169], v[168:169], v[246:247], v[246:247] op_sel:[0,1,0] op_sel_hi:[1,1,0]
    v_pk_fma_f32 v[170:171], v[170:171], v[246:247], v[246:247] op_sel:[0,1,0] op_sel_hi:[1,1,0]
    v_pk_fma_f32 v[172:173], v[172:173], v[248:249], v[248:249] op_sel:[0,1,0] op_sel_hi:[1,1,0]
    v_pk_fma_f32 v[174:175], v[174:175], v[248:249], v[248:249] op_sel:[0,1,0] op_sel_hi:[1,1,0]
    v_pk_fma_f32 v[176:177], v[176:177], v[248:249], v[248:249] op_sel:[0,1,0] op_sel_hi:[1,1,0]
    v_pk_fma_f32 v[178:179], v[178:179], v[248:249], v[248:249] op_sel:[0,1,0] op_sel_hi:[1,1,0]
    v_pk_fma_f32 v[124:125], v[124:125], v[250:251], v[250:251] op_sel:[0,1,0] op_sel_hi:[1,1,0]
    v_pk_fma_f32 v[126:127], v[126:127], v[250:251], v[250:251] op_sel:[0,1,0] op_sel_hi:[1,1,0]
    v_pk_fma_f32 v[128:129], v[128:129], v[250:251], v[250:251] op_sel:[0,1,0] op_sel_hi:[1,1,0]
    v_pk_fma_f32 v[130:131], v[130:131], v[250:251], v[250:251] op_sel:[0,1,0] op_sel_hi:[1,1,0]
    v_pk_mul_f32 v[156:157], v[156:157], v[28:29]
    v_pk_mul_f32 v[158:159], v[158:159], v[30:31]
    v_pk_mul_f32 v[160:161], v[160:161], v[32:33]
    v_pk_mul_f32 v[162:163], v[162:163], v[34:35]
    v_pk_mul_f32 v[164:165], v[164:165], v[52:53]
    v_pk_mul_f32 v[166:167], v[166:167], v[54:55]
    v_pk_mul_f32 v[168:169], v[168:169], v[56:57]
    v_pk_mul_f32 v[170:171], v[170:171], v[58:59]
    v_pk_mul_f32 v[172:173], v[172:173], v[76:77]
    v_pk_mul_f32 v[174:175], v[174:175], v[78:79]
    v_pk_mul_f32 v[176:177], v[176:177], v[80:81]
    v_pk_mul_f32 v[178:179], v[178:179], v[82:83]
    v_pk_mul_f32 v[124:125], v[124:125], v[100:101]
    v_pk_mul_f32 v[126:127], v[126:127], v[102:103]
    v_pk_mul_f32 v[128:129], v[128:129], v[104:105]
    v_pk_mul_f32 v[130:131], v[130:131], v[106:107]
    v_exp_f32 v156, v156
    v_exp_f32 v157, v157
    v_exp_f32 v158, v158
    v_exp_f32 v159, v159
    v_exp_f32 v160, v160
    v_exp_f32 v161, v161
    v_exp_f32 v162, v162
    v_exp_f32 v163, v163
    v_exp_f32 v164, v164
    v_exp_f32 v165, v165
    v_exp_f32 v166, v166
    v_exp_f32 v167, v167
    v_exp_f32 v168, v168
    v_exp_f32 v169, v169
    v_exp_f32 v170, v170
    v_exp_f32 v171, v171
    v_exp_f32 v172, v172
    v_exp_f32 v173, v173
    v_exp_f32 v174, v174
    v_exp_f32 v175, v175
    v_exp_f32 v176, v176
    v_exp_f32 v177, v177
    v_exp_f32 v178, v178
    v_exp_f32 v179, v179
    v_exp_f32 v124, v124
    v_exp_f32 v125, v125
    v_exp_f32 v126, v126
    v_exp_f32 v127, v127
    v_exp_f32 v128, v128
    v_exp_f32 v129, v129
    v_exp_f32 v130, v130
    v_exp_f32 v131, v131
    v_pk_fma_f32 v[156:157], v[156:157], v[204:205], v[204:205] op_sel_hi:[1,0,0]
    v_pk_fma_f32 v[158:159], v[158:159], v[204:205], v[204:205] op_sel_hi:[1,0,0]
    v_pk_fma_f32 v[160:161], v[160:161], v[204:205], v[204:205] op_sel_hi:[1,0,0]
    v_pk_fma_f32 v[162:163], v[162:163], v[204:205], v[204:205] op_sel_hi:[1,0,0]
    v_pk_fma_f32 v[164:165], v[164:165], v[206:207], v[206:207] op_sel_hi:[1,0,0]
    v_pk_fma_f32 v[166:167], v[166:167], v[206:207], v[206:207] op_sel_hi:[1,0,0]
    v_pk_fma_f32 v[168:169], v[168:169], v[206:207], v[206:207] op_sel_hi:[1,0,0]
    v_pk_fma_f32 v[170:171], v[170:171], v[206:207], v[206:207] op_sel_hi:[1,0,0]
    v_pk_fma_f32 v[172:173], v[172:173], v[208:209], v[208:209] op_sel_hi:[1,0,0]
    v_pk_fma_f32 v[174:175], v[174:175], v[208:209], v[208:209] op_sel_hi:[1,0,0]
    v_pk_fma_f32 v[176:177], v[176:177], v[208:209], v[208:209] op_sel_hi:[1,0,0]
    v_pk_fma_f32 v[178:179], v[178:179], v[208:209], v[208:209] op_sel_hi:[1,0,0]
    v_pk_fma_f32 v[124:125], v[124:125], v[210:211], v[210:211] op_sel_hi:[1,0,0]
    v_pk_fma_f32 v[126:127], v[126:127], v[210:211], v[210:211] op_sel_hi:[1,0,0]
    v_pk_fma_f32 v[128:129], v[128:129], v[210:211], v[210:211] op_sel_hi:[1,0,0]
    v_pk_fma_f32 v[130:131], v[130:131], v[210:211], v[210:211] op_sel_hi:[1,0,0]
    v_rcp_f32 v156, v156
    v_rcp_f32 v157, v157
    v_rcp_f32 v158, v158
    v_rcp_f32 v159, v159
    v_rcp_f32 v160, v160
    v_rcp_f32 v161, v161
    v_rcp_f32 v162, v162
    v_rcp_f32 v163, v163
    v_rcp_f32 v164, v164
    v_rcp_f32 v165, v165
    v_rcp_f32 v166, v166
    v_rcp_f32 v167, v167
    v_rcp_f32 v168, v168
    v_rcp_f32 v169, v169
    v_rcp_f32 v170, v170
    v_rcp_f32 v171, v171
    v_rcp_f32 v172, v172
    v_rcp_f32 v173, v173
    v_rcp_f32 v174, v174
    v_rcp_f32 v175, v175
    v_rcp_f32 v176, v176
    v_rcp_f32 v177, v177
    v_rcp_f32 v178, v178
    v_rcp_f32 v179, v179
    v_rcp_f32 v124, v124
    v_rcp_f32 v125, v125
    v_rcp_f32 v126, v126
    v_rcp_f32 v127, v127
    v_rcp_f32 v128, v128
    v_rcp_f32 v129, v129
    v_rcp_f32 v130, v130
    v_rcp_f32 v131, v131
    v_pk_mul_f32 v[156:157], v[156:157], v[28:29]
    v_pk_mul_f32 v[158:159], v[158:159], v[30:31]
    v_pk_mul_f32 v[160:161], v[160:161], v[32:33]
    v_pk_mul_f32 v[162:163], v[162:163], v[34:35]
    v_pk_mul_f32 v[164:165], v[164:165], v[52:53]
    v_pk_mul_f32 v[166:167], v[166:167], v[54:55]
    v_pk_mul_f32 v[168:169], v[168:169], v[56:57]
    v_pk_mul_f32 v[170:171], v[170:171], v[58:59]
    v_pk_mul_f32 v[172:173], v[172:173], v[76:77]
    v_pk_mul_f32 v[174:175], v[174:175], v[78:79]
    v_pk_mul_f32 v[176:177], v[176:177], v[80:81]
    v_pk_mul_f32 v[178:179], v[178:179], v[82:83]
    v_pk_mul_f32 v[124:125], v[124:125], v[100:101]
    v_pk_mul_f32 v[126:127], v[126:127], v[102:103]
    v_pk_mul_f32 v[128:129], v[128:129], v[104:105]
    v_pk_mul_f32 v[130:131], v[130:131], v[106:107]
    v_cvt_pk_bf16_f32 v28, v156, v157
    v_cvt_pk_bf16_f32 v29, v158, v159
    v_cvt_pk_bf16_f32 v30, v160, v161
    v_cvt_pk_bf16_f32 v31, v162, v163
    v_cvt_pk_bf16_f32 v52, v164, v165
    v_cvt_pk_bf16_f32 v53, v166, v167
    v_cvt_pk_bf16_f32 v54, v168, v169
    v_cvt_pk_bf16_f32 v55, v170, v171
    v_cvt_pk_bf16_f32 v76, v172, v173
    v_cvt_pk_bf16_f32 v77, v174, v175
    v_cvt_pk_bf16_f32 v78, v176, v177
    v_cvt_pk_bf16_f32 v79, v178, v179
    v_cvt_pk_bf16_f32 v100, v124, v125
    v_cvt_pk_bf16_f32 v101, v126, v127
    v_cvt_pk_bf16_f32 v102, v128, v129
    v_cvt_pk_bf16_f32 v103, v130, v131
    buffer_store_dwordx4 v[28:31], v2, s[24:27], s60 offen offset:0 sc1
    buffer_store_dwordx4 v[52:55], v2, s[24:27], s60 offen offset:1024 sc1
    buffer_store_dwordx4 v[76:79], v2, s[24:27], s47 offen offset:0 sc1
    buffer_store_dwordx4 v[100:103], v2, s[24:27], s47 offen offset:1024 sc1
    s_mov_b64 exec, s[62:63]
    s_nop 0
    ds_write_b128 v18, v[28:31] offset:0
    ds_write_b128 v18, v[52:55] offset:1024
    ds_write_b128 v18, v[76:79] offset:6144
    ds_write_b128 v18, v[100:103] offset:7168
    s_mov_b64 exec, -1
    s_nop 0
    s_add_u32 s60, s60, 2048
    s_add_u32 s47, s47, 2048
    v_pk_mul_f32 v[156:157], v[36:37], v[36:37]
    v_pk_mul_f32 v[158:159], v[38:39], v[38:39]
    v_pk_mul_f32 v[160:161], v[40:41], v[40:41]
    v_pk_mul_f32 v[162:163], v[42:43], v[42:43]
    v_pk_mul_f32 v[164:165], v[60:61], v[60:61]
    v_pk_mul_f32 v[166:167], v[62:63], v[62:63]
    v_pk_mul_f32 v[168:169], v[64:65], v[64:65]
    v_pk_mul_f32 v[170:171], v[66:67], v[66:67]
    v_pk_mul_f32 v[172:173], v[84:85], v[84:85]
    v_pk_mul_f32 v[174:175], v[86:87], v[86:87]
    v_pk_mul_f32 v[176:177], v[88:89], v[88:89]
    v_pk_mul_f32 v[178:179], v[90:91], v[90:91]
    v_pk_mul_f32 v[124:125], v[108:109], v[108:109]
    v_pk_mul_f32 v[126:127], v[110:111], v[110:111]
    v_pk_mul_f32 v[128:129], v[112:113], v[112:113]
    v_pk_mul_f32 v[130:131], v[114:115], v[114:115]
    v_pk_fma_f32 v[156:157], v[156:157], v[244:245], v[244:245] op_sel:[0,1,0] op_sel_hi:[1,1,0]
    v_pk_fma_f32 v[158:159], v[158:159], v[244:245], v[244:245] op_sel:[0,1,0] op_sel_hi:[1,1,0]
    v_pk_fma_f32 v[160:161], v[160:161], v[244:245], v[244:245] op_sel:[0,1,0] op_sel_hi:[1,1,0]
    v_pk_fma_f32 v[162:163], v[162:163], v[244:245], v[244:245] op_sel:[0,1,0] op_sel_hi:[1,1,0]
    v_pk_fma_f32 v[164:165], v[164:165], v[246:247], v[246:247] op_sel:[0,1,0] op_sel_hi:[1,1,0]
    v_pk_fma_f32 v[166:167], v[166:167], v[246:247], v[246:247] op_sel:[0,1,0] op_sel_hi:[1,1,0]
    v_pk_fma_f32 v[168:169], v[168:169], v[246:247], v[246:247] op_sel:[0,1,0] op_sel_hi:[1,1,0]
    v_pk_fma_f32 v[170:171], v[170:171], v[246:247], v[246:247] op_sel:[0,1,0] op_sel_hi:[1,1,0]
    v_pk_fma_f32 v[172:173], v[172:173], v[248:249], v[248:249] op_sel:[0,1,0] op_sel_hi:[1,1,0]
    v_pk_fma_f32 v[174:175], v[174:175], v[248:249], v[248:249] op_sel:[0,1,0] op_sel_hi:[1,1,0]
    v_pk_fma_f32 v[176:177], v[176:177], v[248:249], v[248:249] op_sel:[0,1,0] op_sel_hi:[1,1,0]
    v_pk_fma_f32 v[178:179], v[178:179], v[248:249], v[248:249] op_sel:[0,1,0] op_sel_hi:[1,1,0]
    v_pk_fma_f32 v[124:125], v[124:125], v[250:251], v[250:251] op_sel:[0,1,0] op_sel_hi:[1,1,0]
    v_pk_fma_f32 v[126:127], v[126:127], v[250:251], v[250:251] op_sel:[0,1,0] op_sel_hi:[1,1,0]
    v_pk_fma_f32 v[128:129], v[128:129], v[250:251], v[250:251] op_sel:[0,1,0] op_sel_hi:[1,1,0]
    v_pk_fma_f32 v[130:131], v[130:131], v[250:251], v[250:251] op_sel:[0,1,0] op_sel_hi:[1,1,0]
    v_pk_mul_f32 v[156:157], v[156:157], v[36:37]
    v_pk_mul_f32 v[158:159], v[158:159], v[38:39]
    v_pk_mul_f32 v[160:161], v[160:161], v[40:41]
    v_pk_mul_f32 v[162:163], v[162:163], v[42:43]
    v_pk_mul_f32 v[164:165], v[164:165], v[60:61]
    v_pk_mul_f32 v[166:167], v[166:167], v[62:63]
    v_pk_mul_f32 v[168:169], v[168:169], v[64:65]
    v_pk_mul_f32 v[170:171], v[170:171], v[66:67]
    v_pk_mul_f32 v[172:173], v[172:173], v[84:85]
    v_pk_mul_f32 v[174:175], v[174:175], v[86:87]
    v_pk_mul_f32 v[176:177], v[176:177], v[88:89]
    v_pk_mul_f32 v[178:179], v[178:179], v[90:91]
    v_pk_mul_f32 v[124:125], v[124:125], v[108:109]
    v_pk_mul_f32 v[126:127], v[126:127], v[110:111]
    v_pk_mul_f32 v[128:129], v[128:129], v[112:113]
    v_pk_mul_f32 v[130:131], v[130:131], v[114:115]
    v_exp_f32 v156, v156
    v_exp_f32 v157, v157
    v_exp_f32 v158, v158
    v_exp_f32 v159, v159
    v_exp_f32 v160, v160
    v_exp_f32 v161, v161
    v_exp_f32 v162, v162
    v_exp_f32 v163, v163
    v_exp_f32 v164, v164
    v_exp_f32 v165, v165
    v_exp_f32 v166, v166
    v_exp_f32 v167, v167
    v_exp_f32 v168, v168
    v_exp_f32 v169, v169
    v_exp_f32 v170, v170
    v_exp_f32 v171, v171
    v_exp_f32 v172, v172
    v_exp_f32 v173, v173
    v_exp_f32 v174, v174
    v_exp_f32 v175, v175
    v_exp_f32 v176, v176
    v_exp_f32 v177, v177
    v_exp_f32 v178, v178
    v_exp_f32 v179, v179
    v_exp_f32 v124, v124
    v_exp_f32 v125, v125
    v_exp_f32 v126, v126
    v_exp_f32 v127, v127
    v_exp_f32 v128, v128
    v_exp_f32 v129, v129
    v_exp_f32 v130, v130
    v_exp_f32 v131, v131
    v_pk_fma_f32 v[156:157], v[156:157], v[204:205], v[204:205] op_sel_hi:[1,0,0]
    v_pk_fma_f32 v[158:159], v[158:159], v[204:205], v[204:205] op_sel_hi:[1,0,0]
    v_pk_fma_f32 v[160:161], v[160:161], v[204:205], v[204:205] op_sel_hi:[1,0,0]
    v_pk_fma_f32 v[162:163], v[162:163], v[204:205], v[204:205] op_sel_hi:[1,0,0]
    v_pk_fma_f32 v[164:165], v[164:165], v[206:207], v[206:207] op_sel_hi:[1,0,0]
    v_pk_fma_f32 v[166:167], v[166:167], v[206:207], v[206:207] op_sel_hi:[1,0,0]
    v_pk_fma_f32 v[168:169], v[168:169], v[206:207], v[206:207] op_sel_hi:[1,0,0]
    v_pk_fma_f32 v[170:171], v[170:171], v[206:207], v[206:207] op_sel_hi:[1,0,0]
    v_pk_fma_f32 v[172:173], v[172:173], v[208:209], v[208:209] op_sel_hi:[1,0,0]
    v_pk_fma_f32 v[174:175], v[174:175], v[208:209], v[208:209] op_sel_hi:[1,0,0]
    v_pk_fma_f32 v[176:177], v[176:177], v[208:209], v[208:209] op_sel_hi:[1,0,0]
    v_pk_fma_f32 v[178:179], v[178:179], v[208:209], v[208:209] op_sel_hi:[1,0,0]
    v_pk_fma_f32 v[124:125], v[124:125], v[210:211], v[210:211] op_sel_hi:[1,0,0]
    v_pk_fma_f32 v[126:127], v[126:127], v[210:211], v[210:211] op_sel_hi:[1,0,0]
    v_pk_fma_f32 v[128:129], v[128:129], v[210:211], v[210:211] op_sel_hi:[1,0,0]
    v_pk_fma_f32 v[130:131], v[130:131], v[210:211], v[210:211] op_sel_hi:[1,0,0]
    v_rcp_f32 v156, v156
    v_rcp_f32 v157, v157
    v_rcp_f32 v158, v158
    v_rcp_f32 v159, v159
    v_rcp_f32 v160, v160
    v_rcp_f32 v161, v161
    v_rcp_f32 v162, v162
    v_rcp_f32 v163, v163
    v_rcp_f32 v164, v164
    v_rcp_f32 v165, v165
    v_rcp_f32 v166, v166
    v_rcp_f32 v167, v167
    v_rcp_f32 v168, v168
    v_rcp_f32 v169, v169
    v_rcp_f32 v170, v170
    v_rcp_f32 v171, v171
    v_rcp_f32 v172, v172
    v_rcp_f32 v173, v173
    v_rcp_f32 v174, v174
    v_rcp_f32 v175, v175
    v_rcp_f32 v176, v176
    v_rcp_f32 v177, v177
    v_rcp_f32 v178, v178
    v_rcp_f32 v179, v179
    v_rcp_f32 v124, v124
    v_rcp_f32 v125, v125
    v_rcp_f32 v126, v126
    v_rcp_f32 v127, v127
    v_rcp_f32 v128, v128
    v_rcp_f32 v129, v129
    v_rcp_f32 v130, v130
    v_rcp_f32 v131, v131
    s_waitcnt vmcnt(0)
    s_mov_b64 exec, 1
    buffer_store_dword v4, v3, s[36:39], 0 offen sc1
    s_mov_b64 exec, -1
    v_add_u32 v4, 1, v4
    v_pk_mul_f32 v[156:157], v[156:157], v[36:37]
    v_pk_mul_f32 v[158:159], v[158:159], v[38:39]
    v_pk_mul_f32 v[160:161], v[160:161], v[40:41]
    v_pk_mul_f32 v[162:163], v[162:163], v[42:43]
    v_pk_mul_f32 v[164:165], v[164:165], v[60:61]
    v_pk_mul_f32 v[166:167], v[166:167], v[62:63]
    v_pk_mul_f32 v[168:169], v[168:169], v[64:65]
    v_pk_mul_f32 v[170:171], v[170:171], v[66:67]
    v_pk_mul_f32 v[172:173], v[172:173], v[84:85]
    v_pk_mul_f32 v[174:175], v[174:175], v[86:87]
    v_pk_mul_f32 v[176:177], v[176:177], v[88:89]
    v_pk_mul_f32 v[178:179], v[178:179], v[90:91]
    v_pk_mul_f32 v[124:125], v[124:125], v[108:109]
    v_pk_mul_f32 v[126:127], v[126:127], v[110:111]
    v_pk_mul_f32 v[128:129], v[128:129], v[112:113]
    v_pk_mul_f32 v[130:131], v[130:131], v[114:115]
    v_cvt_pk_bf16_f32 v36, v156, v157
    v_cvt_pk_bf16_f32 v37, v158, v159
    v_cvt_pk_bf16_f32 v38, v160, v161
    v_cvt_pk_bf16_f32 v39, v162, v163
    v_cvt_pk_bf16_f32 v60, v164, v165
    v_cvt_pk_bf16_f32 v61, v166, v167
    v_cvt_pk_bf16_f32 v62, v168, v169
    v_cvt_pk_bf16_f32 v63, v170, v171
    v_cvt_pk_bf16_f32 v84, v172, v173
    v_cvt_pk_bf16_f32 v85, v174, v175
    v_cvt_pk_bf16_f32 v86, v176, v177
    v_cvt_pk_bf16_f32 v87, v178, v179
    v_cvt_pk_bf16_f32 v108, v124, v125
    v_cvt_pk_bf16_f32 v109, v126, v127
    v_cvt_pk_bf16_f32 v110, v128, v129
    v_cvt_pk_bf16_f32 v111, v130, v131
    buffer_store_dwordx4 v[36:39], v2, s[24:27], s60 offen offset:0 sc1
    buffer_store_dwordx4 v[60:63], v2, s[24:27], s60 offen offset:1024 sc1
    buffer_store_dwordx4 v[84:87], v2, s[24:27], s47 offen offset:0 sc1
    buffer_store_dwordx4 v[108:111], v2, s[24:27], s47 offen offset:1024 sc1
    s_mov_b64 exec, s[62:63]
    s_nop 0
    ds_write_b128 v18, v[36:39] offset:2048
    ds_write_b128 v18, v[60:63] offset:3072
    ds_write_b128 v18, v[84:87] offset:8192
    ds_write_b128 v18, v[108:111] offset:9216
    s_mov_b64 exec, -1
    s_nop 0
    s_add_u32 s60, s60, 2048
    s_add_u32 s47, s47, 2048
    v_pk_mul_f32 v[156:157], v[44:45], v[44:45]
    v_pk_mul_f32 v[158:159], v[46:47], v[46:47]
    v_pk_mul_f32 v[160:161], v[48:49], v[48:49]
    v_pk_mul_f32 v[162:163], v[50:51], v[50:51]
    v_pk_mul_f32 v[164:165], v[68:69], v[68:69]
    v_pk_mul_f32 v[166:167], v[70:71], v[70:71]
    v_pk_mul_f32 v[168:169], v[72:73], v[72:73]
    v_pk_mul_f32 v[170:171], v[74:75], v[74:75]
    v_pk_mul_f32 v[172:173], v[92:93], v[92:93]
    v_pk_mul_f32 v[174:175], v[94:95], v[94:95]
    v_pk_mul_f32 v[176:177], v[96:97], v[96:97]
    v_pk_mul_f32 v[178:179], v[98:99], v[98:99]
    v_pk_mul_f32 v[124:125], v[116:117], v[116:117]
    v_pk_mul_f32 v[126:127], v[118:119], v[118:119]
    v_pk_mul_f32 v[128:129], v[120:121], v[120:121]
    v_pk_mul_f32 v[130:131], v[122:123], v[122:123]
    v_pk_fma_f32 v[156:157], v[156:157], v[244:245], v[244:245] op_sel:[0,1,0] op_sel_hi:[1,1,0]
    v_pk_fma_f32 v[158:159], v[158:159], v[244:245], v[244:245] op_sel:[0,1,0] op_sel_hi:[1,1,0]
    v_pk_fma_f32 v[160:161], v[160:161], v[244:245], v[244:245] op_sel:[0,1,0] op_sel_hi:[1,1,0]
    v_pk_fma_f32 v[162:163], v[162:163], v[244:245], v[244:245] op_sel:[0,1,0] op_sel_hi:[1,1,0]
    v_pk_fma_f32 v[164:165], v[164:165], v[246:247], v[246:247] op_sel:[0,1,0] op_sel_hi:[1,1,0]
    v_pk_fma_f32 v[166:167], v[166:167], v[246:247], v[246:247] op_sel:[0,1,0] op_sel_hi:[1,1,0]
    v_pk_fma_f32 v[168:169], v[168:169], v[246:247], v[246:247] op_sel:[0,1,0] op_sel_hi:[1,1,0]
    v_pk_fma_f32 v[170:171], v[170:171], v[246:247], v[246:247] op_sel:[0,1,0] op_sel_hi:[1,1,0]
    v_pk_fma_f32 v[172:173], v[172:173], v[248:249], v[248:249] op_sel:[0,1,0] op_sel_hi:[1,1,0]
    v_pk_fma_f32 v[174:175], v[174:175], v[248:249], v[248:249] op_sel:[0,1,0] op_sel_hi:[1,1,0]
    v_pk_fma_f32 v[176:177], v[176:177], v[248:249], v[248:249] op_sel:[0,1,0] op_sel_hi:[1,1,0]
    v_pk_fma_f32 v[178:179], v[178:179], v[248:249], v[248:249] op_sel:[0,1,0] op_sel_hi:[1,1,0]
    v_pk_fma_f32 v[124:125], v[124:125], v[250:251], v[250:251] op_sel:[0,1,0] op_sel_hi:[1,1,0]
    v_pk_fma_f32 v[126:127], v[126:127], v[250:251], v[250:251] op_sel:[0,1,0] op_sel_hi:[1,1,0]
    v_pk_fma_f32 v[128:129], v[128:129], v[250:251], v[250:251] op_sel:[0,1,0] op_sel_hi:[1,1,0]
    v_pk_fma_f32 v[130:131], v[130:131], v[250:251], v[250:251] op_sel:[0,1,0] op_sel_hi:[1,1,0]
    v_pk_mul_f32 v[156:157], v[156:157], v[44:45]
    v_pk_mul_f32 v[158:159], v[158:159], v[46:47]
    v_pk_mul_f32 v[160:161], v[160:161], v[48:49]
    v_pk_mul_f32 v[162:163], v[162:163], v[50:51]
    v_pk_mul_f32 v[164:165], v[164:165], v[68:69]
    v_pk_mul_f32 v[166:167], v[166:167], v[70:71]
    v_pk_mul_f32 v[168:169], v[168:169], v[72:73]
    v_pk_mul_f32 v[170:171], v[170:171], v[74:75]
    v_pk_mul_f32 v[172:173], v[172:173], v[92:93]
    v_pk_mul_f32 v[174:175], v[174:175], v[94:95]
    v_pk_mul_f32 v[176:177], v[176:177], v[96:97]
    v_pk_mul_f32 v[178:179], v[178:179], v[98:99]
    v_pk_mul_f32 v[124:125], v[124:125], v[116:117]
    v_pk_mul_f32 v[126:127], v[126:127], v[118:119]
    v_pk_mul_f32 v[128:129], v[128:129], v[120:121]
    v_pk_mul_f32 v[130:131], v[130:131], v[122:123]
    v_exp_f32 v156, v156
    v_exp_f32 v157, v157
    v_exp_f32 v158, v158
    v_exp_f32 v159, v159
    v_exp_f32 v160, v160
    v_exp_f32 v161, v161
    v_exp_f32 v162, v162
    v_exp_f32 v163, v163
    v_exp_f32 v164, v164
    v_exp_f32 v165, v165
    v_exp_f32 v166, v166
    v_exp_f32 v167, v167
    v_exp_f32 v168, v168
    v_exp_f32 v169, v169
    v_exp_f32 v170, v170
    v_exp_f32 v171, v171
    v_exp_f32 v172, v172
    v_exp_f32 v173, v173
    v_exp_f32 v174, v174
    v_exp_f32 v175, v175
    v_exp_f32 v176, v176
    v_exp_f32 v177, v177
    v_exp_f32 v178, v178
    v_exp_f32 v179, v179
    v_exp_f32 v124, v124
    v_exp_f32 v125, v125
    v_exp_f32 v126, v126
    v_exp_f32 v127, v127
    v_exp_f32 v128, v128
    v_exp_f32 v129, v129
    v_exp_f32 v130, v130
    v_exp_f32 v131, v131
    v_pk_fma_f32 v[156:157], v[156:157], v[204:205], v[204:205] op_sel_hi:[1,0,0]
    v_pk_fma_f32 v[158:159], v[158:159], v[204:205], v[204:205] op_sel_hi:[1,0,0]
    v_pk_fma_f32 v[160:161], v[160:161], v[204:205], v[204:205] op_sel_hi:[1,0,0]
    v_pk_fma_f32 v[162:163], v[162:163], v[204:205], v[204:205] op_sel_hi:[1,0,0]
    v_pk_fma_f32 v[164:165], v[164:165], v[206:207], v[206:207] op_sel_hi:[1,0,0]
    v_pk_fma_f32 v[166:167], v[166:167], v[206:207], v[206:207] op_sel_hi:[1,0,0]
    v_pk_fma_f32 v[168:169], v[168:169], v[206:207], v[206:207] op_sel_hi:[1,0,0]
    v_pk_fma_f32 v[170:171], v[170:171], v[206:207], v[206:207] op_sel_hi:[1,0,0]
    v_pk_fma_f32 v[172:173], v[172:173], v[208:209], v[208:209] op_sel_hi:[1,0,0]
    v_pk_fma_f32 v[174:175], v[174:175], v[208:209], v[208:209] op_sel_hi:[1,0,0]
    v_pk_fma_f32 v[176:177], v[176:177], v[208:209], v[208:209] op_sel_hi:[1,0,0]
    v_pk_fma_f32 v[178:179], v[178:179], v[208:209], v[208:209] op_sel_hi:[1,0,0]
    v_pk_fma_f32 v[124:125], v[124:125], v[210:211], v[210:211] op_sel_hi:[1,0,0]
    v_pk_fma_f32 v[126:127], v[126:127], v[210:211], v[210:211] op_sel_hi:[1,0,0]
    v_pk_fma_f32 v[128:129], v[128:129], v[210:211], v[210:211] op_sel_hi:[1,0,0]
    v_pk_fma_f32 v[130:131], v[130:131], v[210:211], v[210:211] op_sel_hi:[1,0,0]
    v_rcp_f32 v156, v156
    v_rcp_f32 v157, v157
    v_rcp_f32 v158, v158
    v_rcp_f32 v159, v159
    v_rcp_f32 v160, v160
    v_rcp_f32 v161, v161
    v_rcp_f32 v162, v162
    v_rcp_f32 v163, v163
    v_rcp_f32 v164, v164
    v_rcp_f32 v165, v165
    v_rcp_f32 v166, v166
    v_rcp_f32 v167, v167
    v_rcp_f32 v168, v168
    v_rcp_f32 v169, v169
    v_rcp_f32 v170, v170
    v_rcp_f32 v171, v171
    v_rcp_f32 v172, v172
    v_rcp_f32 v173, v173
    v_rcp_f32 v174, v174
    v_rcp_f32 v175, v175
    v_rcp_f32 v176, v176
    v_rcp_f32 v177, v177
    v_rcp_f32 v178, v178
    v_rcp_f32 v179, v179
    v_rcp_f32 v124, v124
    v_rcp_f32 v125, v125
    v_rcp_f32 v126, v126
    v_rcp_f32 v127, v127
    v_rcp_f32 v128, v128
    v_rcp_f32 v129, v129
    v_rcp_f32 v130, v130
    v_rcp_f32 v131, v131
    s_waitcnt vmcnt(0)
    s_mov_b64 exec, 1
    buffer_store_dword v4, v3, s[36:39], 0 offen sc1
    s_mov_b64 exec, -1
    v_add_u32 v4, 1, v4
    v_pk_mul_f32 v[156:157], v[156:157], v[44:45]
    v_pk_mul_f32 v[158:159], v[158:159], v[46:47]
    v_pk_mul_f32 v[160:161], v[160:161], v[48:49]
    v_pk_mul_f32 v[162:163], v[162:163], v[50:51]
    v_pk_mul_f32 v[164:165], v[164:165], v[68:69]
    v_pk_mul_f32 v[166:167], v[166:167], v[70:71]
    v_pk_mul_f32 v[168:169], v[168:169], v[72:73]
    v_pk_mul_f32 v[170:171], v[170:171], v[74:75]
    v_pk_mul_f32 v[172:173], v[172:173], v[92:93]
    v_pk_mul_f32 v[174:175], v[174:175], v[94:95]
    v_pk_mul_f32 v[176:177], v[176:177], v[96:97]
    v_pk_mul_f32 v[178:179], v[178:179], v[98:99]
    v_pk_mul_f32 v[124:125], v[124:125], v[116:117]
    v_pk_mul_f32 v[126:127], v[126:127], v[118:119]
    v_pk_mul_f32 v[128:129], v[128:129], v[120:121]
    v_pk_mul_f32 v[130:131], v[130:131], v[122:123]
    v_cvt_pk_bf16_f32 v44, v156, v157
    v_cvt_pk_bf16_f32 v45, v158, v159
    v_cvt_pk_bf16_f32 v46, v160, v161
    v_cvt_pk_bf16_f32 v47, v162, v163
    v_cvt_pk_bf16_f32 v68, v164, v165
    v_cvt_pk_bf16_f32 v69, v166, v167
    v_cvt_pk_bf16_f32 v70, v168, v169
    v_cvt_pk_bf16_f32 v71, v170, v171
    v_cvt_pk_bf16_f32 v92, v172, v173
    v_cvt_pk_bf16_f32 v93, v174, v175
    v_cvt_pk_bf16_f32 v94, v176, v177
    v_cvt_pk_bf16_f32 v95, v178, v179
    v_cvt_pk_bf16_f32 v116, v124, v125
    v_cvt_pk_bf16_f32 v117, v126, v127
    v_cvt_pk_bf16_f32 v118, v128, v129
    v_cvt_pk_bf16_f32 v119, v130, v131
    buffer_store_dwordx4 v[44:47], v2, s[24:27], s60 offen offset:0 sc1
    buffer_store_dwordx4 v[68:71], v2, s[24:27], s60 offen offset:1024 sc1
    buffer_store_dwordx4 v[92:95], v2, s[24:27], s47 offen offset:0 sc1
    buffer_store_dwordx4 v[116:119], v2, s[24:27], s47 offen offset:1024 sc1
    s_mov_b64 exec, s[62:63]
    s_nop 0
    ds_write_b128 v18, v[44:47] offset:4096
    ds_write_b128 v18, v[68:71] offset:5120
    ds_write_b128 v18, v[92:95] offset:10240
    ds_write_b128 v18, v[116:119] offset:11264
    s_mov_b64 exec, -1
    s_nop 0
    s_add_u32 s60, s60, 2048
    s_add_u32 s47, s47, 2048
S_comp2:
    s_add_u32 s24, s22, 12845056
    s_addc_u32 s25, s23, 0
    s_mov_b32 s26, 3604480
    s_mov_b32 s27, 0x20000
    s_mov_b32 s32, s20
    s_mov_b32 s33, s21
    s_mov_b32 s34, 2621440
    s_mov_b32 s35, 0x20000
    .p2align 3
    s_waitcnt lgkmcnt(0)
    s_barrier
    ds_read_b64 v[202:203], v17 offset:0
    ds_read_b64 v[204:205], v17 offset:2048
    v_xor_b32 v5, 32, v17
    ds_read_b64 v[206:207], v5 offset:0
    ds_read_b64 v[208:209], v5 offset:2048
    v_xor_b32 v5, 64, v17
    ds_read_b64 v[210:211], v5 offset:0
    ds_read_b64 v[212:213], v5 offset:2048
    v_xor_b32 v5, 96, v17
    ds_read_b64 v[214:215], v5 offset:0
    ds_read_b64 v[216:217], v5 offset:2048
    ds_read_b128 v[154:157], v10 offset:0
    ds_read_b128 v[158:161], v10 offset:1024
    ds_read_b128 v[162:165], v10 offset:12288
    ds_read_b128 v[166:169], v10 offset:13312
    ds_read_b64_tr_b16 v[186:187], v12 offset:0
    ds_read_b64_tr_b16 v[188:189], v12 offset:2048
    s_waitcnt lgkmcnt(6)
    ds_read_b64_tr_b16 v[190:191], v13 offset:0
    ds_read_b64_tr_b16 v[192:193], v13 offset:2048
    ds_read_b64_tr_b16 v[194:195], v14 offset:0
    ds_read_b64_tr_b16 v[196:197], v14 offset:2048
    ds_read_b64_tr_b16 v[198:199], v15 offset:0
    ds_read_b64_tr_b16 v[200:201], v15 offset:2048
    v_lshlrev_b32 v130, 16, v228
    v_and_b32 v131, 0xffff0000, v228
    v_lshlrev_b32 v132, 16, v229
    v_and_b32 v133, 0xffff0000, v229
    v_lshlrev_b32 v22, 16, v202
    v_and_b32 v23, 0xffff0000, v202
    v_lshlrev_b32 v24, 16, v203
    v_and_b32 v25, 0xffff0000, v203
    v_pk_add_f32 v[22:23], v[22:23], v[130:131]
    v_pk_add_f32 v[24:25], v[24:25], v[132:133]
    v_lshlrev_b32 v38, 16, v204
    v_and_b32 v39, 0xffff0000, v204
    v_lshlrev_b32 v40, 16, v205
    v_and_b32 v41, 0xffff0000, v205
    v_pk_add_f32 v[38:39], v[38:39], v[130:131]
    v_pk_add_f32 v[40:41], v[40:41], v[132:133]
    v_lshlrev_b32 v130, 16, v230
    v_and_b32 v131, 0xffff0000, v230
    v_lshlrev_b32 v132, 16, v231
    v_and_b32 v133, 0xffff0000, v231
    v_lshlrev_b32 v26, 16, v206
    v_and_b32 v27, 0xffff0000, v206
    v_lshlrev_b32 v28, 16, v207
    v_and_b32 v29, 0xffff0000, v207
    v_pk_add_f32 v[26:27], v[26:27], v[130:131]
    v_pk_add_f32 v[28:29], v[28:29], v[132:133]
    v_lshlrev_b32 v42, 16, v208
    v_and_b32 v43, 0xffff0000, v208
    v_lshlrev_b32 v44, 16, v209
    v_and_b32 v45, 0xffff0000, v209
    v_pk_add_f32 v[42:43], v[42:43], v[130:131]
    v_pk_add_f32 v[44:45], v[44:45], v[132:133]
    v_lshlrev_b32 v130, 16, v232
    v_and_b32 v131, 0xffff0000, v232
    v_lshlrev_b32 v132, 16, v233
    v_and_b32 v133, 0xffff0000, v233
    v_lshlrev_b32 v30, 16, v210
    v_and_b32 v31, 0xffff0000, v210
    v_lshlrev_b32 v32, 16, v211
    v_and_b32 v33, 0xffff0000, v211
    v_pk_add_f32 v[30:31], v[30:31], v[130:131]
    v_pk_add_f32 v[32:33], v[32:33], v[132:133]
    v_lshlrev_b32 v46, 16, v212
    v_and_b32 v47, 0xffff0000, v212
    v_lshlrev_b32 v48, 16, v213
    v_and_b32 v49, 0xffff0000, v213
    v_pk_add_f32 v[46:47], v[46:47], v[130:131]
    v_pk_add_f32 v[48:49], v[48:49], v[132:133]
    v_lshlrev_b32 v130, 16, v234
    v_and_b32 v131, 0xffff0000, v234
    v_lshlrev_b32 v132, 16, v235
    v_and_b32 v133, 0xffff0000, v235
    v_lshlrev_b32 v34, 16, v214
    v_and_b32 v35, 0xffff0000, v214
    v_lshlrev_b32 v36, 16, v215
    v_and_b32 v37, 0xffff0000, v215
    v_pk_add_f32 v[34:35], v[34:35], v[130:131]
    v_pk_add_f32 v[36:37], v[36:37], v[132:133]
    v_lshlrev_b32 v50, 16, v216
    v_and_b32 v51, 0xffff0000, v216
    v_lshlrev_b32 v52, 16, v217
    v_and_b32 v53, 0xffff0000, v217
    v_pk_add_f32 v[50:51], v[50:51], v[130:131]
    v_pk_add_f32 v[52:53], v[52:53], v[132:133]
    .p2align 3
    s_waitcnt lgkmcnt(0)
    s_nop 0
    v_mfma_f32_16x16x32_bf16 v[22:25], v[186:189], v[154:157], v[22:25]
    ds_read_b128 v[170:173], v10 offset:2048
    v_mfma_f32_16x16x32_bf16 v[38:41], v[186:189], v[158:161], v[38:41]
    ds_read_b128 v[174:177], v10 offset:3072
    v_mfma_f32_16x16x32_bf16 v[54:57], v[186:189], v[162:165], 0
    ds_read_b128 v[178:181], v10 offset:14336
    v_mfma_f32_16x16x32_bf16 v[70:73], v[186:189], v[166:169], 0
    ds_read_b128 v[182:185], v10 offset:15360
    v_mfma_f32_16x16x32_bf16 v[26:29], v[190:193], v[154:157], v[26:29]
    ds_read_b64_tr_b16 v[202:203], v12 offset:4096
    v_mfma_f32_16x16x32_bf16 v[42:45], v[190:193], v[158:161], v[42:45]
    ds_read_b64_tr_b16 v[204:205], v12 offset:6144
    v_mfma_f32_16x16x32_bf16 v[58:61], v[190:193], v[162:165], 0
    ds_read_b64_tr_b16 v[206:207], v13 offset:4096
    v_mfma_f32_16x16x32_bf16 v[74:77], v[190:193], v[166:169], 0
    ds_read_b64_tr_b16 v[208:209], v13 offset:6144
    v_mfma_f32_16x16x32_bf16 v[30:33], v[194:197], v[154:157], v[30:33]
    ds_read_b64_tr_b16 v[210:211], v14 offset:4096
    v_mfma_f32_16x16x32_bf16 v[46:49], v[194:197], v[158:161], v[46:49]
    ds_read_b64_tr_b16 v[212:213], v14 offset:6144
    v_mfma_f32_16x16x32_bf16 v[62:65], v[194:197], v[162:165], 0
    ds_read_b64_tr_b16 v[214:215], v15 offset:4096
    v_mfma_f32_16x16x32_bf16 v[78:81], v[194:197], v[166:169], 0
    ds_read_b64_tr_b16 v[216:217], v15 offset:6144
    v_mfma_f32_16x16x32_bf16 v[34:37], v[198:201], v[154:157], v[34:37]
    v_mfma_f32_16x16x32_bf16 v[50:53], v[198:201], v[158:161], v[50:53]
    v_mfma_f32_16x16x32_bf16 v[66:69], v[198:201], v[162:165], 0
    v_mfma_f32_16x16x32_bf16 v[82:85], v[198:201], v[166:169], 0
    .p2align 3
    s_waitcnt lgkmcnt(0)
    s_nop 0
    v_mfma_f32_16x16x32_bf16 v[22:25], v[202:205], v[170:173], v[22:25]
    ds_read_b128 v[154:157], v10 offset:4096
    v_mfma_f32_16x16x32_bf16 v[38:41], v[202:205], v[174:177], v[38:41]
    ds_read_b128 v[158:161], v10 offset:5120
    v_mfma_f32_16x16x32_bf16 v[54:57], v[202:205], v[178:181], v[54:57]
    ds_read_b128 v[162:165], v10 offset:16384
    v_mfma_f32_16x16x32_bf16 v[70:73], v[202:205], v[182:185], v[70:73]
    ds_read_b128 v[166:169], v10 offset:17408
    v_mfma_f32_16x16x32_bf16 v[26:29], v[206:209], v[170:173], v[26:29]
    ds_read_b64_tr_b16 v[186:187], v12 offset:8192
    v_mfma_f32_16x16x32_bf16 v[42:45], v[206:209], v[174:177], v[42:45]
    ds_read_b64_tr_b16 v[188:189], v12 offset:10240
    v_mfma_f32_16x16x32_bf16 v[58:61], v[206:209], v[178:181], v[58:61]
    ds_read_b64_tr_b16 v[190:191], v13 offset:8192
    v_mfma_f32_16x16x32_bf16 v[74:77], v[206:209], v[182:185], v[74:77]
    ds_read_b64_tr_b16 v[192:193], v13 offset:10240
    v_mfma_f32_16x16x32_bf16 v[30:33], v[210:213], v[170:173], v[30:33]
    ds_read_b64_tr_b16 v[194:195], v14 offset:8192
    v_mfma_f32_16x16x32_bf16 v[46:49], v[210:213], v[174:177], v[46:49]
    ds_read_b64_tr_b16 v[196:197], v14 offset:10240
    v_mfma_f32_16x16x32_bf16 v[62:65], v[210:213], v[178:181], v[62:65]
    ds_read_b64_tr_b16 v[198:199], v15 offset:8192
    v_mfma_f32_16x16x32_bf16 v[78:81], v[210:213], v[182:185], v[78:81]
    ds_read_b64_tr_b16 v[200:201], v15 offset:10240
    v_mfma_f32_16x16x32_bf16 v[34:37], v[214:217], v[170:173], v[34:37]
    v_add_u32 v10, 49152, v10
    v_add_u32 v12, 49152, v12
    v_mfma_f32_16x16x32_bf16 v[50:53], v[214:217], v[174:177], v[50:53]
    v_add_u32 v13, 49152, v13
    v_mfma_f32_16x16x32_bf16 v[66:69], v[214:217], v[178:181], v[66:69]
    v_add_u32 v14, 49152, v14
    v_mfma_f32_16x16x32_bf16 v[82:85], v[214:217], v[182:185], v[82:85]
    v_add_u32 v15, 49152, v15
    s_lshl_b32 s47, s43, 2
    s_lshl_b32 s48, s42, 1
    s_add_u32 s47, s47, s48
    s_add_u32 s47, s47, s54
    s_mul_i32 s48, s55, 0x80008000
    v_lshlrev_b32 v5, 31, v8
    v_or_b32 v5, 1.0, v5
    v_lshlrev_b32 v4, 1, v9
    v_cvt_f32_u32 v4, v4
    v_cmp_eq_u32 vcc, 0, v9
    v_lshl_add_u32 v3, v8, 6, s47
    v_cvt_f32_u32 v20, v3
    v_mul_f32 v20, 0xba000000, v20
    v_mul_f32 v21, v4, v20
    s_add_u32 s47, s47, 1024
    v_fmamk_f32 v133, v20, 0x3f800000, v21
    v_fmamk_f32 v135, v20, 0x41000000, v21
    v_fmamk_f32 v137, v20, 0x41100000, v21
    v_cos_f32 v130, v21
    v_sin_f32 v131, v21
    v_cos_f32 v132, v133
    v_sin_f32 v133, v133
    v_cos_f32 v134, v135
    v_sin_f32 v135, v135
    v_cos_f32 v136, v137
    v_sin_f32 v137, v137
    v_cndmask_b32 v131, v131, v5, vcc
    v_mul_f32 v130, 0x35cccccd, v130
    v_mul_f32 v131, 0x35cccccd, v131
    v_mul_f32 v132, 0x35cccccd, v132
    v_mul_f32 v133, 0x35cccccd, v133
    v_mul_f32 v134, 0x35cccccd, v134
    v_mul_f32 v135, 0x35cccccd, v135
    v_mul_f32 v136, 0x35cccccd, v136
    v_mul_f32 v137, 0x35cccccd, v137
    v_cvt_pk_bf16_f32 v138, v130, v131
    v_cvt_pk_bf16_f32 v139, v132, v133
    v_cvt_pk_bf16_f32 v140, v134, v135
    v_cvt_pk_bf16_f32 v141, v136, v137
    v_xor_b32 v146, s48, v138
    v_xor_b32 v147, s48, v139
    v_xor_b32 v148, s48, v140
    v_xor_b32 v149, s48, v141
    v_lshl_add_u32 v3, v8, 6, s47
    v_cvt_f32_u32 v20, v3
    v_mul_f32 v20, 0xba000000, v20
    v_mul_f32 v21, v4, v20
    s_add_u32 s47, s47, 1024
    v_fmamk_f32 v133, v20, 0x3f800000, v21
    v_fmamk_f32 v135, v20, 0x41000000, v21
    v_fmamk_f32 v137, v20, 0x41100000, v21
    v_cos_f32 v130, v21
    v_sin_f32 v131, v21
    v_cos_f32 v132, v133
    v_sin_f32 v133, v133
    v_cos_f32 v134, v135
    v_sin_f32 v135, v135
    v_cos_f32 v136, v137
    v_sin_f32 v137, v137
    v_cndmask_b32 v131, v131, v5, vcc
    v_mul_f32 v130, 0x35cccccd, v130
    v_mul_f32 v131, 0x35cccccd, v131
    v_mul_f32 v132, 0x35cccccd, v132
    v_mul_f32 v133, 0x35cccccd, v133
    v_mul_f32 v134, 0x35cccccd, v134
    v_mul_f32 v135, 0x35cccccd, v135
    v_mul_f32 v136, 0x35cccccd, v136
    v_mul_f32 v137, 0x35cccccd, v137
    v_cvt_pk_bf16_f32 v142, v130, v131
    v_cvt_pk_bf16_f32 v143, v132, v133
    v_cvt_pk_bf16_f32 v144, v134, v135
    v_cvt_pk_bf16_f32 v145, v136, v137
    v_xor_b32 v150, s48, v142
    v_xor_b32 v151, s48, v143
    v_xor_b32 v152, s48, v144
    v_xor_b32 v153, s48, v145
    v_mov_b32 v3, s61
    v_add_u32 v4, 2, v6
    s_waitcnt vmcnt(0)
    s_mov_b64 exec, 1
    buffer_store_dword v4, v3, s[36:39], 0 offen sc1
    s_mov_b64 exec, -1
    v_add_u32 v4, 1, v4
    .p2align 3
    s_waitcnt lgkmcnt(0)
    s_barrier
    v_mfma_f32_16x16x32_bf16 v[22:25], v[186:189], v[154:157], v[22:25]
    ds_read_b128 v[170:173], v10 offset:0
    v_mfma_f32_16x16x32_bf16 v[38:41], v[186:189], v[158:161], v[38:41]
    ds_read_b128 v[174:177], v10 offset:1024
    v_mfma_f32_16x16x32_bf16 v[54:57], v[186:189], v[162:165], v[54:57]
    ds_read_b128 v[178:181], v10 offset:12288
    v_mfma_f32_16x16x32_bf16 v[70:73], v[186:189], v[166:169], v[70:73]
    ds_read_b128 v[182:185], v10 offset:13312
    v_mfma_f32_16x16x32_bf16 v[26:29], v[190:193], v[154:157], v[26:29]
    ds_read_b64_tr_b16 v[202:203], v12 offset:0
    v_mfma_f32_16x16x32_bf16 v[42:45], v[190:193], v[158:161], v[42:45]
    ds_read_b64_tr_b16 v[204:205], v12 offset:2048
    v_mfma_f32_16x16x32_bf16 v[58:61], v[190:193], v[162:165], v[58:61]
    ds_read_b64_tr_b16 v[206:207], v13 offset:0
    v_mfma_f32_16x16x32_bf16 v[74:77], v[190:193], v[166:169], v[74:77]
    ds_read_b64_tr_b16 v[208:209], v13 offset:2048
    v_mfma_f32_16x16x32_bf16 v[30:33], v[194:197], v[154:157], v[30:33]
    ds_read_b64_tr_b16 v[210:211], v14 offset:0
    v_mfma_f32_16x16x32_bf16 v[46:49], v[194:197], v[158:161], v[46:49]
    ds_read_b64_tr_b16 v[212:213], v14 offset:2048
    v_mfma_f32_16x16x32_bf16 v[62:65], v[194:197], v[162:165], v[62:65]
    ds_read_b64_tr_b16 v[214:215], v15 offset:0
    v_mfma_f32_16x16x32_bf16 v[78:81], v[194:197], v[166:169], v[78:81]
    ds_read_b64_tr_b16 v[216:217], v15 offset:2048
    v_mfma_f32_16x16x32_bf16 v[34:37], v[198:201], v[154:157], v[34:37]
    v_mfma_f32_16x16x32_bf16 v[50:53], v[198:201], v[158:161], v[50:53]
    v_mfma_f32_16x16x32_bf16 v[66:69], v[198:201], v[162:165], v[66:69]
    v_mfma_f32_16x16x32_bf16 v[82:85], v[198:201], v[166:169], v[82:85]
    .p2align 3
    s_waitcnt lgkmcnt(0)
    s_nop 0
    v_mfma_f32_16x16x32_bf16 v[22:25], v[202:205], v[170:173], v[22:25]
    ds_read_b128 v[154:157], v10 offset:2048
    v_mfma_f32_16x16x32_bf16 v[38:41], v[202:205], v[174:177], v[38:41]
    ds_read_b128 v[158:161], v10 offset:3072
    v_mfma_f32_16x16x32_bf16 v[54:57], v[202:205], v[178:181], v[54:57]
    ds_read_b128 v[162:165], v10 offset:14336
    v_mfma_f32_16x16x32_bf16 v[70:73], v[202:205], v[182:185], v[70:73]
    ds_read_b128 v[166:169], v10 offset:15360
    v_mfma_f32_16x16x32_bf16 v[26:29], v[206:209], v[170:173], v[26:29]
    ds_read_b64_tr_b16 v[186:187], v12 offset:4096
    v_mfma_f32_16x16x32_bf16 v[42:45], v[206:209], v[174:177], v[42:45]
    ds_read_b64_tr_b16 v[188:189], v12 offset:6144
    v_mfma_f32_16x16x32_bf16 v[58:61], v[206:209], v[178:181], v[58:61]
    ds_read_b64_tr_b16 v[190:191], v13 offset:4096
    v_mfma_f32_16x16x32_bf16 v[74:77], v[206:209], v[182:185], v[74:77]
    ds_read_b64_tr_b16 v[192:193], v13 offset:6144
    v_mfma_f32_16x16x32_bf16 v[30:33], v[210:213], v[170:173], v[30:33]
    ds_read_b64_tr_b16 v[194:195], v14 offset:4096
    v_mfma_f32_16x16x32_bf16 v[46:49], v[210:213], v[174:177], v[46:49]
    ds_read_b64_tr_b16 v[196:197], v14 offset:6144
    v_mfma_f32_16x16x32_bf16 v[62:65], v[210:213], v[178:181], v[62:65]
    ds_read_b64_tr_b16 v[198:199], v15 offset:4096
    v_mfma_f32_16x16x32_bf16 v[78:81], v[210:213], v[182:185], v[78:81]
    ds_read_b64_tr_b16 v[200:201], v15 offset:6144
    v_mfma_f32_16x16x32_bf16 v[34:37], v[214:217], v[170:173], v[34:37]
    v_mfma_f32_16x16x32_bf16 v[50:53], v[214:217], v[174:177], v[50:53]
    v_mfma_f32_16x16x32_bf16 v[66:69], v[214:217], v[178:181], v[66:69]
    v_mfma_f32_16x16x32_bf16 v[82:85], v[214:217], v[182:185], v[82:85]
    .p2align 3
    s_waitcnt lgkmcnt(0)
    s_nop 0
    v_mfma_f32_16x16x32_bf16 v[22:25], v[186:189], v[154:157], v[22:25]
    ds_read_b128 v[170:173], v10 offset:4096
    v_mfma_f32_16x16x32_bf16 v[38:41], v[186:189], v[158:161], v[38:41]
    ds_read_b128 v[174:177], v10 offset:5120
    v_mfma_f32_16x16x32_bf16 v[54:57], v[186:189], v[162:165], v[54:57]
    ds_read_b128 v[178:181], v10 offset:16384
    v_mfma_f32_16x16x32_bf16 v[70:73], v[186:189], v[166:169], v[70:73]
    ds_read_b128 v[182:185], v10 offset:17408
    v_mfma_f32_16x16x32_bf16 v[26:29], v[190:193], v[154:157], v[26:29]
    ds_read_b64_tr_b16 v[202:203], v12 offset:8192
    v_mfma_f32_16x16x32_bf16 v[42:45], v[190:193], v[158:161], v[42:45]
    ds_read_b64_tr_b16 v[204:205], v12 offset:10240
    v_mfma_f32_16x16x32_bf16 v[58:61], v[190:193], v[162:165], v[58:61]
    ds_read_b64_tr_b16 v[206:207], v13 offset:8192
    v_mfma_f32_16x16x32_bf16 v[74:77], v[190:193], v[166:169], v[74:77]
    ds_read_b64_tr_b16 v[208:209], v13 offset:10240
    v_mfma_f32_16x16x32_bf16 v[30:33], v[194:197], v[154:157], v[30:33]
    ds_read_b64_tr_b16 v[210:211], v14 offset:8192
    v_mfma_f32_16x16x32_bf16 v[46:49], v[194:197], v[158:161], v[46:49]
    ds_read_b64_tr_b16 v[212:213], v14 offset:10240
    v_mfma_f32_16x16x32_bf16 v[62:65], v[194:197], v[162:165], v[62:65]
    ds_read_b64_tr_b16 v[214:215], v15 offset:8192
    v_mfma_f32_16x16x32_bf16 v[78:81], v[194:197], v[166:169], v[78:81]
    ds_read_b64_tr_b16 v[216:217], v15 offset:10240
    v_mfma_f32_16x16x32_bf16 v[34:37], v[198:201], v[154:157], v[34:37]
    v_add_u32 v10, 49152, v10
    v_add_u32 v12, 49152, v12
    v_mfma_f32_16x16x32_bf16 v[50:53], v[198:201], v[158:161], v[50:53]
    v_add_u32 v13, 49152, v13
    v_mfma_f32_16x16x32_bf16 v[66:69], v[198:201], v[162:165], v[66:69]
    v_add_u32 v14, 49152, v14
    v_mfma_f32_16x16x32_bf16 v[82:85], v[198:201], v[166:169], v[82:85]
    v_add_u32 v15, 49152, v15
    .p2align 3
    s_waitcnt lgkmcnt(0)
    s_barrier
    v_mfma_f32_16x16x32_bf16 v[22:25], v[202:205], v[170:173], v[22:25]
    ds_read_b128 v[154:157], v10 offset:0
    v_mfma_f32_16x16x32_bf16 v[38:41], v[202:205], v[174:177], v[38:41]
    ds_read_b128 v[158:161], v10 offset:1024
    v_mfma_f32_16x16x32_bf16 v[54:57], v[202:205], v[178:181], v[54:57]
    ds_read_b128 v[162:165], v10 offset:12288
    v_mfma_f32_16x16x32_bf16 v[70:73], v[202:205], v[182:185], v[70:73]
    ds_read_b128 v[166:169], v10 offset:13312
    v_mfma_f32_16x16x32_bf16 v[26:29], v[206:209], v[170:173], v[26:29]
    ds_read_b64_tr_b16 v[186:187], v12 offset:0
    v_mfma_f32_16x16x32_bf16 v[42:45], v[206:209], v[174:177], v[42:45]
    ds_read_b64_tr_b16 v[188:189], v12 offset:2048
    v_mfma_f32_16x16x32_bf16 v[58:61], v[206:209], v[178:181], v[58:61]
    ds_read_b64_tr_b16 v[190:191], v13 offset:0
    v_mfma_f32_16x16x32_bf16 v[74:77], v[206:209], v[182:185], v[74:77]
    ds_read_b64_tr_b16 v[192:193], v13 offset:2048
    v_mfma_f32_16x16x32_bf16 v[30:33], v[210:213], v[170:173], v[30:33]
    ds_read_b64_tr_b16 v[194:195], v14 offset:0
    v_mfma_f32_16x16x32_bf16 v[46:49], v[210:213], v[174:177], v[46:49]
    ds_read_b64_tr_b16 v[196:197], v14 offset:2048
    v_mfma_f32_16x16x32_bf16 v[62:65], v[210:213], v[178:181], v[62:65]
    ds_read_b64_tr_b16 v[198:199], v15 offset:0
    v_mfma_f32_16x16x32_bf16 v[78:81], v[210:213], v[182:185], v[78:81]
    ds_read_b64_tr_b16 v[200:201], v15 offset:2048
    v_mfma_f32_16x16x32_bf16 v[34:37], v[214:217], v[170:173], v[34:37]
    v_mfma_f32_16x16x32_bf16 v[50:53], v[214:217], v[174:177], v[50:53]
    v_mfma_f32_16x16x32_bf16 v[66:69], v[214:217], v[178:181], v[66:69]
    v_mfma_f32_16x16x32_bf16 v[82:85], v[214:217], v[182:185], v[82:85]
    .p2align 3
    s_waitcnt lgkmcnt(0)
    s_nop 0
    v_mfma_f32_16x16x32_bf16 v[22:25], v[186:189], v[154:157], v[22:25]
    ds_read_b128 v[170:173], v10 offset:2048
    v_mfma_f32_16x16x32_bf16 v[38:41], v[186:189], v[158:161], v[38:41]
    ds_read_b128 v[174:177], v10 offset:3072
    v_mfma_f32_16x16x32_bf16 v[54:57], v[186:189], v[162:165], v[54:57]
    ds_read_b128 v[178:181], v10 offset:14336
    v_mfma_f32_16x16x32_bf16 v[70:73], v[186:189], v[166:169], v[70:73]
    ds_read_b128 v[182:185], v10 offset:15360
    v_mfma_f32_16x16x32_bf16 v[26:29], v[190:193], v[154:157], v[26:29]
    ds_read_b64_tr_b16 v[202:203], v12 offset:4096
    v_mfma_f32_16x16x32_bf16 v[42:45], v[190:193], v[158:161], v[42:45]
    ds_read_b64_tr_b16 v[204:205], v12 offset:6144
    v_mfma_f32_16x16x32_bf16 v[58:61], v[190:193], v[162:165], v[58:61]
    ds_read_b64_tr_b16 v[206:207], v13 offset:4096
    v_mfma_f32_16x16x32_bf16 v[74:77], v[190:193], v[166:169], v[74:77]
    ds_read_b64_tr_b16 v[208:209], v13 offset:6144
    v_mfma_f32_16x16x32_bf16 v[30:33], v[194:197], v[154:157], v[30:33]
    ds_read_b64_tr_b16 v[210:211], v14 offset:4096
    v_mfma_f32_16x16x32_bf16 v[46:49], v[194:197], v[158:161], v[46:49]
    ds_read_b64_tr_b16 v[212:213], v14 offset:6144
    v_mfma_f32_16x16x32_bf16 v[62:65], v[194:197], v[162:165], v[62:65]
    ds_read_b64_tr_b16 v[214:215], v15 offset:4096
    v_mfma_f32_16x16x32_bf16 v[78:81], v[194:197], v[166:169], v[78:81]
    ds_read_b64_tr_b16 v[216:217], v15 offset:6144
    v_mfma_f32_16x16x32_bf16 v[34:37], v[198:201], v[154:157], v[34:37]
    v_mfma_f32_16x16x32_bf16 v[50:53], v[198:201], v[158:161], v[50:53]
    v_mfma_f32_16x16x32_bf16 v[66:69], v[198:201], v[162:165], v[66:69]
    v_mfma_f32_16x16x32_bf16 v[82:85], v[198:201], v[166:169], v[82:85]
    .p2align 3
    s_waitcnt lgkmcnt(0)
    s_nop 0
    v_mfma_f32_16x16x32_bf16 v[22:25], v[202:205], v[170:173], v[22:25]
    ds_read_b128 v[154:157], v10 offset:4096
    v_mfma_f32_16x16x32_bf16 v[38:41], v[202:205], v[174:177], v[38:41]
    ds_read_b128 v[158:161], v10 offset:5120
    v_mfma_f32_16x16x32_bf16 v[54:57], v[202:205], v[178:181], v[54:57]
    ds_read_b128 v[162:165], v10 offset:16384
    v_mfma_f32_16x16x32_bf16 v[70:73], v[202:205], v[182:185], v[70:73]
    ds_read_b128 v[166:169], v10 offset:17408
    v_mfma_f32_16x16x32_bf16 v[26:29], v[206:209], v[170:173], v[26:29]
    ds_read_b64_tr_b16 v[186:187], v12 offset:8192
    v_mfma_f32_16x16x32_bf16 v[42:45], v[206:209], v[174:177], v[42:45]
    ds_read_b64_tr_b16 v[188:189], v12 offset:10240
    v_mfma_f32_16x16x32_bf16 v[58:61], v[206:209], v[178:181], v[58:61]
    ds_read_b64_tr_b16 v[190:191], v13 offset:8192
    v_mfma_f32_16x16x32_bf16 v[74:77], v[206:209], v[182:185], v[74:77]
    ds_read_b64_tr_b16 v[192:193], v13 offset:10240
    v_mfma_f32_16x16x32_bf16 v[30:33], v[210:213], v[170:173], v[30:33]
    ds_read_b64_tr_b16 v[194:195], v14 offset:8192
    v_mfma_f32_16x16x32_bf16 v[46:49], v[210:213], v[174:177], v[46:49]
    ds_read_b64_tr_b16 v[196:197], v14 offset:10240
    v_mfma_f32_16x16x32_bf16 v[62:65], v[210:213], v[178:181], v[62:65]
    ds_read_b64_tr_b16 v[198:199], v15 offset:8192
    v_mfma_f32_16x16x32_bf16 v[78:81], v[210:213], v[182:185], v[78:81]
    ds_read_b64_tr_b16 v[200:201], v15 offset:10240
    v_mfma_f32_16x16x32_bf16 v[34:37], v[214:217], v[170:173], v[34:37]
    v_add_u32 v10, 4294868992, v10
    v_add_u32 v12, 4294868992, v12
    v_mfma_f32_16x16x32_bf16 v[50:53], v[214:217], v[174:177], v[50:53]
    v_add_u32 v13, 4294868992, v13
    v_mfma_f32_16x16x32_bf16 v[66:69], v[214:217], v[178:181], v[66:69]
    v_add_u32 v14, 4294868992, v14
    v_mfma_f32_16x16x32_bf16 v[82:85], v[214:217], v[182:185], v[82:85]
    v_add_u32 v15, 4294868992, v15
    .p2align 3
    s_waitcnt lgkmcnt(0)
    s_barrier
    v_mfma_f32_16x16x32_bf16 v[22:25], v[186:189], v[154:157], v[22:25]
    ds_read_b128 v[170:173], v10 offset:0
    v_mfma_f32_16x16x32_bf16 v[38:41], v[186:189], v[158:161], v[38:41]
    ds_read_b128 v[174:177], v10 offset:1024
    v_mfma_f32_16x16x32_bf16 v[54:57], v[186:189], v[162:165], v[54:57]
    ds_read_b128 v[178:181], v10 offset:12288
    v_mfma_f32_16x16x32_bf16 v[70:73], v[186:189], v[166:169], v[70:73]
    ds_read_b128 v[182:185], v10 offset:13312
    v_mfma_f32_16x16x32_bf16 v[26:29], v[190:193], v[154:157], v[26:29]
    ds_read_b64_tr_b16 v[202:203], v12 offset:0
    v_mfma_f32_16x16x32_bf16 v[42:45], v[190:193], v[158:161], v[42:45]
    ds_read_b64_tr_b16 v[204:205], v12 offset:2048
    v_mfma_f32_16x16x32_bf16 v[58:61], v[190:193], v[162:165], v[58:61]
    ds_read_b64_tr_b16 v[206:207], v13 offset:0
    v_mfma_f32_16x16x32_bf16 v[74:77], v[190:193], v[166:169], v[74:77]
    ds_read_b64_tr_b16 v[208:209], v13 offset:2048
    v_mfma_f32_16x16x32_bf16 v[30:33], v[194:197], v[154:157], v[30:33]
    ds_read_b64_tr_b16 v[210:211], v14 offset:0
    v_mfma_f32_16x16x32_bf16 v[46:49], v[194:197], v[158:161], v[46:49]
    ds_read_b64_tr_b16 v[212:213], v14 offset:2048
    v_mfma_f32_16x16x32_bf16 v[62:65], v[194:197], v[162:165], v[62:65]
    ds_read_b64_tr_b16 v[214:215], v15 offset:0
    v_mfma_f32_16x16x32_bf16 v[78:81], v[194:197], v[166:169], v[78:81]
    ds_read_b64_tr_b16 v[216:217], v15 offset:2048
    v_mfma_f32_16x16x32_bf16 v[34:37], v[198:201], v[154:157], v[34:37]
    v_mfma_f32_16x16x32_bf16 v[50:53], v[198:201], v[158:161], v[50:53]
    v_mfma_f32_16x16x32_bf16 v[66:69], v[198:201], v[162:165], v[66:69]
    v_mfma_f32_16x16x32_bf16 v[82:85], v[198:201], v[166:169], v[82:85]
    .p2align 3
    s_waitcnt lgkmcnt(0)
    s_nop 0
    v_mfma_f32_16x16x32_bf16 v[22:25], v[202:205], v[170:173], v[22:25]
    ds_read_b128 v[154:157], v10 offset:2048
    v_mfma_f32_16x16x32_bf16 v[38:41], v[202:205], v[174:177], v[38:41]
    ds_read_b128 v[158:161], v10 offset:3072
    v_mfma_f32_16x16x32_bf16 v[54:57], v[202:205], v[178:181], v[54:57]
    ds_read_b128 v[162:165], v10 offset:14336
    v_mfma_f32_16x16x32_bf16 v[70:73], v[202:205], v[182:185], v[70:73]
    ds_read_b128 v[166:169], v10 offset:15360
    v_mfma_f32_16x16x32_bf16 v[26:29], v[206:209], v[170:173], v[26:29]
    ds_read_b64_tr_b16 v[186:187], v12 offset:4096
    v_mfma_f32_16x16x32_bf16 v[42:45], v[206:209], v[174:177], v[42:45]
    ds_read_b64_tr_b16 v[188:189], v12 offset:6144
    v_mfma_f32_16x16x32_bf16 v[58:61], v[206:209], v[178:181], v[58:61]
    ds_read_b64_tr_b16 v[190:191], v13 offset:4096
    v_mfma_f32_16x16x32_bf16 v[74:77], v[206:209], v[182:185], v[74:77]
    ds_read_b64_tr_b16 v[192:193], v13 offset:6144
    v_mfma_f32_16x16x32_bf16 v[30:33], v[210:213], v[170:173], v[30:33]
    ds_read_b64_tr_b16 v[194:195], v14 offset:4096
    v_mfma_f32_16x16x32_bf16 v[46:49], v[210:213], v[174:177], v[46:49]
    ds_read_b64_tr_b16 v[196:197], v14 offset:6144
    v_mfma_f32_16x16x32_bf16 v[62:65], v[210:213], v[178:181], v[62:65]
    ds_read_b64_tr_b16 v[198:199], v15 offset:4096
    v_mfma_f32_16x16x32_bf16 v[78:81], v[210:213], v[182:185], v[78:81]
    ds_read_b64_tr_b16 v[200:201], v15 offset:6144
    v_mfma_f32_16x16x32_bf16 v[34:37], v[214:217], v[170:173], v[34:37]
    v_mfma_f32_16x16x32_bf16 v[50:53], v[214:217], v[174:177], v[50:53]
    v_mfma_f32_16x16x32_bf16 v[66:69], v[214:217], v[178:181], v[66:69]
    v_mfma_f32_16x16x32_bf16 v[82:85], v[214:217], v[182:185], v[82:85]
    .p2align 3
    s_waitcnt lgkmcnt(0)
    s_nop 0
    v_mfma_f32_16x16x32_bf16 v[22:25], v[186:189], v[154:157], v[22:25]
    ds_read_b128 v[170:173], v10 offset:4096
    v_mfma_f32_16x16x32_bf16 v[38:41], v[186:189], v[158:161], v[38:41]
    ds_read_b128 v[174:177], v10 offset:5120
    v_mfma_f32_16x16x32_bf16 v[54:57], v[186:189], v[162:165], v[54:57]
    ds_read_b128 v[178:181], v10 offset:16384
    v_mfma_f32_16x16x32_bf16 v[70:73], v[186:189], v[166:169], v[70:73]
    ds_read_b128 v[182:185], v10 offset:17408
    v_mfma_f32_16x16x32_bf16 v[26:29], v[190:193], v[154:157], v[26:29]
    ds_read_b64_tr_b16 v[202:203], v12 offset:8192
    v_mfma_f32_16x16x32_bf16 v[42:45], v[190:193], v[158:161], v[42:45]
    ds_read_b64_tr_b16 v[204:205], v12 offset:10240
    v_mfma_f32_16x16x32_bf16 v[58:61], v[190:193], v[162:165], v[58:61]
    ds_read_b64_tr_b16 v[206:207], v13 offset:8192
    v_mfma_f32_16x16x32_bf16 v[74:77], v[190:193], v[166:169], v[74:77]
    ds_read_b64_tr_b16 v[208:209], v13 offset:10240
    v_mfma_f32_16x16x32_bf16 v[30:33], v[194:197], v[154:157], v[30:33]
    ds_read_b64_tr_b16 v[210:211], v14 offset:8192
    v_mfma_f32_16x16x32_bf16 v[46:49], v[194:197], v[158:161], v[46:49]
    ds_read_b64_tr_b16 v[212:213], v14 offset:10240
    v_mfma_f32_16x16x32_bf16 v[62:65], v[194:197], v[162:165], v[62:65]
    ds_read_b64_tr_b16 v[214:215], v15 offset:8192
    v_mfma_f32_16x16x32_bf16 v[78:81], v[194:197], v[166:169], v[78:81]
    ds_read_b64_tr_b16 v[216:217], v15 offset:10240
    v_mfma_f32_16x16x32_bf16 v[34:37], v[198:201], v[154:157], v[34:37]
    v_add_u32 v10, 49152, v10
    v_add_u32 v12, 49152, v12
    v_mfma_f32_16x16x32_bf16 v[50:53], v[198:201], v[158:161], v[50:53]
    v_add_u32 v13, 49152, v13
    v_mfma_f32_16x16x32_bf16 v[66:69], v[198:201], v[162:165], v[66:69]
    v_add_u32 v14, 49152, v14
    v_mfma_f32_16x16x32_bf16 v[82:85], v[198:201], v[166:169], v[82:85]
    v_add_u32 v15, 49152, v15
    .p2align 3
    s_waitcnt lgkmcnt(0)
    s_barrier
    v_mfma_f32_16x16x32_bf16 v[22:25], v[202:205], v[170:173], v[22:25]
    ds_read_b128 v[154:157], v10 offset:0
    v_mfma_f32_16x16x32_bf16 v[38:41], v[202:205], v[174:177], v[38:41]
    ds_read_b128 v[158:161], v10 offset:1024
    v_mfma_f32_16x16x32_bf16 v[54:57], v[202:205], v[178:181], v[54:57]
    ds_read_b128 v[162:165], v10 offset:12288
    v_mfma_f32_16x16x32_bf16 v[70:73], v[202:205], v[182:185], v[70:73]
    ds_read_b128 v[166:169], v10 offset:13312
    v_mfma_f32_16x16x32_bf16 v[26:29], v[206:209], v[170:173], v[26:29]
    ds_read_b64_tr_b16 v[186:187], v12 offset:0
    v_mfma_f32_16x16x32_bf16 v[42:45], v[206:209], v[174:177], v[42:45]
    ds_read_b64_tr_b16 v[188:189], v12 offset:2048
    v_mfma_f32_16x16x32_bf16 v[58:61], v[206:209], v[178:181], v[58:61]
    ds_read_b64_tr_b16 v[190:191], v13 offset:0
    v_mfma_f32_16x16x32_bf16 v[74:77], v[206:209], v[182:185], v[74:77]
    ds_read_b64_tr_b16 v[192:193], v13 offset:2048
    v_mfma_f32_16x16x32_bf16 v[30:33], v[210:213], v[170:173], v[30:33]
    ds_read_b64_tr_b16 v[194:195], v14 offset:0
    v_mfma_f32_16x16x32_bf16 v[46:49], v[210:213], v[174:177], v[46:49]
    ds_read_b64_tr_b16 v[196:197], v14 offset:2048
    v_mfma_f32_16x16x32_bf16 v[62:65], v[210:213], v[178:181], v[62:65]
    ds_read_b64_tr_b16 v[198:199], v15 offset:0
    v_mfma_f32_16x16x32_bf16 v[78:81], v[210:213], v[182:185], v[78:81]
    ds_read_b64_tr_b16 v[200:201], v15 offset:2048
    v_mfma_f32_16x16x32_bf16 v[34:37], v[214:217], v[170:173], v[34:37]
    v_mfma_f32_16x16x32_bf16 v[50:53], v[214:217], v[174:177], v[50:53]
    v_mfma_f32_16x16x32_bf16 v[66:69], v[214:217], v[178:181], v[66:69]
    v_mfma_f32_16x16x32_bf16 v[82:85], v[214:217], v[182:185], v[82:85]
    .p2align 3
    s_waitcnt lgkmcnt(0)
    s_nop 0
    v_mfma_f32_16x16x32_bf16 v[22:25], v[186:189], v[154:157], v[22:25]
    ds_read_b128 v[170:173], v10 offset:2048
    v_mfma_f32_16x16x32_bf16 v[38:41], v[186:189], v[158:161], v[38:41]
    ds_read_b128 v[174:177], v10 offset:3072
    v_mfma_f32_16x16x32_bf16 v[54:57], v[186:189], v[162:165], v[54:57]
    ds_read_b128 v[178:181], v10 offset:14336
    v_mfma_f32_16x16x32_bf16 v[70:73], v[186:189], v[166:169], v[70:73]
    ds_read_b128 v[182:185], v10 offset:15360
    v_mfma_f32_16x16x32_bf16 v[26:29], v[190:193], v[154:157], v[26:29]
    ds_read_b64_tr_b16 v[202:203], v12 offset:4096
    v_mfma_f32_16x16x32_bf16 v[42:45], v[190:193], v[158:161], v[42:45]
    ds_read_b64_tr_b16 v[204:205], v12 offset:6144
    v_mfma_f32_16x16x32_bf16 v[58:61], v[190:193], v[162:165], v[58:61]
    ds_read_b64_tr_b16 v[206:207], v13 offset:4096
    v_mfma_f32_16x16x32_bf16 v[74:77], v[190:193], v[166:169], v[74:77]
    ds_read_b64_tr_b16 v[208:209], v13 offset:6144
    v_mfma_f32_16x16x32_bf16 v[30:33], v[194:197], v[154:157], v[30:33]
    ds_read_b64_tr_b16 v[210:211], v14 offset:4096
    v_mfma_f32_16x16x32_bf16 v[46:49], v[194:197], v[158:161], v[46:49]
    ds_read_b64_tr_b16 v[212:213], v14 offset:6144
    v_mfma_f32_16x16x32_bf16 v[62:65], v[194:197], v[162:165], v[62:65]
    ds_read_b64_tr_b16 v[214:215], v15 offset:4096
    v_mfma_f32_16x16x32_bf16 v[78:81], v[194:197], v[166:169], v[78:81]
    ds_read_b64_tr_b16 v[216:217], v15 offset:6144
    v_mfma_f32_16x16x32_bf16 v[34:37], v[198:201], v[154:157], v[34:37]
    v_mfma_f32_16x16x32_bf16 v[50:53], v[198:201], v[158:161], v[50:53]
    v_mfma_f32_16x16x32_bf16 v[66:69], v[198:201], v[162:165], v[66:69]
    v_mfma_f32_16x16x32_bf16 v[82:85], v[198:201], v[166:169], v[82:85]
    .p2align 3
    s_waitcnt lgkmcnt(0)
    s_nop 0
    v_mfma_f32_16x16x32_bf16 v[22:25], v[202:205], v[170:173], v[22:25]
    ds_read_b128 v[154:157], v10 offset:4096
    v_mfma_f32_16x16x32_bf16 v[38:41], v[202:205], v[174:177], v[38:41]
    ds_read_b128 v[158:161], v10 offset:5120
    v_mfma_f32_16x16x32_bf16 v[54:57], v[202:205], v[178:181], v[54:57]
    ds_read_b128 v[162:165], v10 offset:16384
    v_mfma_f32_16x16x32_bf16 v[70:73], v[202:205], v[182:185], v[70:73]
    ds_read_b128 v[166:169], v10 offset:17408
    v_mfma_f32_16x16x32_bf16 v[26:29], v[206:209], v[170:173], v[26:29]
    ds_read_b64_tr_b16 v[186:187], v12 offset:8192
    v_mfma_f32_16x16x32_bf16 v[42:45], v[206:209], v[174:177], v[42:45]
    ds_read_b64_tr_b16 v[188:189], v12 offset:10240
    v_mfma_f32_16x16x32_bf16 v[58:61], v[206:209], v[178:181], v[58:61]
    ds_read_b64_tr_b16 v[190:191], v13 offset:8192
    v_mfma_f32_16x16x32_bf16 v[74:77], v[206:209], v[182:185], v[74:77]
    ds_read_b64_tr_b16 v[192:193], v13 offset:10240
    v_mfma_f32_16x16x32_bf16 v[30:33], v[210:213], v[170:173], v[30:33]
    ds_read_b64_tr_b16 v[194:195], v14 offset:8192
    v_mfma_f32_16x16x32_bf16 v[46:49], v[210:213], v[174:177], v[46:49]
    ds_read_b64_tr_b16 v[196:197], v14 offset:10240
    v_mfma_f32_16x16x32_bf16 v[62:65], v[210:213], v[178:181], v[62:65]
    ds_read_b64_tr_b16 v[198:199], v15 offset:8192
    v_mfma_f32_16x16x32_bf16 v[78:81], v[210:213], v[182:185], v[78:81]
    ds_read_b64_tr_b16 v[200:201], v15 offset:10240
    v_mfma_f32_16x16x32_bf16 v[34:37], v[214:217], v[170:173], v[34:37]
    v_add_u32 v10, 49152, v10
    v_add_u32 v12, 49152, v12
    v_mfma_f32_16x16x32_bf16 v[50:53], v[214:217], v[174:177], v[50:53]
    v_add_u32 v13, 49152, v13
    v_mfma_f32_16x16x32_bf16 v[66:69], v[214:217], v[178:181], v[66:69]
    v_add_u32 v14, 49152, v14
    v_mfma_f32_16x16x32_bf16 v[82:85], v[214:217], v[182:185], v[82:85]
    v_add_u32 v15, 49152, v15
    .p2align 3
    s_waitcnt lgkmcnt(0)
    s_barrier
    v_mfma_f32_16x16x32_bf16 v[22:25], v[186:189], v[154:157], v[22:25]
    ds_read_b128 v[170:173], v10 offset:0
    v_mfma_f32_16x16x32_bf16 v[38:41], v[186:189], v[158:161], v[38:41]
    ds_read_b128 v[174:177], v10 offset:1024
    v_mfma_f32_16x16x32_bf16 v[54:57], v[186:189], v[162:165], v[54:57]
    ds_read_b128 v[178:181], v10 offset:12288
    v_mfma_f32_16x16x32_bf16 v[70:73], v[186:189], v[166:169], v[70:73]
    ds_read_b128 v[182:185], v10 offset:13312
    v_mfma_f32_16x16x32_bf16 v[26:29], v[190:193], v[154:157], v[26:29]
    ds_read_b64_tr_b16 v[202:203], v12 offset:0
    v_mfma_f32_16x16x32_bf16 v[42:45], v[190:193], v[158:161], v[42:45]
    ds_read_b64_tr_b16 v[204:205], v12 offset:2048
    v_mfma_f32_16x16x32_bf16 v[58:61], v[190:193], v[162:165], v[58:61]
    ds_read_b64_tr_b16 v[206:207], v13 offset:0
    v_mfma_f32_16x16x32_bf16 v[74:77], v[190:193], v[166:169], v[74:77]
    ds_read_b64_tr_b16 v[208:209], v13 offset:2048
    v_mfma_f32_16x16x32_bf16 v[30:33], v[194:197], v[154:157], v[30:33]
    ds_read_b64_tr_b16 v[210:211], v14 offset:0
    v_mfma_f32_16x16x32_bf16 v[46:49], v[194:197], v[158:161], v[46:49]
    ds_read_b64_tr_b16 v[212:213], v14 offset:2048
    v_mfma_f32_16x16x32_bf16 v[62:65], v[194:197], v[162:165], v[62:65]
    ds_read_b64_tr_b16 v[214:215], v15 offset:0
    v_mfma_f32_16x16x32_bf16 v[78:81], v[194:197], v[166:169], v[78:81]
    ds_read_b64_tr_b16 v[216:217], v15 offset:2048
    v_mfma_f32_16x16x32_bf16 v[34:37], v[198:201], v[154:157], v[34:37]
    v_mov_b32 v89, s45
    v_mov_b32 v93, s45
    v_mfma_f32_16x16x32_bf16 v[50:53], v[198:201], v[158:161], v[50:53]
    v_mov_b32 v97, s45
    v_mfma_f32_16x16x32_bf16 v[66:69], v[198:201], v[162:165], v[66:69]
    v_mov_b32 v101, s45
    v_mfma_f32_16x16x32_bf16 v[82:85], v[198:201], v[166:169], v[82:85]
    .p2align 3
    s_waitcnt lgkmcnt(0)
    s_nop 0
    v_mfma_f32_16x16x32_bf16 v[22:25], v[202:205], v[170:173], v[22:25]
    ds_read_b128 v[154:157], v10 offset:2048
    v_mfma_f32_16x16x32_bf16 v[38:41], v[202:205], v[174:177], v[38:41]
    ds_read_b128 v[158:161], v10 offset:3072
    v_mfma_f32_16x16x32_bf16 v[54:57], v[202:205], v[178:181], v[54:57]
    ds_read_b128 v[162:165], v10 offset:14336
    v_mfma_f32_16x16x32_bf16 v[70:73], v[202:205], v[182:185], v[70:73]
    ds_read_b128 v[166:169], v10 offset:15360
    v_mfma_f32_16x16x32_bf16 v[26:29], v[206:209], v[170:173], v[26:29]
    ds_read_b64_tr_b16 v[186:187], v12 offset:4096
    v_mfma_f32_16x16x32_bf16 v[42:45], v[206:209], v[174:177], v[42:45]
    ds_read_b64_tr_b16 v[188:189], v12 offset:6144
    v_mfma_f32_16x16x32_bf16 v[58:61], v[206:209], v[178:181], v[58:61]
    ds_read_b64_tr_b16 v[190:191], v13 offset:4096
    v_mfma_f32_16x16x32_bf16 v[74:77], v[206:209], v[182:185], v[74:77]
    ds_read_b64_tr_b16 v[192:193], v13 offset:6144
    v_mfma_f32_16x16x32_bf16 v[30:33], v[210:213], v[170:173], v[30:33]
    ds_read_b64_tr_b16 v[194:195], v14 offset:4096
    v_mfma_f32_16x16x32_bf16 v[46:49], v[210:213], v[174:177], v[46:49]
    ds_read_b64_tr_b16 v[196:197], v14 offset:6144
    v_mfma_f32_16x16x32_bf16 v[62:65], v[210:213], v[178:181], v[62:65]
    ds_read_b64_tr_b16 v[198:199], v15 offset:4096
    v_mfma_f32_16x16x32_bf16 v[78:81], v[210:213], v[182:185], v[78:81]
    ds_read_b64_tr_b16 v[200:201], v15 offset:6144
    v_mfma_f32_16x16x32_bf16 v[34:37], v[214:217], v[170:173], v[34:37]
    v_mov_b32 v105, s45
    v_mov_b32 v107, s45
    v_mfma_f32_16x16x32_bf16 v[50:53], v[214:217], v[174:177], v[50:53]
    v_lshlrev_b32 v19, 3, v1
    v_mfma_f32_16x16x32_bf16 v[66:69], v[214:217], v[178:181], v[66:69]
    v_mfma_f32_16x16x32_bf16 v[82:85], v[214:217], v[182:185], v[82:85]
    .p2align 3
    s_waitcnt lgkmcnt(0)
    s_nop 0
    v_mfma_f32_16x16x32_bf16 v[22:25], v[186:189], v[154:157], v[22:25]
    ds_read_b128 v[170:173], v10 offset:4096
    v_mfma_f32_16x16x32_bf16 v[38:41], v[186:189], v[158:161], v[38:41]
    ds_read_b128 v[174:177], v10 offset:5120
    v_mfma_f32_16x16x32_bf16 v[54:57], v[186:189], v[162:165], v[54:57]
    ds_read_b128 v[178:181], v10 offset:16384
    v_mfma_f32_16x16x32_bf16 v[70:73], v[186:189], v[166:169], v[70:73]
    ds_read_b128 v[182:185], v10 offset:17408
    v_mfma_f32_16x16x32_bf16 v[26:29], v[190:193], v[154:157], v[26:29]
    ds_read_b64_tr_b16 v[202:203], v12 offset:8192
    v_mfma_f32_16x16x32_bf16 v[42:45], v[190:193], v[158:161], v[42:45]
    ds_read_b64_tr_b16 v[204:205], v12 offset:10240
    v_mfma_f32_16x16x32_bf16 v[58:61], v[190:193], v[162:165], v[58:61]
    ds_read_b64_tr_b16 v[206:207], v13 offset:8192
    v_mfma_f32_16x16x32_bf16 v[74:77], v[190:193], v[166:169], v[74:77]
    ds_read_b64_tr_b16 v[208:209], v13 offset:10240
    v_mfma_f32_16x16x32_bf16 v[30:33], v[194:197], v[154:157], v[30:33]
    ds_read_b64_tr_b16 v[210:211], v14 offset:8192
    v_mfma_f32_16x16x32_bf16 v[46:49], v[194:197], v[158:161], v[46:49]
    ds_read_b64_tr_b16 v[212:213], v14 offset:10240
    v_mfma_f32_16x16x32_bf16 v[62:65], v[194:197], v[162:165], v[62:65]
    ds_read_b64_tr_b16 v[214:215], v15 offset:8192
    v_mfma_f32_16x16x32_bf16 v[78:81], v[194:197], v[166:169], v[78:81]
    ds_read_b64_tr_b16 v[216:217], v15 offset:10240
    v_mfma_f32_16x16x32_bf16 v[34:37], v[198:201], v[154:157], v[34:37]
    v_add_u32 v10, 4294868992, v10
    v_add_u32 v12, 4294868992, v12
    v_mfma_f32_16x16x32_bf16 v[50:53], v[198:201], v[158:161], v[50:53]
    v_add_u32 v13, 4294868992, v13
    v_mfma_f32_16x16x32_bf16 v[66:69], v[198:201], v[162:165], v[66:69]
    v_add_u32 v14, 4294868992, v14
    v_mfma_f32_16x16x32_bf16 v[82:85], v[198:201], v[166:169], v[82:85]
    v_add_u32 v15, 4294868992, v15
    .p2align 3
    s_waitcnt lgkmcnt(0)
    s_barrier
    v_mfma_f32_16x16x32_bf16 v[22:25], v[202:205], v[170:173], v[22:25]
    ds_read_b128 v[154:157], v10 offset:0
    v_mfma_f32_16x16x32_bf16 v[38:41], v[202:205], v[174:177], v[38:41]
    ds_read_b128 v[158:161], v10 offset:1024
    v_mfma_f32_16x16x32_bf16 v[54:57], v[202:205], v[178:181], v[54:57]
    ds_read_b128 v[162:165], v10 offset:12288
    v_mfma_f32_16x16x32_bf16 v[70:73], v[202:205], v[182:185], v[70:73]
    ds_read_b128 v[166:169], v10 offset:13312
    v_mfma_f32_16x16x32_bf16 v[26:29], v[206:209], v[170:173], v[26:29]
    ds_read_b64_tr_b16 v[186:187], v12 offset:0
    v_mfma_f32_16x16x32_bf16 v[42:45], v[206:209], v[174:177], v[42:45]
    ds_read_b64_tr_b16 v[188:189], v12 offset:2048
    v_mfma_f32_16x16x32_bf16 v[58:61], v[206:209], v[178:181], v[58:61]
    ds_read_b64_tr_b16 v[190:191], v13 offset:0
    v_mfma_f32_16x16x32_bf16 v[74:77], v[206:209], v[182:185], v[74:77]
    ds_read_b64_tr_b16 v[192:193], v13 offset:2048
    v_mfma_f32_16x16x32_bf16 v[30:33], v[210:213], v[170:173], v[30:33]
    ds_read_b64_tr_b16 v[194:195], v14 offset:0
    v_mfma_f32_16x16x32_bf16 v[46:49], v[210:213], v[174:177], v[46:49]
    ds_read_b64_tr_b16 v[196:197], v14 offset:2048
    v_mfma_f32_16x16x32_bf16 v[62:65], v[210:213], v[178:181], v[62:65]
    ds_read_b64_tr_b16 v[198:199], v15 offset:0
    v_mfma_f32_16x16x32_bf16 v[78:81], v[210:213], v[182:185], v[78:81]
    ds_read_b64_tr_b16 v[200:201], v15 offset:2048
    v_mfma_f32_16x16x32_bf16 v[34:37], v[214:217], v[170:173], v[34:37]
    v_mfma_f32_16x16x32_bf16 v[50:53], v[214:217], v[174:177], v[50:53]
    v_mfma_f32_16x16x32_bf16 v[66:69], v[214:217], v[178:181], v[66:69]
    v_mfma_f32_16x16x32_bf16 v[82:85], v[214:217], v[182:185], v[82:85]
    .p2align 3
    s_waitcnt lgkmcnt(0)
    s_nop 0
    v_mfma_f32_16x16x32_bf16 v[22:25], v[186:189], v[154:157], v[22:25]
    ds_read_b128 v[170:173], v10 offset:2048
    v_mfma_f32_16x16x32_bf16 v[38:41], v[186:189], v[158:161], v[38:41]
    ds_read_b128 v[174:177], v10 offset:3072
    v_mfma_f32_16x16x32_bf16 v[54:57], v[186:189], v[162:165], v[54:57]
    ds_read_b128 v[178:181], v10 offset:14336
    v_mfma_f32_16x16x32_bf16 v[70:73], v[186:189], v[166:169], v[70:73]
    ds_read_b128 v[182:185], v10 offset:15360
    v_mfma_f32_16x16x32_bf16 v[26:29], v[190:193], v[154:157], v[26:29]
    ds_read_b64_tr_b16 v[202:203], v12 offset:4096
    v_mfma_f32_16x16x32_bf16 v[42:45], v[190:193], v[158:161], v[42:45]
    ds_read_b64_tr_b16 v[204:205], v12 offset:6144
    v_mfma_f32_16x16x32_bf16 v[58:61], v[190:193], v[162:165], v[58:61]
    ds_read_b64_tr_b16 v[206:207], v13 offset:4096
    v_mfma_f32_16x16x32_bf16 v[74:77], v[190:193], v[166:169], v[74:77]
    ds_read_b64_tr_b16 v[208:209], v13 offset:6144
    v_mfma_f32_16x16x32_bf16 v[30:33], v[194:197], v[154:157], v[30:33]
    ds_read_b64_tr_b16 v[210:211], v14 offset:4096
    v_mfma_f32_16x16x32_bf16 v[46:49], v[194:197], v[158:161], v[46:49]
    ds_read_b64_tr_b16 v[212:213], v14 offset:6144
    v_mfma_f32_16x16x32_bf16 v[62:65], v[194:197], v[162:165], v[62:65]
    ds_read_b64_tr_b16 v[214:215], v15 offset:4096
    v_mfma_f32_16x16x32_bf16 v[78:81], v[194:197], v[166:169], v[78:81]
    ds_read_b64_tr_b16 v[216:217], v15 offset:6144
    v_mfma_f32_16x16x32_bf16 v[34:37], v[198:201], v[154:157], v[34:37]
    v_mfma_f32_16x16x32_bf16 v[50:53], v[198:201], v[158:161], v[50:53]
    v_mfma_f32_16x16x32_bf16 v[66:69], v[198:201], v[162:165], v[66:69]
    v_mfma_f32_16x16x32_bf16 v[82:85], v[198:201], v[166:169], v[82:85]
    .p2align 3
    s_waitcnt lgkmcnt(0)
    s_nop 0
    v_mfma_f32_16x16x32_bf16 v[22:25], v[202:205], v[170:173], v[22:25]
    ds_read_b128 v[154:157], v10 offset:4096
    v_mfma_f32_16x16x32_bf16 v[38:41], v[202:205], v[174:177], v[38:41]
    ds_read_b128 v[158:161], v10 offset:5120
    v_mfma_f32_16x16x32_bf16 v[54:57], v[202:205], v[178:181], v[54:57]
    ds_read_b128 v[162:165], v10 offset:16384
    v_mfma_f32_16x16x32_bf16 v[70:73], v[202:205], v[182:185], v[70:73]
    ds_read_b128 v[166:169], v10 offset:17408
    v_mfma_f32_16x16x32_bf16 v[26:29], v[206:209], v[170:173], v[26:29]
    ds_read_b64_tr_b16 v[186:187], v12 offset:8192
    v_mfma_f32_16x16x32_bf16 v[42:45], v[206:209], v[174:177], v[42:45]
    ds_read_b64_tr_b16 v[188:189], v12 offset:10240
    v_mfma_f32_16x16x32_bf16 v[58:61], v[206:209], v[178:181], v[58:61]
    ds_read_b64_tr_b16 v[190:191], v13 offset:8192
    v_mfma_f32_16x16x32_bf16 v[74:77], v[206:209], v[182:185], v[74:77]
    ds_read_b64_tr_b16 v[192:193], v13 offset:10240
    v_mfma_f32_16x16x32_bf16 v[30:33], v[210:213], v[170:173], v[30:33]
    ds_read_b64_tr_b16 v[194:195], v14 offset:8192
    v_mfma_f32_16x16x32_bf16 v[46:49], v[210:213], v[174:177], v[46:49]
    ds_read_b64_tr_b16 v[196:197], v14 offset:10240
    v_mfma_f32_16x16x32_bf16 v[62:65], v[210:213], v[178:181], v[62:65]
    ds_read_b64_tr_b16 v[198:199], v15 offset:8192
    v_mfma_f32_16x16x32_bf16 v[78:81], v[210:213], v[182:185], v[78:81]
    ds_read_b64_tr_b16 v[200:201], v15 offset:10240
    v_mfma_f32_16x16x32_bf16 v[34:37], v[214:217], v[170:173], v[34:37]
    v_add_u32 v10, 49152, v10
    v_add_u32 v12, 49152, v12
    v_mfma_f32_16x16x32_bf16 v[50:53], v[214:217], v[174:177], v[50:53]
    v_add_u32 v13, 49152, v13
    v_mfma_f32_16x16x32_bf16 v[66:69], v[214:217], v[178:181], v[66:69]
    v_add_u32 v14, 49152, v14
    v_mfma_f32_16x16x32_bf16 v[82:85], v[214:217], v[182:185], v[82:85]
    v_add_u32 v15, 49152, v15
    .p2align 3
    s_waitcnt lgkmcnt(0)
    s_barrier
    v_mfma_f32_16x16x32_bf16 v[22:25], v[186:189], v[154:157], v[22:25]
    ds_read_b128 v[170:173], v10 offset:0
    v_mfma_f32_16x16x32_bf16 v[38:41], v[186:189], v[158:161], v[38:41]
    ds_read_b128 v[174:177], v10 offset:1024
    v_mfma_f32_16x16x32_bf16 v[54:57], v[186:189], v[162:165], v[54:57]
    ds_read_b128 v[178:181], v10 offset:12288
    v_mfma_f32_16x16x32_bf16 v[70:73], v[186:189], v[166:169], v[70:73]
    ds_read_b128 v[182:185], v10 offset:13312
    v_mfma_f32_16x16x32_bf16 v[26:29], v[190:193], v[154:157], v[26:29]
    ds_read_b64_tr_b16 v[202:203], v12 offset:0
    v_mfma_f32_16x16x32_bf16 v[42:45], v[190:193], v[158:161], v[42:45]
    ds_read_b64_tr_b16 v[204:205], v12 offset:2048
    v_mfma_f32_16x16x32_bf16 v[58:61], v[190:193], v[162:165], v[58:61]
    ds_read_b64_tr_b16 v[206:207], v13 offset:0
    v_mfma_f32_16x16x32_bf16 v[74:77], v[190:193], v[166:169], v[74:77]
    ds_read_b64_tr_b16 v[208:209], v13 offset:2048
    v_mfma_f32_16x16x32_bf16 v[30:33], v[194:197], v[154:157], v[30:33]
    ds_read_b64_tr_b16 v[210:211], v14 offset:0
    v_mfma_f32_16x16x32_bf16 v[46:49], v[194:197], v[158:161], v[46:49]
    ds_read_b64_tr_b16 v[212:213], v14 offset:2048
    v_mfma_f32_16x16x32_bf16 v[62:65], v[194:197], v[162:165], v[62:65]
    ds_read_b64_tr_b16 v[214:215], v15 offset:0
    v_mfma_f32_16x16x32_bf16 v[78:81], v[194:197], v[166:169], v[78:81]
    ds_read_b64_tr_b16 v[216:217], v15 offset:2048
    v_mfma_f32_16x16x32_bf16 v[34:37], v[198:201], v[154:157], v[34:37]
    v_mfma_f32_16x16x32_bf16 v[50:53], v[198:201], v[158:161], v[50:53]
    v_mfma_f32_16x16x32_bf16 v[66:69], v[198:201], v[162:165], v[66:69]
    v_mfma_f32_16x16x32_bf16 v[82:85], v[198:201], v[166:169], v[82:85]
    .p2align 3
    s_waitcnt lgkmcnt(0)
    s_nop 0
    v_mfma_f32_16x16x32_bf16 v[22:25], v[202:205], v[170:173], v[22:25]
    ds_read_b128 v[154:157], v10 offset:2048
    v_mfma_f32_16x16x32_bf16 v[38:41], v[202:205], v[174:177], v[38:41]
    ds_read_b128 v[158:161], v10 offset:3072
    v_mfma_f32_16x16x32_bf16 v[54:57], v[202:205], v[178:181], v[54:57]
    ds_read_b128 v[162:165], v10 offset:14336
    v_mfma_f32_16x16x32_bf16 v[70:73], v[202:205], v[182:185], v[70:73]
    ds_read_b128 v[166:169], v10 offset:15360
    v_mfma_f32_16x16x32_bf16 v[26:29], v[206:209], v[170:173], v[26:29]
    ds_read_b64_tr_b16 v[186:187], v12 offset:4096
    v_mfma_f32_16x16x32_bf16 v[42:45], v[206:209], v[174:177], v[42:45]
    ds_read_b64_tr_b16 v[188:189], v12 offset:6144
    v_mfma_f32_16x16x32_bf16 v[58:61], v[206:209], v[178:181], v[58:61]
    ds_read_b64_tr_b16 v[190:191], v13 offset:4096
    v_mfma_f32_16x16x32_bf16 v[74:77], v[206:209], v[182:185], v[74:77]
    ds_read_b64_tr_b16 v[192:193], v13 offset:6144
    v_mfma_f32_16x16x32_bf16 v[30:33], v[210:213], v[170:173], v[30:33]
    ds_read_b64_tr_b16 v[194:195], v14 offset:4096
    v_mfma_f32_16x16x32_bf16 v[46:49], v[210:213], v[174:177], v[46:49]
    ds_read_b64_tr_b16 v[196:197], v14 offset:6144
    v_mfma_f32_16x16x32_bf16 v[62:65], v[210:213], v[178:181], v[62:65]
    ds_read_b64_tr_b16 v[198:199], v15 offset:4096
    v_mfma_f32_16x16x32_bf16 v[78:81], v[210:213], v[182:185], v[78:81]
    ds_read_b64_tr_b16 v[200:201], v15 offset:6144
    v_mfma_f32_16x16x32_bf16 v[34:37], v[214:217], v[170:173], v[34:37]
    v_mfma_f32_16x16x32_bf16 v[50:53], v[214:217], v[174:177], v[50:53]
    v_mfma_f32_16x16x32_bf16 v[66:69], v[214:217], v[178:181], v[66:69]
    v_mfma_f32_16x16x32_bf16 v[82:85], v[214:217], v[182:185], v[82:85]
    .p2align 3
    s_waitcnt lgkmcnt(0)
    s_nop 0
    v_mfma_f32_16x16x32_bf16 v[22:25], v[186:189], v[154:157], v[22:25]
    ds_read_b128 v[170:173], v10 offset:4096
    v_mfma_f32_16x16x32_bf16 v[38:41], v[186:189], v[158:161], v[38:41]
    ds_read_b128 v[174:177], v10 offset:5120
    v_mfma_f32_16x16x32_bf16 v[54:57], v[186:189], v[162:165], v[54:57]
    ds_read_b128 v[178:181], v10 offset:16384
    v_mfma_f32_16x16x32_bf16 v[70:73], v[186:189], v[166:169], v[70:73]
    ds_read_b128 v[182:185], v10 offset:17408
    v_mfma_f32_16x16x32_bf16 v[26:29], v[190:193], v[154:157], v[26:29]
    ds_read_b64_tr_b16 v[202:203], v12 offset:8192
    v_mfma_f32_16x16x32_bf16 v[42:45], v[190:193], v[158:161], v[42:45]
    ds_read_b64_tr_b16 v[204:205], v12 offset:10240
    v_mfma_f32_16x16x32_bf16 v[58:61], v[190:193], v[162:165], v[58:61]
    ds_read_b64_tr_b16 v[206:207], v13 offset:8192
    v_mfma_f32_16x16x32_bf16 v[74:77], v[190:193], v[166:169], v[74:77]
    ds_read_b64_tr_b16 v[208:209], v13 offset:10240
    v_mfma_f32_16x16x32_bf16 v[30:33], v[194:197], v[154:157], v[30:33]
    ds_read_b64_tr_b16 v[210:211], v14 offset:8192
    v_mfma_f32_16x16x32_bf16 v[46:49], v[194:197], v[158:161], v[46:49]
    ds_read_b64_tr_b16 v[212:213], v14 offset:10240
    v_mfma_f32_16x16x32_bf16 v[62:65], v[194:197], v[162:165], v[62:65]
    ds_read_b64_tr_b16 v[214:215], v15 offset:8192
    v_mfma_f32_16x16x32_bf16 v[78:81], v[194:197], v[166:169], v[78:81]
    ds_read_b64_tr_b16 v[216:217], v15 offset:10240
    v_mfma_f32_16x16x32_bf16 v[34:37], v[198:201], v[154:157], v[34:37]
    v_add_u32 v10, 49152, v10
    v_add_u32 v12, 49152, v12
    v_mfma_f32_16x16x32_bf16 v[50:53], v[198:201], v[158:161], v[50:53]
    v_add_u32 v13, 49152, v13
    v_mfma_f32_16x16x32_bf16 v[66:69], v[198:201], v[162:165], v[66:69]
    v_add_u32 v14, 49152, v14
    v_mfma_f32_16x16x32_bf16 v[82:85], v[198:201], v[166:169], v[82:85]
    v_add_u32 v15, 49152, v15
    .p2align 3
    s_waitcnt lgkmcnt(0)
    s_barrier
    v_mfma_f32_16x16x32_bf16 v[22:25], v[202:205], v[170:173], v[22:25]
    ds_read_b128 v[154:157], v10 offset:0
    v_mfma_f32_16x16x32_bf16 v[38:41], v[202:205], v[174:177], v[38:41]
    ds_read_b128 v[158:161], v10 offset:1024
    v_mfma_f32_16x16x32_bf16 v[54:57], v[202:205], v[178:181], v[54:57]
    ds_read_b128 v[162:165], v10 offset:12288
    v_mfma_f32_16x16x32_bf16 v[70:73], v[202:205], v[182:185], v[70:73]
    ds_read_b128 v[166:169], v10 offset:13312
    v_mfma_f32_16x16x32_bf16 v[26:29], v[206:209], v[170:173], v[26:29]
    ds_read_b64_tr_b16 v[186:187], v12 offset:0
    v_mfma_f32_16x16x32_bf16 v[42:45], v[206:209], v[174:177], v[42:45]
    ds_read_b64_tr_b16 v[188:189], v12 offset:2048
    v_mfma_f32_16x16x32_bf16 v[58:61], v[206:209], v[178:181], v[58:61]
    ds_read_b64_tr_b16 v[190:191], v13 offset:0
    v_mfma_f32_16x16x32_bf16 v[74:77], v[206:209], v[182:185], v[74:77]
    ds_read_b64_tr_b16 v[192:193], v13 offset:2048
    v_mfma_f32_16x16x32_bf16 v[30:33], v[210:213], v[170:173], v[30:33]
    ds_read_b64_tr_b16 v[194:195], v14 offset:0
    v_mfma_f32_16x16x32_bf16 v[46:49], v[210:213], v[174:177], v[46:49]
    ds_read_b64_tr_b16 v[196:197], v14 offset:2048
    v_mfma_f32_16x16x32_bf16 v[62:65], v[210:213], v[178:181], v[62:65]
    ds_read_b64_tr_b16 v[198:199], v15 offset:0
    v_mfma_f32_16x16x32_bf16 v[78:81], v[210:213], v[182:185], v[78:81]
    ds_read_b64_tr_b16 v[200:201], v15 offset:2048
    v_mfma_f32_16x16x32_bf16 v[34:37], v[214:217], v[170:173], v[34:37]
    v_mfma_f32_16x16x32_bf16 v[50:53], v[214:217], v[174:177], v[50:53]
    v_mfma_f32_16x16x32_bf16 v[66:69], v[214:217], v[178:181], v[66:69]
    v_mfma_f32_16x16x32_bf16 v[82:85], v[214:217], v[182:185], v[82:85]
    .p2align 3
    s_waitcnt lgkmcnt(0)
    s_nop 0
    v_mfma_f32_16x16x32_bf16 v[22:25], v[186:189], v[154:157], v[22:25]
    ds_read_b128 v[170:173], v10 offset:2048
    v_mfma_f32_16x16x32_bf16 v[38:41], v[186:189], v[158:161], v[38:41]
    ds_read_b128 v[174:177], v10 offset:3072
    v_mfma_f32_16x16x32_bf16 v[54:57], v[186:189], v[162:165], v[54:57]
    ds_read_b128 v[178:181], v10 offset:14336
    v_mfma_f32_16x16x32_bf16 v[70:73], v[186:189], v[166:169], v[70:73]
    ds_read_b128 v[182:185], v10 offset:15360
    v_mfma_f32_16x16x32_bf16 v[26:29], v[190:193], v[154:157], v[26:29]
    ds_read_b64_tr_b16 v[202:203], v12 offset:4096
    v_mfma_f32_16x16x32_bf16 v[42:45], v[190:193], v[158:161], v[42:45]
    ds_read_b64_tr_b16 v[204:205], v12 offset:6144
    v_mfma_f32_16x16x32_bf16 v[58:61], v[190:193], v[162:165], v[58:61]
    ds_read_b64_tr_b16 v[206:207], v13 offset:4096
    v_mfma_f32_16x16x32_bf16 v[74:77], v[190:193], v[166:169], v[74:77]
    ds_read_b64_tr_b16 v[208:209], v13 offset:6144
    v_mfma_f32_16x16x32_bf16 v[30:33], v[194:197], v[154:157], v[30:33]
    ds_read_b64_tr_b16 v[210:211], v14 offset:4096
    v_mfma_f32_16x16x32_bf16 v[46:49], v[194:197], v[158:161], v[46:49]
    ds_read_b64_tr_b16 v[212:213], v14 offset:6144
    v_mfma_f32_16x16x32_bf16 v[62:65], v[194:197], v[162:165], v[62:65]
    ds_read_b64_tr_b16 v[214:215], v15 offset:4096
    v_mfma_f32_16x16x32_bf16 v[78:81], v[194:197], v[166:169], v[78:81]
    ds_read_b64_tr_b16 v[216:217], v15 offset:6144
    v_mfma_f32_16x16x32_bf16 v[34:37], v[198:201], v[154:157], v[34:37]
    v_mfma_f32_16x16x32_bf16 v[50:53], v[198:201], v[158:161], v[50:53]
    v_mfma_f32_16x16x32_bf16 v[66:69], v[198:201], v[162:165], v[66:69]
    v_mfma_f32_16x16x32_bf16 v[82:85], v[198:201], v[166:169], v[82:85]
    .p2align 3
    s_waitcnt lgkmcnt(0)
    s_nop 0
    v_mfma_f32_16x16x32_bf16 v[22:25], v[202:205], v[170:173], v[22:25]
    ds_read_b128 v[154:157], v10 offset:4096
    v_mfma_f32_16x16x32_bf16 v[38:41], v[202:205], v[174:177], v[38:41]
    ds_read_b128 v[158:161], v10 offset:5120
    v_mfma_f32_16x16x32_bf16 v[54:57], v[202:205], v[178:181], v[54:57]
    ds_read_b128 v[162:165], v10 offset:16384
    v_mfma_f32_16x16x32_bf16 v[70:73], v[202:205], v[182:185], v[70:73]
    ds_read_b128 v[166:169], v10 offset:17408
    v_mfma_f32_16x16x32_bf16 v[26:29], v[206:209], v[170:173], v[26:29]
    ds_read_b64_tr_b16 v[186:187], v12 offset:8192
    v_mfma_f32_16x16x32_bf16 v[42:45], v[206:209], v[174:177], v[42:45]
    ds_read_b64_tr_b16 v[188:189], v12 offset:10240
    v_mfma_f32_16x16x32_bf16 v[58:61], v[206:209], v[178:181], v[58:61]
    ds_read_b64_tr_b16 v[190:191], v13 offset:8192
    v_mfma_f32_16x16x32_bf16 v[74:77], v[206:209], v[182:185], v[74:77]
    ds_read_b64_tr_b16 v[192:193], v13 offset:10240
    v_mfma_f32_16x16x32_bf16 v[30:33], v[210:213], v[170:173], v[30:33]
    ds_read_b64_tr_b16 v[194:195], v14 offset:8192
    v_mfma_f32_16x16x32_bf16 v[46:49], v[210:213], v[174:177], v[46:49]
    ds_read_b64_tr_b16 v[196:197], v14 offset:10240
    v_mfma_f32_16x16x32_bf16 v[62:65], v[210:213], v[178:181], v[62:65]
    ds_read_b64_tr_b16 v[198:199], v15 offset:8192
    v_mfma_f32_16x16x32_bf16 v[78:81], v[210:213], v[182:185], v[78:81]
    ds_read_b64_tr_b16 v[200:201], v15 offset:10240
    v_mfma_f32_16x16x32_bf16 v[34:37], v[214:217], v[170:173], v[34:37]
    v_mfma_f32_16x16x32_bf16 v[50:53], v[214:217], v[174:177], v[50:53]
    v_mfma_f32_16x16x32_bf16 v[66:69], v[214:217], v[178:181], v[66:69]
    v_mfma_f32_16x16x32_bf16 v[82:85], v[214:217], v[182:185], v[82:85]
    s_waitcnt lgkmcnt(0)
    v_mfma_f32_16x16x32_bf16 v[54:57], v[186:189], v[162:165], v[54:57]
    v_mfma_f32_16x16x32_bf16 v[70:73], v[186:189], v[166:169], v[70:73]
    v_mfma_f32_16x16x32_bf16 v[58:61], v[190:193], v[162:165], v[58:61]
    v_mfma_f32_16x16x32_bf16 v[74:77], v[190:193], v[166:169], v[74:77]
    v_mfma_f32_16x16x32_bf16 v[62:65], v[194:197], v[162:165], v[62:65]
    v_mfma_f32_16x16x32_bf16 v[78:81], v[194:197], v[166:169], v[78:81]
    v_mfma_f32_16x16x32_bf16 v[66:69], v[198:201], v[162:165], v[66:69]
    v_mfma_f32_16x16x32_bf16 v[82:85], v[198:201], v[166:169], v[82:85]
    v_mfma_f32_16x16x32_bf16 v[22:25], v[186:189], v[154:157], v[22:25]
    v_mfma_f32_16x16x32_bf16 v[38:41], v[186:189], v[158:161], v[38:41]
    v_mfma_f32_16x16x32_bf16 v[26:29], v[190:193], v[154:157], v[26:29]
    v_mfma_f32_16x16x32_bf16 v[42:45], v[190:193], v[158:161], v[42:45]
    v_mfma_f32_16x16x32_bf16 v[30:33], v[194:197], v[154:157], v[30:33]
    v_cvt_pk_bf16_f32 v86, v54, v55
    v_cvt_pk_bf16_f32 v87, v56, v57
    v_mfma_f32_16x16x32_bf16 v[46:49], v[194:197], v[158:161], v[46:49]
    v_cvt_pk_bf16_f32 v96, v70, v71
    v_cvt_pk_bf16_f32 v98, v72, v73
    v_mfma_f32_16x16x32_bf16 v[34:37], v[198:201], v[154:157], v[34:37]
    v_cvt_pk_bf16_f32 v88, v58, v59
    v_cvt_pk_bf16_f32 v90, v60, v61
    v_mfma_f32_16x16x32_bf16 v[50:53], v[198:201], v[158:161], v[50:53]
    v_cvt_pk_bf16_f32 v99, v74, v75
    v_cvt_pk_bf16_f32 v100, v76, v77
    v_cvt_pk_bf16_f32 v91, v62, v63
    v_cvt_pk_bf16_f32 v92, v64, v65
    v_cvt_pk_bf16_f32 v102, v78, v79
    v_cvt_pk_bf16_f32 v103, v80, v81
    v_cvt_pk_bf16_f32 v94, v66, v67
    v_cvt_pk_bf16_f32 v95, v68, v69
    v_cvt_pk_bf16_f32 v104, v82, v83
    v_cvt_pk_bf16_f32 v106, v84, v85
    buffer_store_dwordx4 v[86:89], v2, s[24:27], s56 offen offset:0 sc1
    buffer_store_dwordx4 v[90:93], v2, s[24:27], s56 offen offset:1024 sc1
    buffer_store_dwordx4 v[94:97], v2, s[24:27], s56 offen offset:2048 sc1
    buffer_store_dwordx4 v[98:101], v2, s[24:27], s56 offen offset:3072 sc1
    s_add_u32 s47, s56, 4096
    buffer_store_dwordx4 v[102:105], v2, s[24:27], s47 offen sc1
    buffer_store_dwordx2 v[106:107], v19, s[24:27], s47 offen offset:1024 sc1
    s_mul_i32 s47, s54, 49152
    v_add_u32 v10, s47, v2
    s_mov_b32 s50, 0
    s_waitcnt vmcnt(0)
    buffer_load_dwordx4 v[108:111], v2, s[24:27], s57 offen offset:0 sc1
    buffer_load_dwordx4 v[112:115], v2, s[24:27], s57 offen offset:1024 sc1
    buffer_load_dwordx4 v[116:119], v2, s[24:27], s57 offen offset:2048 sc1
    buffer_load_dwordx4 v[120:123], v2, s[24:27], s57 offen offset:3072 sc1
    s_add_u32 s47, s57, 4096
    buffer_load_dwordx4 v[124:127], v2, s[24:27], s47 offen sc1
    buffer_load_dwordx2 v[128:129], v19, s[24:27], s47 offen offset:1024 sc1
    s_barrier
    ds_read_b128 v[154:157], v10 offset:0
    ds_read_b128 v[158:161], v10 offset:1024
    ds_read_b128 v[162:165], v10 offset:2048
    ds_read_b128 v[166:169], v10 offset:3072
    ds_read_b128 v[170:173], v10 offset:22528
    ds_read_b128 v[174:177], v10 offset:23552
    ds_read_b128 v[178:181], v10 offset:24576
    ds_read_b128 v[182:185], v10 offset:25600
    ds_read_b128 v[186:189], v10 offset:10240
    ds_read_b128 v[190:193], v10 offset:11264
    ds_read_b128 v[194:197], v10 offset:12288
    ds_read_b128 v[198:201], v10 offset:13312
    ds_read_b128 v[202:205], v10 offset:32768
    ds_read_b128 v[206:209], v10 offset:33792
    s_waitcnt lgkmcnt(13)
    v_mfma_f32_16x16x32_bf16 v[22:25], v[154:157], v[138:141], v[22:25]
    v_mfma_f32_16x16x32_bf16 v[38:41], v[154:157], v[142:145], v[38:41]
    ds_read_b128 v[210:213], v10 offset:34816
    s_waitcnt lgkmcnt(13)
    v_mfma_f32_16x16x32_bf16 v[26:29], v[158:161], v[138:141], v[26:29]
    v_mfma_f32_16x16x32_bf16 v[42:45], v[158:161], v[142:145], v[42:45]
    ds_read_b128 v[214:217], v10 offset:35840
    s_waitcnt lgkmcnt(13)
    v_mfma_f32_16x16x32_bf16 v[30:33], v[162:165], v[138:141], v[30:33]
    v_mfma_f32_16x16x32_bf16 v[46:49], v[162:165], v[142:145], v[46:49]
    s_waitcnt lgkmcnt(12)
    v_mfma_f32_16x16x32_bf16 v[34:37], v[166:169], v[138:141], v[34:37]
    v_mfma_f32_16x16x32_bf16 v[50:53], v[166:169], v[142:145], v[50:53]
    s_waitcnt lgkmcnt(11)
    v_mfma_f32_16x16x32_bf16 v[22:25], v[170:173], v[146:149], v[22:25]
    v_mfma_f32_16x16x32_bf16 v[38:41], v[170:173], v[150:153], v[38:41]
    s_waitcnt lgkmcnt(10)
    v_mfma_f32_16x16x32_bf16 v[26:29], v[174:177], v[146:149], v[26:29]
    v_mfma_f32_16x16x32_bf16 v[42:45], v[174:177], v[150:153], v[42:45]
    s_waitcnt lgkmcnt(9)
    v_mfma_f32_16x16x32_bf16 v[30:33], v[178:181], v[146:149], v[30:33]
    v_mfma_f32_16x16x32_bf16 v[46:49], v[178:181], v[150:153], v[46:49]
    s_waitcnt lgkmcnt(8)
    v_mfma_f32_16x16x32_bf16 v[34:37], v[182:185], v[146:149], v[34:37]
    v_mfma_f32_16x16x32_bf16 v[50:53], v[182:185], v[150:153], v[50:53]
    s_waitcnt lgkmcnt(7)
    v_mfma_f32_16x16x32_bf16 v[22:25], v[186:189], v[138:141], v[22:25]
    v_mfma_f32_16x16x32_bf16 v[38:41], v[186:189], v[142:145], v[38:41]
    s_waitcnt lgkmcnt(6)
    v_mfma_f32_16x16x32_bf16 v[26:29], v[190:193], v[138:141], v[26:29]
    v_mfma_f32_16x16x32_bf16 v[42:45], v[190:193], v[142:145], v[42:45]
    s_waitcnt lgkmcnt(5)
    v_mfma_f32_16x16x32_bf16 v[30:33], v[194:197], v[138:141], v[30:33]
    v_mfma_f32_16x16x32_bf16 v[46:49], v[194:197], v[142:145], v[46:49]
    s_waitcnt lgkmcnt(4)
    v_mfma_f32_16x16x32_bf16 v[34:37], v[198:201], v[138:141], v[34:37]
    v_mfma_f32_16x16x32_bf16 v[50:53], v[198:201], v[142:145], v[50:53]
    s_waitcnt lgkmcnt(3)
    v_mfma_f32_16x16x32_bf16 v[22:25], v[202:205], v[146:149], v[22:25]
    v_mfma_f32_16x16x32_bf16 v[38:41], v[202:205], v[150:153], v[38:41]
    s_waitcnt lgkmcnt(2)
    v_mfma_f32_16x16x32_bf16 v[26:29], v[206:209], v[146:149], v[26:29]
    v_mfma_f32_16x16x32_bf16 v[42:45], v[206:209], v[150:153], v[42:45]
    s_waitcnt lgkmcnt(1)
    v_mfma_f32_16x16x32_bf16 v[30:33], v[210:213], v[146:149], v[30:33]
    v_mfma_f32_16x16x32_bf16 v[46:49], v[210:213], v[150:153], v[46:49]
    s_waitcnt lgkmcnt(0)
    v_mfma_f32_16x16x32_bf16 v[34:37], v[214:217], v[146:149], v[34:37]
    v_mfma_f32_16x16x32_bf16 v[50:53], v[214:217], v[150:153], v[50:53]
    s_branch S_zf
S_z:
    s_sleep 4
    buffer_load_dwordx4 v[108:111], v2, s[24:27], s57 offen offset:0 sc1
    buffer_load_dwordx4 v[112:115], v2, s[24:27], s57 offen offset:1024 sc1
    buffer_load_dwordx4 v[116:119], v2, s[24:27], s57 offen offset:2048 sc1
    buffer_load_dwordx4 v[120:123], v2, s[24:27], s57 offen offset:3072 sc1
    s_add_u32 s47, s57, 4096
    buffer_load_dwordx4 v[124:127], v2, s[24:27], s47 offen sc1
    buffer_load_dwordx2 v[128:129], v19, s[24:27], s47 offen offset:1024 sc1
S_zf:
    s_add_u32 s50, s50, 1
    s_waitcnt vmcnt(0)
    v_xor_b32 v3, v6, v111
    v_xor_b32 v4, v6, v115
    v_xor_b32 v5, v6, v119
    v_or3_b32 v3, v3, v4, v5
    v_xor_b32 v4, v6, v123
    v_xor_b32 v5, v6, v127
    v_or3_b32 v3, v3, v4, v5
    v_xor_b32 v4, v6, v129
    v_or_b32 v3, v3, v4
    v_cmp_ne_u32 vcc, 0, v3
    s_cmp_ge_u32 s50, 131072
    s_cbranch_scc1 S_z_ok
    s_cbranch_vccnz S_z
S_z_ok:
    s_lshl_b32 s47, s40, 12
    s_add_u32 s47, s47, 147456
    v_add_u32 v5, s47, v2
    v_lshlrev_b32 v130, 16, v108
    v_and_b32 v131, 0xffff0000, v108
    v_lshlrev_b32 v132, 16, v109
    v_and_b32 v133, 0xffff0000, v109
    v_pk_add_f32 v[22:23], v[22:23], v[130:131]
    v_pk_add_f32 v[24:25], v[24:25], v[132:133]
    v_cvt_pk_bf16_f32 v22, v22, v23
    v_cvt_pk_bf16_f32 v23, v24, v25
    ds_write_b64 v17, v[22:23] offset:0
    v_lshlrev_b32 v130, 16, v110
    v_and_b32 v131, 0xffff0000, v110
    v_lshlrev_b32 v132, 16, v112
    v_and_b32 v133, 0xffff0000, v112
    v_pk_add_f32 v[26:27], v[26:27], v[130:131]
    v_pk_add_f32 v[28:29], v[28:29], v[132:133]
    v_xor_b32 v4, 32, v17
    v_cvt_pk_bf16_f32 v26, v26, v27
    v_cvt_pk_bf16_f32 v27, v28, v29
    ds_write_b64 v4, v[26:27] offset:0
    v_lshlrev_b32 v130, 16, v113
    v_and_b32 v131, 0xffff0000, v113
    v_lshlrev_b32 v132, 16, v114
    v_and_b32 v133, 0xffff0000, v114
    v_pk_add_f32 v[30:31], v[30:31], v[130:131]
    v_pk_add_f32 v[32:33], v[32:33], v[132:133]
    v_xor_b32 v4, 64, v17
    v_cvt_pk_bf16_f32 v30, v30, v31
    v_cvt_pk_bf16_f32 v31, v32, v33
    ds_write_b64 v4, v[30:31] offset:0
    v_lshlrev_b32 v130, 16, v116
    v_and_b32 v131, 0xffff0000, v116
    v_lshlrev_b32 v132, 16, v117
    v_and_b32 v133, 0xffff0000, v117
    v_pk_add_f32 v[34:35], v[34:35], v[130:131]
    v_pk_add_f32 v[36:37], v[36:37], v[132:133]
    v_xor_b32 v4, 96, v17
    v_cvt_pk_bf16_f32 v34, v34, v35
    v_cvt_pk_bf16_f32 v35, v36, v37
    ds_write_b64 v4, v[34:35] offset:0
    ds_read_b128 v[86:89], v5 offset:0
    ds_read_b128 v[90:93], v5 offset:1024
    v_lshlrev_b32 v130, 16, v118
    v_and_b32 v131, 0xffff0000, v118
    v_lshlrev_b32 v132, 16, v120
    v_and_b32 v133, 0xffff0000, v120
    v_pk_add_f32 v[38:39], v[38:39], v[130:131]
    v_pk_add_f32 v[40:41], v[40:41], v[132:133]
    v_cvt_pk_bf16_f32 v38, v38, v39
    v_cvt_pk_bf16_f32 v39, v40, v41
    ds_write_b64 v17, v[38:39] offset:2048
    v_lshlrev_b32 v130, 16, v121
    v_and_b32 v131, 0xffff0000, v121
    v_lshlrev_b32 v132, 16, v122
    v_and_b32 v133, 0xffff0000, v122
    v_pk_add_f32 v[42:43], v[42:43], v[130:131]
    v_pk_add_f32 v[44:45], v[44:45], v[132:133]
    v_xor_b32 v4, 32, v17
    v_cvt_pk_bf16_f32 v42, v42, v43
    v_cvt_pk_bf16_f32 v43, v44, v45
    ds_write_b64 v4, v[42:43] offset:2048
    v_lshlrev_b32 v130, 16, v124
    v_and_b32 v131, 0xffff0000, v124
    v_lshlrev_b32 v132, 16, v125
    v_and_b32 v133, 0xffff0000, v125
    v_pk_add_f32 v[46:47], v[46:47], v[130:131]
    v_pk_add_f32 v[48:49], v[48:49], v[132:133]
    v_xor_b32 v4, 64, v17
    v_cvt_pk_bf16_f32 v46, v46, v47
    v_cvt_pk_bf16_f32 v47, v48, v49
    ds_write_b64 v4, v[46:47] offset:2048
    v_lshlrev_b32 v130, 16, v126
    v_and_b32 v131, 0xffff0000, v126
    v_lshlrev_b32 v132, 16, v128
    v_and_b32 v133, 0xffff0000, v128
    v_pk_add_f32 v[50:51], v[50:51], v[130:131]
    v_pk_add_f32 v[52:53], v[52:53], v[132:133]
    v_xor_b32 v4, 96, v17
    v_cvt_pk_bf16_f32 v50, v50, v51
    v_cvt_pk_bf16_f32 v51, v52, v53
    ds_write_b64 v4, v[50:51] offset:2048
    ds_read_b128 v[94:97], v5 offset:2048
    ds_read_b128 v[98:101], v5 offset:3072
    s_waitcnt lgkmcnt(7)
    buffer_store_dwordx4 v[86:89], v16, s[32:35], s58 offen sc1
    s_add_u32 s58, s58, 655360
    s_waitcnt lgkmcnt(6)
    buffer_store_dwordx4 v[90:93], v16, s[32:35], s58 offen sc1
    s_add_u32 s58, s58, 655360
    s_waitcnt lgkmcnt(1)
    buffer_store_dwordx4 v[94:97], v16, s[32:35], s58 offen sc1
    s_add_u32 s58, s58, 655360
    s_waitcnt lgkmcnt(0)
    buffer_store_dwordx4 v[98:101], v16, s[32:35], s58 offen sc1
    s_add_u32 s58, s58, 655360
    s_endpgm
S_comp2a:
    s_mov_b32 s28, s18
    s_mov_b32 s29, s19
    s_mov_b32 s30, 1280
    s_mov_b32 s31, 0x20000
    v_lshlrev_b32 v5, 3, v9
    buffer_load_dwordx2 v[228:229], v5, s[28:31], s59 offen offset:0
    buffer_load_dwordx2 v[230:231], v5, s[28:31], s59 offen offset:32
    buffer_load_dwordx2 v[232:233], v5, s[28:31], s59 offen offset:64
    buffer_load_dwordx2 v[234:235], v5, s[28:31], s59 offen offset:96
    s_waitcnt vmcnt(0)
    s_branch S_comp2
S_sretry:
    s_add_u32 s50, s50, 1
    s_cmp_ge_u32 s50, 131072
    s_cbranch_scc1 S_sok
    s_sleep 2
    buffer_load_dwordx2 v[204:205], v5, s[28:31], 0 offen offset:0 sc1
    buffer_load_dwordx2 v[206:207], v5, s[28:31], 0 offen offset:128 sc1
    buffer_load_dwordx2 v[208:209], v5, s[28:31], 0 offen offset:256 sc1
    buffer_load_dwordx2 v[210:211], v5, s[28:31], 0 offen offset:384 sc1
    buffer_load_dwordx4 v[212:215], v252, s[32:35], 0 offen offset:0 sc1
    buffer_load_dwordx4 v[216:219], v252, s[32:35], 0 offen offset:256 sc1
    buffer_load_dwordx4 v[220:223], v252, s[32:35], 0 offen offset:512 sc1
    buffer_load_dwordx4 v[224:227], v252, s[32:35], 0 offen offset:768 sc1
    buffer_load_dwordx4 v[228:231], v252, s[32:35], 0 offen offset:1024 sc1
    buffer_load_dwordx4 v[232:235], v252, s[32:35], 0 offen offset:1280 sc1
    s_waitcnt vmcnt(0)
    v_xor_b32 v3, v6, v205
    v_xor_b32 v4, v6, v207
    v_xor_b32 v244, v6, v209
    v_or3_b32 v3, v3, v4, v244
    v_xor_b32 v4, v6, v211
    v_xor_b32 v244, v6, v215
    v_or3_b32 v3, v3, v4, v244
    v_xor_b32 v4, v6, v219
    v_xor_b32 v244, v6, v223
    v_or3_b32 v3, v3, v4, v244
    v_xor_b32 v4, v6, v227
    v_xor_b32 v244, v6, v231
    v_or3_b32 v3, v3, v4, v244
    v_xor_b32 v4, v6, v235
    v_or_b32 v3, v3, v4
    v_cmp_ne_u32 vcc, 0, v3
    s_cbranch_vccnz S_sretry
    s_branch S_sok
S_t1:
    v_and_b32 v8, 31, v1
    v_lshrrev_b32 v9, 5, v1
    s_mul_i32 s54, s42, 3
    s_add_u32 s54, s54, s44
    s_sub_u32 s54, s54, 5
    s_lshl_b32 s47, s54, 5
    v_add_u32 v34, s47, v8
    v_cmp_eq_u32 s[52:53], 0, v34
    v_cvt_f32_u32 v37, v34
    v_mul_f32 v37, 0x3acccccd, v37
    v_mov_b32 v4, 0x3e800000
    v_cndmask_b32 v177, v37, v4, s[52:53]
    s_and_b32 s48, s40, 1
    s_cmp_eq_u32 s48, 0
    s_cselect_b32 s49, 0x3e800000, 0
    v_mov_b32 v4, s49
    v_cndmask_b32 v178, 0, v4, s[52:53]
    s_lshr_b32 s49, s40, 1
    s_lshl_b32 s49, s49, 5
    s_add_u32 s49, s49, s48
    s_cmp_ge_u32 s46, 5
    s_cselect_b32 s48, -5, 5
    s_add_u32 s48, s48, s46
    s_lshl_b32 s48, s48, 6
    s_add_u32 s49, s49, s48
    v_lshl_add_u32 v3, v9, 3, s49
    v_add_u32 v14, 65536, v2
    s_lshl_b32 s47, s40, 11
    v_add_u32 v176, s47, v14
    v_cvt_f32_u32 v3, v3
    v_mul_f32 v38, v3, v37
    v_fma_f32 v179, v3, v177, v178
    v_mul_f32 v3, 0x42800000, v37
    v_cos_f32 v3, v3
    s_nop 0
    v_add_f32 v180, v3, v3
    v_add_f32 v181, v3, v3
    v_fmamk_f32 v41, v37, 0x40000000, v38
    v_fmamk_f32 v49, v177, 0x40000000, v179
    v_fmamk_f32 v42, v37, 0x40800000, v38
    v_fmamk_f32 v50, v177, 0x40800000, v179
    v_fmamk_f32 v43, v37, 0x40c00000, v38
    v_fmamk_f32 v51, v177, 0x40c00000, v179
    v_fmamk_f32 v44, v37, 0x41800000, v38
    v_fmamk_f32 v52, v177, 0x41800000, v179
    v_fmamk_f32 v45, v37, 0x41900000, v38
    v_fmamk_f32 v53, v177, 0x41900000, v179
    v_fmamk_f32 v46, v37, 0x41a00000, v38
    v_fmamk_f32 v54, v177, 0x41a00000, v179
    v_fmamk_f32 v47, v37, 0x41b00000, v38
    v_fmamk_f32 v55, v177, 0x41b00000, v179
    v_cos_f32 v40, v38
    v_sin_f32 v48, v179
    v_cos_f32 v41, v41
    v_sin_f32 v49, v49
    v_cos_f32 v42, v42
    v_sin_f32 v50, v50
    v_cos_f32 v43, v43
    v_sin_f32 v51, v51
    v_cos_f32 v44, v44
    v_sin_f32 v52, v52
    v_cos_f32 v45, v45
    v_sin_f32 v53, v53
    v_cos_f32 v46, v46
    v_sin_f32 v54, v54
    v_cos_f32 v47, v47
    v_sin_f32 v55, v55
    v_cvt_pk_bf16_f32 v72, v40, v41
    v_cvt_pk_bf16_f32 v73, v42, v43
    v_cvt_pk_bf16_f32 v74, v44, v45
    v_cvt_pk_bf16_f32 v75, v46, v47
    v_cvt_pk_bf16_f32 v76, v48, v49
    v_cvt_pk_bf16_f32 v77, v50, v51
    v_cvt_pk_bf16_f32 v78, v52, v53
    v_cvt_pk_bf16_f32 v79, v54, v55
    ds_write_b128 v176, v[72:75] offset:0
    ds_write_b128 v176, v[76:79] offset:1024
    v_fmamk_f32 v56, v37, 0x42800000, v38
    v_fmamk_f32 v64, v177, 0x42800000, v179
    v_fmamk_f32 v57, v37, 0x42840000, v38
    v_fmamk_f32 v65, v177, 0x42840000, v179
    v_fmamk_f32 v58, v37, 0x42880000, v38
    v_fmamk_f32 v66, v177, 0x42880000, v179
    v_fmamk_f32 v59, v37, 0x428c0000, v38
    v_fmamk_f32 v67, v177, 0x428c0000, v179
    v_fmamk_f32 v60, v37, 0x42a00000, v38
    v_fmamk_f32 v68, v177, 0x42a00000, v179
    v_fmamk_f32 v61, v37, 0x42a40000, v38
    v_fmamk_f32 v69, v177, 0x42a40000, v179
    v_fmamk_f32 v62, v37, 0x42a80000, v38
    v_fmamk_f32 v70, v177, 0x42a80000, v179
    v_fmamk_f32 v63, v37, 0x42ac0000, v38
    v_fmamk_f32 v71, v177, 0x42ac0000, v179
    v_cos_f32 v56, v56
    v_sin_f32 v64, v64
    v_cos_f32 v57, v57
    v_sin_f32 v65, v65
    v_cos_f32 v58, v58
    v_sin_f32 v66, v66
    v_cos_f32 v59, v59
    v_sin_f32 v67, v67
    v_cos_f32 v60, v60
    v_sin_f32 v68, v68
    v_cos_f32 v61, v61
    v_sin_f32 v69, v69
    v_cos_f32 v62, v62
    v_sin_f32 v70, v70
    v_cos_f32 v63, v63
    v_sin_f32 v71, v71
    v_cvt_pk_bf16_f32 v80, v56, v57
    v_cvt_pk_bf16_f32 v81, v58, v59
    v_cvt_pk_bf16_f32 v82, v60, v61
    v_cvt_pk_bf16_f32 v83, v62, v63
    v_cvt_pk_bf16_f32 v84, v64, v65
    v_cvt_pk_bf16_f32 v85, v66, v67
    v_cvt_pk_bf16_f32 v86, v68, v69
    v_cvt_pk_bf16_f32 v87, v70, v71
    ds_write_b128 v176, v[80:83] offset:8192
    ds_write_b128 v176, v[84:87] offset:9216
    v_pk_fma_f32 v[40:41], v[56:57], v[180:181], v[40:41] neg_lo:[0,0,1] neg_hi:[0,0,1]
    v_pk_fma_f32 v[42:43], v[58:59], v[180:181], v[42:43] neg_lo:[0,0,1] neg_hi:[0,0,1]
    v_pk_fma_f32 v[44:45], v[60:61], v[180:181], v[44:45] neg_lo:[0,0,1] neg_hi:[0,0,1]
    v_pk_fma_f32 v[46:47], v[62:63], v[180:181], v[46:47] neg_lo:[0,0,1] neg_hi:[0,0,1]
    v_pk_fma_f32 v[48:49], v[64:65], v[180:181], v[48:49] neg_lo:[0,0,1] neg_hi:[0,0,1]
    v_pk_fma_f32 v[50:51], v[66:67], v[180:181], v[50:51] neg_lo:[0,0,1] neg_hi:[0,0,1]
    v_pk_fma_f32 v[52:53], v[68:69], v[180:181], v[52:53] neg_lo:[0,0,1] neg_hi:[0,0,1]
    v_pk_fma_f32 v[54:55], v[70:71], v[180:181], v[54:55] neg_lo:[0,0,1] neg_hi:[0,0,1]
    v_cvt_pk_bf16_f32 v72, v40, v41
    v_cvt_pk_bf16_f32 v73, v42, v43
    v_cvt_pk_bf16_f32 v74, v44, v45
    v_cvt_pk_bf16_f32 v75, v46, v47
    v_cvt_pk_bf16_f32 v76, v48, v49
    v_cvt_pk_bf16_f32 v77, v50, v51
    v_cvt_pk_bf16_f32 v78, v52, v53
    v_cvt_pk_bf16_f32 v79, v54, v55
    ds_write_b128 v176, v[72:75] offset:16384
    ds_write_b128 v176, v[76:79] offset:17408
    v_pk_fma_f32 v[56:57], v[40:41], v[180:181], v[56:57] neg_lo:[0,0,1] neg_hi:[0,0,1]
    v_pk_fma_f32 v[58:59], v[42:43], v[180:181], v[58:59] neg_lo:[0,0,1] neg_hi:[0,0,1]
    v_pk_fma_f32 v[60:61], v[44:45], v[180:181], v[60:61] neg_lo:[0,0,1] neg_hi:[0,0,1]
    v_pk_fma_f32 v[62:63], v[46:47], v[180:181], v[62:63] neg_lo:[0,0,1] neg_hi:[0,0,1]
    v_pk_fma_f32 v[64:65], v[48:49], v[180:181], v[64:65] neg_lo:[0,0,1] neg_hi:[0,0,1]
    v_pk_fma_f32 v[66:67], v[50:51], v[180:181], v[66:67] neg_lo:[0,0,1] neg_hi:[0,0,1]
    v_pk_fma_f32 v[68:69], v[52:53], v[180:181], v[68:69] neg_lo:[0,0,1] neg_hi:[0,0,1]
    v_pk_fma_f32 v[70:71], v[54:55], v[180:181], v[70:71] neg_lo:[0,0,1] neg_hi:[0,0,1]
    v_cvt_pk_bf16_f32 v80, v56, v57
    v_cvt_pk_bf16_f32 v81, v58, v59
    v_cvt_pk_bf16_f32 v82, v60, v61
    v_cvt_pk_bf16_f32 v83, v62, v63
    v_cvt_pk_bf16_f32 v84, v64, v65
    v_cvt_pk_bf16_f32 v85, v66, v67
    v_cvt_pk_bf16_f32 v86, v68, v69
    v_cvt_pk_bf16_f32 v87, v70, v71
    ds_write_b128 v176, v[80:83] offset:24576
    ds_write_b128 v176, v[84:87] offset:25600
    v_pk_fma_f32 v[40:41], v[56:57], v[180:181], v[40:41] neg_lo:[0,0,1] neg_hi:[0,0,1]
    v_pk_fma_f32 v[42:43], v[58:59], v[180:181], v[42:43] neg_lo:[0,0,1] neg_hi:[0,0,1]
    v_pk_fma_f32 v[44:45], v[60:61], v[180:181], v[44:45] neg_lo:[0,0,1] neg_hi:[0,0,1]
    v_pk_fma_f32 v[46:47], v[62:63], v[180:181], v[46:47] neg_lo:[0,0,1] neg_hi:[0,0,1]
    v_pk_fma_f32 v[48:49], v[64:65], v[180:181], v[48:49] neg_lo:[0,0,1] neg_hi:[0,0,1]
    v_pk_fma_f32 v[50:51], v[66:67], v[180:181], v[50:51] neg_lo:[0,0,1] neg_hi:[0,0,1]
    v_pk_fma_f32 v[52:53], v[68:69], v[180:181], v[52:53] neg_lo:[0,0,1] neg_hi:[0,0,1]
    v_pk_fma_f32 v[54:55], v[70:71], v[180:181], v[54:55] neg_lo:[0,0,1] neg_hi:[0,0,1]
    v_cvt_pk_bf16_f32 v72, v40, v41
    v_cvt_pk_bf16_f32 v73, v42, v43
    v_cvt_pk_bf16_f32 v74, v44, v45
    v_cvt_pk_bf16_f32 v75, v46, v47
    v_cvt_pk_bf16_f32 v76, v48, v49
    v_cvt_pk_bf16_f32 v77, v50, v51
    v_cvt_pk_bf16_f32 v78, v52, v53
    v_cvt_pk_bf16_f32 v79, v54, v55
    ds_write_b128 v176, v[72:75] offset:32768
    ds_write_b128 v176, v[76:79] offset:33792
    s_waitcnt lgkmcnt(0)
    s_add_u32 s36, s22, 20578304
    s_addc_u32 s37, s23, 0
    s_mov_b32 s38, 289920
    s_mov_b32 s39, 0x20000
    s_load_dword s45, s[36:37], 289792
    s_add_u32 s24, s22, 7077888
    s_addc_u32 s25, s23, 0
    s_mov_b32 s26, 2883584
    s_mov_b32 s27, 0x20000
    s_add_u32 s28, s22, 20447232
    s_addc_u32 s29, s23, 0
    s_mov_b32 s30, 16384
    s_mov_b32 s31, 0x20000
    s_mov_b32 s56, 0x05040100
    s_mov_b32 s57, 0x07060302
    s_lshl_b32 s55, s43, 2
    s_add_u32 s55, s55, s40
    v_lshrrev_b32 v3, 1, v8
    v_and_b32 v4, 7, v3
    v_xor_b32 v4, v4, v9
    v_lshlrev_b32 v4, 4, v4
    v_lshl_add_u32 v4, v8, 7, v4
    s_lshl_b32 s47, s40, 12
    v_add_u32 v10, s47, v4
    v_xor_b32 v11, 32, v10
    v_xor_b32 v12, 64, v10
    v_xor_b32 v13, 96, v10
    v_lshlrev_b32 v15, 31, v1
    v_cndmask_b32 v16, 1.0, 0, s[52:53]
    v_cndmask_b32 v17, 1.0, 0, s[52:53]
    v_cvt_f32_u32 v3, v3
    v_mul_f32 v37, 0x3d000000, v3
    v_cvt_f32_u32 v5, s55
    v_mul_f32 v38, v5, v3
    v_mul_f32 v38, 0x3a000000, v38
    v_and_b32 v4, 1, v8
    v_cvt_f32_u32 v4, v4
    v_fmac_f32 v38, 0xbe800000, v4
    v_cmp_eq_u32 vcc, 1, v8
    v_cvt_f32_u32 v4, v9
    v_mul_f32 v4, 4.0, v4
    v_cndmask_b32 v37, v37, 0.5, vcc
    v_cndmask_b32 v38, v38, 0, vcc
    v_fmac_f32 v38, v4, v37
    v_cmp_gt_u32 vcc, 8, v8
    v_sub_u32 v4, 351, v34
    v_mul_u32_u24 v3, 360448, v9
    v_lshl_add_u32 v35, v4, 4, v3
    v_lshl_add_u32 v34, v34, 4, v3
    v_add_u32 v4, 2560, v34
    v_mov_b32 v3, 2130706432
    v_cndmask_b32 v36, v3, v4, vcc
    v_cmp_eq_u32 vcc, 0, v9
    v_mul_f32 v5, 0x3c000000, v5
    s_nop 0
    v_cndmask_b32 v5, 0, v5, vcc
    v_cos_f32 v18, v5
    v_sin_f32 v19, v5
    v_fmamk_f32 v161, v37, 0x3f800000, v38
    v_fmamk_f32 v162, v37, 0x40000000, v38
    v_fmamk_f32 v163, v37, 0x40400000, v38
    v_fmamk_f32 v164, v37, 0x41000000, v38
    v_fmamk_f32 v165, v37, 0x41100000, v38
    v_fmamk_f32 v166, v37, 0x41200000, v38
    v_fmamk_f32 v167, v37, 0x41300000, v38
    v_fmamk_f32 v168, v37, 0x41800000, v38
    v_fmamk_f32 v169, v37, 0x41880000, v38
    v_fmamk_f32 v170, v37, 0x41900000, v38
    v_fmamk_f32 v171, v37, 0x41980000, v38
    v_fmamk_f32 v172, v37, 0x41c00000, v38
    v_fmamk_f32 v173, v37, 0x41c80000, v38
    v_fmamk_f32 v174, v37, 0x41d00000, v38
    v_fmamk_f32 v175, v37, 0x41d80000, v38
    v_cos_f32 v160, v38
    v_cos_f32 v161, v161
    v_cos_f32 v162, v162
    v_cos_f32 v163, v163
    v_cos_f32 v164, v164
    v_cos_f32 v165, v165
    v_cos_f32 v166, v166
    v_cos_f32 v167, v167
    v_cos_f32 v168, v168
    v_cos_f32 v169, v169
    v_cos_f32 v170, v170
    v_cos_f32 v171, v171
    v_cos_f32 v172, v172
    v_cos_f32 v173, v173
    v_cos_f32 v174, v174
    v_cos_f32 v175, v175
    s_lshl_b32 s47, s55, 8
    v_lshl_add_u32 v20, v8, 3, s47
    .p2align 3
    s_waitcnt lgkmcnt(0)
    s_barrier
    ds_read_b128 v[104:107], v10 offset:0
    ds_read_b128 v[108:111], v11 offset:0
    ds_read_b128 v[120:123], v14 offset:0
    ds_read_b128 v[124:127], v14 offset:1024
    ds_read_b128 v[128:131], v14 offset:2048
    ds_read_b128 v[132:135], v14 offset:3072
    s_waitcnt lgkmcnt(0)
    s_nop 0
    v_perm_b32 v152, v105, v104, s56
    v_perm_b32 v153, v107, v106, s56
    v_perm_b32 v154, v109, v108, s56
    v_perm_b32 v155, v111, v110, s56
    v_perm_b32 v156, v105, v104, s57
    v_perm_b32 v157, v107, v106, s57
    v_mfma_f32_32x32x16_bf16 v[40:55], v[152:155], v[120:123], 0
    v_perm_b32 v158, v109, v108, s57
    v_perm_b32 v159, v111, v110, s57
    ds_read_b128 v[112:115], v12 offset:0
    ds_read_b128 v[116:119], v13 offset:0
    ds_read_b128 v[136:139], v14 offset:4096
    v_mfma_f32_32x32x16_bf16 v[56:71], v[152:155], v[124:127], 0
    ds_read_b128 v[140:143], v14 offset:5120
    ds_read_b128 v[144:147], v14 offset:6144
    ds_read_b128 v[148:151], v14 offset:7168
    v_mfma_f32_32x32x16_bf16 v[72:87], v[156:159], v[128:131], 0
    v_mfma_f32_32x32x16_bf16 v[88:103], v[156:159], v[132:135], 0
    .p2align 3
    s_waitcnt lgkmcnt(0)
    s_barrier
    v_perm_b32 v152, v113, v112, s56
    v_perm_b32 v153, v115, v114, s56
    v_perm_b32 v154, v117, v116, s56
    v_perm_b32 v155, v119, v118, s56
    v_perm_b32 v156, v113, v112, s57
    v_perm_b32 v157, v115, v114, s57
    v_mfma_f32_32x32x16_bf16 v[40:55], v[152:155], v[136:139], v[40:55]
    v_perm_b32 v158, v117, v116, s57
    v_perm_b32 v159, v119, v118, s57
    ds_read_b128 v[104:107], v10 offset:16384
    ds_read_b128 v[108:111], v11 offset:16384
    ds_read_b128 v[120:123], v14 offset:8192
    v_mfma_f32_32x32x16_bf16 v[56:71], v[152:155], v[140:143], v[56:71]
    ds_read_b128 v[124:127], v14 offset:9216
    ds_read_b128 v[128:131], v14 offset:10240
    ds_read_b128 v[132:135], v14 offset:11264
    v_mfma_f32_32x32x16_bf16 v[72:87], v[156:159], v[144:147], v[72:87]
    v_mfma_f32_32x32x16_bf16 v[88:103], v[156:159], v[148:151], v[88:103]
    s_waitcnt lgkmcnt(0)
    s_nop 0
    v_perm_b32 v152, v105, v104, s56
    v_perm_b32 v153, v107, v106, s56
    v_perm_b32 v154, v109, v108, s56
    v_perm_b32 v155, v111, v110, s56
    v_perm_b32 v156, v105, v104, s57
    v_perm_b32 v157, v107, v106, s57
    v_mfma_f32_32x32x16_bf16 v[40:55], v[152:155], v[120:123], v[40:55]
    v_perm_b32 v158, v109, v108, s57
    v_perm_b32 v159, v111, v110, s57
    ds_read_b128 v[112:115], v12 offset:16384
    ds_read_b128 v[116:119], v13 offset:16384
    ds_read_b128 v[136:139], v14 offset:12288
    v_mfma_f32_32x32x16_bf16 v[56:71], v[152:155], v[124:127], v[56:71]
    ds_read_b128 v[140:143], v14 offset:13312
    ds_read_b128 v[144:147], v14 offset:14336
    ds_read_b128 v[148:151], v14 offset:15360
    v_mfma_f32_32x32x16_bf16 v[72:87], v[156:159], v[128:131], v[72:87]
    v_mfma_f32_32x32x16_bf16 v[88:103], v[156:159], v[132:135], v[88:103]
    .p2align 3
    s_waitcnt lgkmcnt(0)
    s_barrier
    v_perm_b32 v152, v113, v112, s56
    v_perm_b32 v153, v115, v114, s56
    v_perm_b32 v154, v117, v116, s56
    v_perm_b32 v155, v119, v118, s56
    v_perm_b32 v156, v113, v112, s57
    v_perm_b32 v157, v115, v114, s57
    v_mfma_f32_32x32x16_bf16 v[40:55], v[152:155], v[136:139], v[40:55]
    v_perm_b32 v158, v117, v116, s57
    v_perm_b32 v159, v119, v118, s57
    ds_read_b128 v[104:107], v10 offset:32768
    ds_read_b128 v[108:111], v11 offset:32768
    ds_read_b128 v[120:123], v14 offset:16384
    v_mfma_f32_32x32x16_bf16 v[56:71], v[152:155], v[140:143], v[56:71]
    ds_read_b128 v[124:127], v14 offset:17408
    ds_read_b128 v[128:131], v14 offset:18432
    ds_read_b128 v[132:135], v14 offset:19456
    v_mfma_f32_32x32x16_bf16 v[72:87], v[156:159], v[144:147], v[72:87]
    v_mfma_f32_32x32x16_bf16 v[88:103], v[156:159], v[148:151], v[88:103]
    s_waitcnt lgkmcnt(0)
    s_nop 0
    v_perm_b32 v152, v105, v104, s56
    v_perm_b32 v153, v107, v106, s56
    v_perm_b32 v154, v109, v108, s56
    v_perm_b32 v155, v111, v110, s56
    v_perm_b32 v156, v105, v104, s57
    v_perm_b32 v157, v107, v106, s57
    v_mfma_f32_32x32x16_bf16 v[40:55], v[152:155], v[120:123], v[40:55]
    v_perm_b32 v158, v109, v108, s57
    v_perm_b32 v159, v111, v110, s57
    ds_read_b128 v[112:115], v12 offset:32768
    ds_read_b128 v[116:119], v13 offset:32768
    ds_read_b128 v[136:139], v14 offset:20480
    v_mfma_f32_32x32x16_bf16 v[56:71], v[152:155], v[124:127], v[56:71]
    ds_read_b128 v[140:143], v14 offset:21504
    ds_read_b128 v[144:147], v14 offset:22528
    ds_read_b128 v[148:151], v14 offset:23552
    v_mfma_f32_32x32x16_bf16 v[72:87], v[156:159], v[128:131], v[72:87]
    v_mfma_f32_32x32x16_bf16 v[88:103], v[156:159], v[132:135], v[88:103]
    .p2align 3
    s_waitcnt lgkmcnt(0)
    s_barrier
    v_perm_b32 v152, v113, v112, s56
    v_perm_b32 v153, v115, v114, s56
    v_perm_b32 v154, v117, v116, s56
    v_perm_b32 v155, v119, v118, s56
    v_perm_b32 v156, v113, v112, s57
    v_perm_b32 v157, v115, v114, s57
    v_mfma_f32_32x32x16_bf16 v[40:55], v[152:155], v[136:139], v[40:55]
    v_perm_b32 v158, v117, v116, s57
    v_perm_b32 v159, v119, v118, s57
    ds_read_b128 v[104:107], v10 offset:49152
    ds_read_b128 v[108:111], v11 offset:49152
    ds_read_b128 v[120:123], v14 offset:24576
    v_mfma_f32_32x32x16_bf16 v[56:71], v[152:155], v[140:143], v[56:71]
    ds_read_b128 v[124:127], v14 offset:25600
    ds_read_b128 v[128:131], v14 offset:26624
    ds_read_b128 v[132:135], v14 offset:27648
    v_mfma_f32_32x32x16_bf16 v[72:87], v[156:159], v[144:147], v[72:87]
    v_mfma_f32_32x32x16_bf16 v[88:103], v[156:159], v[148:151], v[88:103]
    s_waitcnt lgkmcnt(0)
    s_nop 0
    v_perm_b32 v152, v105, v104, s56
    v_perm_b32 v153, v107, v106, s56
    v_perm_b32 v154, v109, v108, s56
    v_perm_b32 v155, v111, v110, s56
    v_perm_b32 v156, v105, v104, s57
    v_perm_b32 v157, v107, v106, s57
    v_mfma_f32_32x32x16_bf16 v[40:55], v[152:155], v[120:123], v[40:55]
    v_perm_b32 v158, v109, v108, s57
    v_perm_b32 v159, v111, v110, s57
    ds_read_b128 v[112:115], v12 offset:49152
    ds_read_b128 v[116:119], v13 offset:49152
    ds_read_b128 v[136:139], v14 offset:28672
    v_mfma_f32_32x32x16_bf16 v[56:71], v[152:155], v[124:127], v[56:71]
    ds_read_b128 v[140:143], v14 offset:29696
    ds_read_b128 v[144:147], v14 offset:30720
    ds_read_b128 v[148:151], v14 offset:31744
    v_mfma_f32_32x32x16_bf16 v[72:87], v[156:159], v[128:131], v[72:87]
    v_mfma_f32_32x32x16_bf16 v[88:103], v[156:159], v[132:135], v[88:103]
    .p2align 3
    s_waitcnt lgkmcnt(0)
    s_barrier
    v_perm_b32 v152, v113, v112, s56
    v_perm_b32 v153, v115, v114, s56
    v_perm_b32 v154, v117, v116, s56
    v_perm_b32 v155, v119, v118, s56
    v_perm_b32 v156, v113, v112, s57
    v_perm_b32 v157, v115, v114, s57
    v_mfma_f32_32x32x16_bf16 v[40:55], v[152:155], v[136:139], v[40:55]
    v_perm_b32 v158, v117, v116, s57
    v_perm_b32 v159, v119, v118, s57
    ds_read_b128 v[104:107], v10 offset:0
    ds_read_b128 v[108:111], v11 offset:0
    ds_read_b128 v[120:123], v14 offset:32768
    v_mfma_f32_32x32x16_bf16 v[56:71], v[152:155], v[140:143], v[56:71]
    ds_read_b128 v[124:127], v14 offset:33792
    ds_read_b128 v[128:131], v14 offset:34816
    ds_read_b128 v[132:135], v14 offset:35840
    v_mfma_f32_32x32x16_bf16 v[72:87], v[156:159], v[144:147], v[72:87]
    v_mfma_f32_32x32x16_bf16 v[88:103], v[156:159], v[148:151], v[88:103]
    s_waitcnt lgkmcnt(0)
    s_nop 0
    v_perm_b32 v152, v105, v104, s56
    v_perm_b32 v153, v107, v106, s56
    v_perm_b32 v154, v109, v108, s56
    v_perm_b32 v155, v111, v110, s56
    v_perm_b32 v156, v105, v104, s57
    v_perm_b32 v157, v107, v106, s57
    v_mfma_f32_32x32x16_bf16 v[40:55], v[152:155], v[120:123], v[40:55]
    v_perm_b32 v158, v109, v108, s57
    v_perm_b32 v159, v111, v110, s57
    ds_read_b128 v[112:115], v12 offset:0
    ds_read_b128 v[116:119], v13 offset:0
    ds_read_b128 v[136:139], v14 offset:36864
    v_mfma_f32_32x32x16_bf16 v[56:71], v[152:155], v[124:127], v[56:71]
    ds_read_b128 v[140:143], v14 offset:37888
    ds_read_b128 v[144:147], v14 offset:38912
    ds_read_b128 v[148:151], v14 offset:39936
    v_mfma_f32_32x32x16_bf16 v[72:87], v[156:159], v[128:131], v[72:87]
    v_mfma_f32_32x32x16_bf16 v[88:103], v[156:159], v[132:135], v[88:103]
    .p2align 3
    s_waitcnt lgkmcnt(0)
    s_barrier
    v_perm_b32 v152, v113, v112, s56
    v_perm_b32 v153, v115, v114, s56
    v_perm_b32 v154, v117, v116, s56
    v_perm_b32 v155, v119, v118, s56
    v_perm_b32 v156, v113, v112, s57
    v_perm_b32 v157, v115, v114, s57
    v_mfma_f32_32x32x16_bf16 v[40:55], v[152:155], v[136:139], v[40:55]
    v_perm_b32 v158, v117, v116, s57
    v_perm_b32 v159, v119, v118, s57
    ds_read_b128 v[104:107], v10 offset:16384
    ds_read_b128 v[108:111], v11 offset:16384
    ds_read_b128 v[120:123], v14 offset:0
    v_mfma_f32_32x32x16_bf16 v[56:71], v[152:155], v[140:143], v[56:71]
    ds_read_b128 v[124:127], v14 offset:1024
    ds_read_b128 v[128:131], v14 offset:2048
    ds_read_b128 v[132:135], v14 offset:3072
    v_mfma_f32_32x32x16_bf16 v[72:87], v[156:159], v[144:147], v[72:87]
    v_mfma_f32_32x32x16_bf16 v[88:103], v[156:159], v[148:151], v[88:103]
    s_nop 7
    v_xor_b32 v40, v15, v40
    v_xor_b32 v41, v15, v41
    v_xor_b32 v42, v15, v42
    v_xor_b32 v43, v15, v43
    v_xor_b32 v44, v15, v44
    v_xor_b32 v45, v15, v45
    v_xor_b32 v46, v15, v46
    v_xor_b32 v47, v15, v47
    v_xor_b32 v48, v15, v48
    v_xor_b32 v49, v15, v49
    v_xor_b32 v50, v15, v50
    v_xor_b32 v51, v15, v51
    v_xor_b32 v52, v15, v52
    v_xor_b32 v53, v15, v53
    v_xor_b32 v54, v15, v54
    v_xor_b32 v55, v15, v55
    v_xor_b32 v56, v15, v56
    v_xor_b32 v57, v15, v57
    v_xor_b32 v58, v15, v58
    v_xor_b32 v59, v15, v59
    v_xor_b32 v60, v15, v60
    v_xor_b32 v61, v15, v61
    v_xor_b32 v62, v15, v62
    v_xor_b32 v63, v15, v63
    v_xor_b32 v64, v15, v64
    v_xor_b32 v65, v15, v65
    v_xor_b32 v66, v15, v66
    v_xor_b32 v67, v15, v67
    v_xor_b32 v68, v15, v68
    v_xor_b32 v69, v15, v69
    v_xor_b32 v70, v15, v70
    v_xor_b32 v71, v15, v71
    v_xor_b32 v72, v15, v72
    v_xor_b32 v73, v15, v73
    v_xor_b32 v74, v15, v74
    v_xor_b32 v75, v15, v75
    v_xor_b32 v76, v15, v76
    v_xor_b32 v77, v15, v77
    v_xor_b32 v78, v15, v78
    v_xor_b32 v79, v15, v79
    v_xor_b32 v80, v15, v80
    v_xor_b32 v81, v15, v81
    v_xor_b32 v82, v15, v82
    v_xor_b32 v83, v15, v83
    v_xor_b32 v84, v15, v84
    v_xor_b32 v85, v15, v85
    v_xor_b32 v86, v15, v86
    v_xor_b32 v87, v15, v87
    v_xor_b32 v88, v15, v88
    v_xor_b32 v89, v15, v89
    v_xor_b32 v90, v15, v90
    v_xor_b32 v91, v15, v91
    v_xor_b32 v92, v15, v92
    v_xor_b32 v93, v15, v93
    v_xor_b32 v94, v15, v94
    v_xor_b32 v95, v15, v95
    v_xor_b32 v96, v15, v96
    v_xor_b32 v97, v15, v97
    v_xor_b32 v98, v15, v98
    v_xor_b32 v99, v15, v99
    v_xor_b32 v100, v15, v100
    v_xor_b32 v101, v15, v101
    v_xor_b32 v102, v15, v102
    v_xor_b32 v103, v15, v103
    s_waitcnt lgkmcnt(0)
    s_nop 0
    v_perm_b32 v152, v105, v104, s56
    v_perm_b32 v153, v107, v106, s56
    v_perm_b32 v154, v109, v108, s56
    v_perm_b32 v155, v111, v110, s56
    v_perm_b32 v156, v105, v104, s57
    v_perm_b32 v157, v107, v106, s57
    v_mfma_f32_32x32x16_bf16 v[40:55], v[152:155], v[120:123], v[40:55]
    v_perm_b32 v158, v109, v108, s57
    v_perm_b32 v159, v111, v110, s57
    ds_read_b128 v[112:115], v12 offset:16384
    ds_read_b128 v[116:119], v13 offset:16384
    ds_read_b128 v[136:139], v14 offset:4096
    v_mfma_f32_32x32x16_bf16 v[56:71], v[152:155], v[124:127], v[56:71]
    ds_read_b128 v[140:143], v14 offset:5120
    ds_read_b128 v[144:147], v14 offset:6144
    ds_read_b128 v[148:151], v14 offset:7168
    v_mfma_f32_32x32x16_bf16 v[72:87], v[156:159], v[128:131], v[72:87]
    v_mfma_f32_32x32x16_bf16 v[88:103], v[156:159], v[132:135], v[88:103]
    buffer_load_dwordx2 v[24:25], v20, s[28:31], 0 offen sc1
    .p2align 3
    s_waitcnt lgkmcnt(0)
    s_barrier
    v_perm_b32 v152, v113, v112, s56
    v_perm_b32 v153, v115, v114, s56
    v_perm_b32 v154, v117, v116, s56
    v_perm_b32 v155, v119, v118, s56
    v_perm_b32 v156, v113, v112, s57
    v_perm_b32 v157, v115, v114, s57
    v_mfma_f32_32x32x16_bf16 v[40:55], v[152:155], v[136:139], v[40:55]
    v_perm_b32 v158, v117, v116, s57
    v_perm_b32 v159, v119, v118, s57
    ds_read_b128 v[104:107], v10 offset:32768
    ds_read_b128 v[108:111], v11 offset:32768
    ds_read_b128 v[120:123], v14 offset:8192
    v_mfma_f32_32x32x16_bf16 v[56:71], v[152:155], v[140:143], v[56:71]
    ds_read_b128 v[124:127], v14 offset:9216
    ds_read_b128 v[128:131], v14 offset:10240
    ds_read_b128 v[132:135], v14 offset:11264
    v_mfma_f32_32x32x16_bf16 v[72:87], v[156:159], v[144:147], v[72:87]
    v_mfma_f32_32x32x16_bf16 v[88:103], v[156:159], v[148:151], v[88:103]
    s_waitcnt lgkmcnt(0)
    s_nop 0
    v_perm_b32 v152, v105, v104, s56
    v_perm_b32 v153, v107, v106, s56
    v_perm_b32 v154, v109, v108, s56
    v_perm_b32 v155, v111, v110, s56
    v_perm_b32 v156, v105, v104, s57
    v_perm_b32 v157, v107, v106, s57
    v_mfma_f32_32x32x16_bf16 v[40:55], v[152:155], v[120:123], v[40:55]
    v_perm_b32 v158, v109, v108, s57
    v_perm_b32 v159, v111, v110, s57
    ds_read_b128 v[112:115], v12 offset:32768
    ds_read_b128 v[116:119], v13 offset:32768
    ds_read_b128 v[136:139], v14 offset:12288
    v_mfma_f32_32x32x16_bf16 v[56:71], v[152:155], v[124:127], v[56:71]
    ds_read_b128 v[140:143], v14 offset:13312
    ds_read_b128 v[144:147], v14 offset:14336
    ds_read_b128 v[148:151], v14 offset:15360
    v_mfma_f32_32x32x16_bf16 v[72:87], v[156:159], v[128:131], v[72:87]
    v_mfma_f32_32x32x16_bf16 v[88:103], v[156:159], v[132:135], v[88:103]
    .p2align 3
    s_waitcnt lgkmcnt(0)
    s_barrier
    v_perm_b32 v152, v113, v112, s56
    v_perm_b32 v153, v115, v114, s56
    v_perm_b32 v154, v117, v116, s56
    v_perm_b32 v155, v119, v118, s56
    v_perm_b32 v156, v113, v112, s57
    v_perm_b32 v157, v115, v114, s57
    v_mfma_f32_32x32x16_bf16 v[40:55], v[152:155], v[136:139], v[40:55]
    v_perm_b32 v158, v117, v116, s57
    v_perm_b32 v159, v119, v118, s57
    ds_read_b128 v[104:107], v10 offset:49152
    ds_read_b128 v[108:111], v11 offset:49152
    ds_read_b128 v[120:123], v14 offset:16384
    v_mfma_f32_32x32x16_bf16 v[56:71], v[152:155], v[140:143], v[56:71]
    ds_read_b128 v[124:127], v14 offset:17408
    ds_read_b128 v[128:131], v14 offset:18432
    ds_read_b128 v[132:135], v14 offset:19456
    v_mfma_f32_32x32x16_bf16 v[72:87], v[156:159], v[144:147], v[72:87]
    v_mfma_f32_32x32x16_bf16 v[88:103], v[156:159], v[148:151], v[88:103]
    s_waitcnt lgkmcnt(0)
    s_nop 0
    v_perm_b32 v152, v105, v104, s56
    v_perm_b32 v153, v107, v106, s56
    v_perm_b32 v154, v109, v108, s56
    v_perm_b32 v155, v111, v110, s56
    v_perm_b32 v156, v105, v104, s57
    v_perm_b32 v157, v107, v106, s57
    v_mfma_f32_32x32x16_bf16 v[40:55], v[152:155], v[120:123], v[40:55]
    v_perm_b32 v158, v109, v108, s57
    v_perm_b32 v159, v111, v110, s57
    ds_read_b128 v[112:115], v12 offset:49152
    ds_read_b128 v[116:119], v13 offset:49152
    ds_read_b128 v[136:139], v14 offset:20480
    v_mfma_f32_32x32x16_bf16 v[56:71], v[152:155], v[124:127], v[56:71]
    ds_read_b128 v[140:143], v14 offset:21504
    ds_read_b128 v[144:147], v14 offset:22528
    ds_read_b128 v[148:151], v14 offset:23552
    v_mfma_f32_32x32x16_bf16 v[72:87], v[156:159], v[128:131], v[72:87]
    v_mfma_f32_32x32x16_bf16 v[88:103], v[156:159], v[132:135], v[88:103]
    .p2align 3
    s_waitcnt lgkmcnt(0)
    s_barrier
    v_perm_b32 v152, v113, v112, s56
    v_perm_b32 v153, v115, v114, s56
    v_perm_b32 v154, v117, v116, s56
    v_perm_b32 v155, v119, v118, s56
    v_perm_b32 v156, v113, v112, s57
    v_perm_b32 v157, v115, v114, s57
    v_mfma_f32_32x32x16_bf16 v[40:55], v[152:155], v[136:139], v[40:55]
    v_perm_b32 v158, v117, v116, s57
    v_perm_b32 v159, v119, v118, s57
    ds_read_b128 v[104:107], v10 offset:0
    ds_read_b128 v[108:111], v11 offset:0
    ds_read_b128 v[120:123], v14 offset:24576
    v_mfma_f32_32x32x16_bf16 v[56:71], v[152:155], v[140:143], v[56:71]
    ds_read_b128 v[124:127], v14 offset:25600
    ds_read_b128 v[128:131], v14 offset:26624
    ds_read_b128 v[132:135], v14 offset:27648
    v_mfma_f32_32x32x16_bf16 v[72:87], v[156:159], v[144:147], v[72:87]
    v_mfma_f32_32x32x16_bf16 v[88:103], v[156:159], v[148:151], v[88:103]
    s_waitcnt lgkmcnt(0)
    s_nop 0
    v_perm_b32 v152, v105, v104, s56
    v_perm_b32 v153, v107, v106, s56
    v_perm_b32 v154, v109, v108, s56
    v_perm_b32 v155, v111, v110, s56
    v_perm_b32 v156, v105, v104, s57
    v_perm_b32 v157, v107, v106, s57
    v_mfma_f32_32x32x16_bf16 v[40:55], v[152:155], v[120:123], v[40:55]
    v_perm_b32 v158, v109, v108, s57
    v_perm_b32 v159, v111, v110, s57
    ds_read_b128 v[112:115], v12 offset:0
    ds_read_b128 v[116:119], v13 offset:0
    ds_read_b128 v[136:139], v14 offset:28672
    v_mfma_f32_32x32x16_bf16 v[56:71], v[152:155], v[124:127], v[56:71]
    ds_read_b128 v[140:143], v14 offset:29696
    ds_read_b128 v[144:147], v14 offset:30720
    ds_read_b128 v[148:151], v14 offset:31744
    v_mfma_f32_32x32x16_bf16 v[72:87], v[156:159], v[128:131], v[72:87]
    v_mfma_f32_32x32x16_bf16 v[88:103], v[156:159], v[132:135], v[88:103]
    .p2align 3
    s_waitcnt lgkmcnt(0)
    s_barrier
    v_perm_b32 v152, v113, v112, s56
    v_perm_b32 v153, v115, v114, s56
    v_perm_b32 v154, v117, v116, s56
    v_perm_b32 v155, v119, v118, s56
    v_perm_b32 v156, v113, v112, s57
    v_perm_b32 v157, v115, v114, s57
    v_mfma_f32_32x32x16_bf16 v[40:55], v[152:155], v[136:139], v[40:55]
    v_perm_b32 v158, v117, v116, s57
    v_perm_b32 v159, v119, v118, s57
    ds_read_b128 v[104:107], v10 offset:16384
    ds_read_b128 v[108:111], v11 offset:16384
    ds_read_b128 v[120:123], v14 offset:32768
    v_mfma_f32_32x32x16_bf16 v[56:71], v[152:155], v[140:143], v[56:71]
    ds_read_b128 v[124:127], v14 offset:33792
    ds_read_b128 v[128:131], v14 offset:34816
    ds_read_b128 v[132:135], v14 offset:35840
    v_mfma_f32_32x32x16_bf16 v[72:87], v[156:159], v[144:147], v[72:87]
    v_mfma_f32_32x32x16_bf16 v[88:103], v[156:159], v[148:151], v[88:103]
    s_waitcnt lgkmcnt(0)
    s_nop 0
    v_perm_b32 v152, v105, v104, s56
    v_perm_b32 v153, v107, v106, s56
    v_perm_b32 v154, v109, v108, s56
    v_perm_b32 v155, v111, v110, s56
    v_perm_b32 v156, v105, v104, s57
    v_perm_b32 v157, v107, v106, s57
    v_mfma_f32_32x32x16_bf16 v[40:55], v[152:155], v[120:123], v[40:55]
    v_perm_b32 v158, v109, v108, s57
    v_perm_b32 v159, v111, v110, s57
    ds_read_b128 v[112:115], v12 offset:16384
    ds_read_b128 v[116:119], v13 offset:16384
    ds_read_b128 v[136:139], v14 offset:36864
    v_mfma_f32_32x32x16_bf16 v[56:71], v[152:155], v[124:127], v[56:71]
    ds_read_b128 v[140:143], v14 offset:37888
    ds_read_b128 v[144:147], v14 offset:38912
    ds_read_b128 v[148:151], v14 offset:39936
    v_mfma_f32_32x32x16_bf16 v[72:87], v[156:159], v[128:131], v[72:87]
    v_mfma_f32_32x32x16_bf16 v[88:103], v[156:159], v[132:135], v[88:103]
    s_waitcnt lgkmcnt(0)
    v_perm_b32 v152, v113, v112, s56
    v_perm_b32 v153, v115, v114, s56
    v_perm_b32 v154, v117, v116, s56
    v_perm_b32 v155, v119, v118, s56
    v_perm_b32 v156, v113, v112, s57
    v_perm_b32 v157, v115, v114, s57
    v_mfma_f32_32x32x16_bf16 v[40:55], v[152:155], v[136:139], v[40:55]
    v_perm_b32 v158, v117, v116, s57
    v_perm_b32 v159, v119, v118, s57
    s_nop 0
    v_mfma_f32_32x32x16_bf16 v[56:71], v[152:155], v[140:143], v[56:71]
    v_mfma_f32_32x32x16_bf16 v[72:87], v[156:159], v[144:147], v[72:87]
    v_mfma_f32_32x32x16_bf16 v[88:103], v[156:159], v[148:151], v[88:103]
    s_add_u32 s45, s45, 2654435769
    v_mov_b32 v6, s45
    s_mov_b32 s50, 0
S_tst:
    s_waitcnt vmcnt(0)
    v_cmp_ne_u32 s[58:59], s45, v25
    s_add_u32 s50, s50, 1
    s_cmp_eq_u64 s[58:59], 0
    s_cbranch_scc1 S_tst_ok
    s_cmp_ge_u32 s50, 131072
    s_cbranch_scc1 S_tst_ok
    s_sleep 2
    buffer_load_dwordx2 v[24:25], v20, s[28:31], 0 offen sc1
    s_branch S_tst
S_tst_ok:
    v_and_b32 v27, 0xffff0000, v24
    v_and_b32 v4, 0xffff, v24
    v_rcp_f32 v5, v27
    v_cndmask_b32 v108, 0, v4, vcc
    s_lshl_b32 s47, s40, 7
    s_add_u32 s47, s47, 106496
    v_lshl_add_u32 v3, v8, 2, s47
    ds_write_b32 v3, v5
    v_lshl_add_u32 v3, v9, 4, s47
    ds_read_b128 v[120:123], v3 offset:0
    ds_read_b128 v[124:127], v3 offset:32
    ds_read_b128 v[128:131], v3 offset:64
    ds_read_b128 v[132:135], v3 offset:96
    v_mov_b32 v5, 0xc3a0
    v_cndmask_b32 v112, 0, v5, s[52:53]
    v_mov_b32 v109, 0
    v_mov_b32 v113, 0
    v_mov_b32 v110, 0
    v_mov_b32 v114, 0
    v_mov_b32 v111, 0
    v_mov_b32 v115, 0
    s_nop 1
    v_mfma_f32_32x32x16_bf16 v[40:55], v[108:111], v[112:115], v[40:55]
    v_mfma_f32_32x32x16_bf16 v[72:87], v[108:111], v[112:115], v[72:87]
    s_waitcnt lgkmcnt(0)
    .p2align 3
    v_pk_mul_f32 v[160:161], v[160:161], v[120:121]
    v_pk_mul_f32 v[162:163], v[162:163], v[122:123]
    v_pk_mul_f32 v[164:165], v[164:165], v[124:125]
    v_pk_mul_f32 v[166:167], v[166:167], v[126:127]
    v_pk_mul_f32 v[168:169], v[168:169], v[128:129]
    v_pk_mul_f32 v[170:171], v[170:171], v[130:131]
    v_pk_mul_f32 v[172:173], v[172:173], v[132:133]
    v_pk_mul_f32 v[174:175], v[174:175], v[134:135]
    v_cvt_pk_bf16_f32 v160, v160, v161
    v_cvt_pk_bf16_f32 v161, v162, v163
    v_cvt_pk_bf16_f32 v162, v164, v165
    v_cvt_pk_bf16_f32 v163, v166, v167
    v_cvt_pk_bf16_f32 v164, v168, v169
    v_cvt_pk_bf16_f32 v165, v170, v171
    v_cvt_pk_bf16_f32 v166, v172, v173
    v_cvt_pk_bf16_f32 v167, v174, v175
    v_pk_fma_f32 v[176:177], v[88:89], v[16:17], v[56:57]
    v_pk_fma_f32 v[88:89], v[56:57], v[16:17], v[88:89] neg_lo:[1,0,0] neg_hi:[1,0,0]
    v_pk_fma_f32 v[178:179], v[90:91], v[16:17], v[58:59]
    v_pk_fma_f32 v[90:91], v[58:59], v[16:17], v[90:91] neg_lo:[1,0,0] neg_hi:[1,0,0]
    v_pk_fma_f32 v[180:181], v[92:93], v[16:17], v[60:61]
    v_pk_fma_f32 v[92:93], v[60:61], v[16:17], v[92:93] neg_lo:[1,0,0] neg_hi:[1,0,0]
    v_pk_fma_f32 v[182:183], v[94:95], v[16:17], v[62:63]
    v_pk_fma_f32 v[94:95], v[62:63], v[16:17], v[94:95] neg_lo:[1,0,0] neg_hi:[1,0,0]
    v_pk_fma_f32 v[184:185], v[96:97], v[16:17], v[64:65]
    v_pk_fma_f32 v[96:97], v[64:65], v[16:17], v[96:97] neg_lo:[1,0,0] neg_hi:[1,0,0]
    v_pk_fma_f32 v[186:187], v[98:99], v[16:17], v[66:67]
    v_pk_fma_f32 v[98:99], v[66:67], v[16:17], v[98:99] neg_lo:[1,0,0] neg_hi:[1,0,0]
    v_pk_fma_f32 v[188:189], v[100:101], v[16:17], v[68:69]
    v_pk_fma_f32 v[100:101], v[68:69], v[16:17], v[100:101] neg_lo:[1,0,0] neg_hi:[1,0,0]
    v_pk_fma_f32 v[190:191], v[102:103], v[16:17], v[70:71]
    v_pk_fma_f32 v[102:103], v[70:71], v[16:17], v[102:103] neg_lo:[1,0,0] neg_hi:[1,0,0]
    v_pk_add_f32 v[56:57], v[40:41], v[72:73] neg_lo:[0,1] neg_hi:[0,1]
    v_pk_add_f32 v[40:41], v[40:41], v[72:73]
    v_pk_add_f32 v[58:59], v[42:43], v[74:75] neg_lo:[0,1] neg_hi:[0,1]
    v_pk_add_f32 v[42:43], v[42:43], v[74:75]
    v_pk_add_f32 v[60:61], v[44:45], v[76:77] neg_lo:[0,1] neg_hi:[0,1]
    v_pk_add_f32 v[44:45], v[44:45], v[76:77]
    v_pk_add_f32 v[62:63], v[46:47], v[78:79] neg_lo:[0,1] neg_hi:[0,1]
    v_pk_add_f32 v[46:47], v[46:47], v[78:79]
    v_pk_add_f32 v[64:65], v[48:49], v[80:81] neg_lo:[0,1] neg_hi:[0,1]
    v_pk_add_f32 v[48:49], v[48:49], v[80:81]
    v_pk_add_f32 v[66:67], v[50:51], v[82:83] neg_lo:[0,1] neg_hi:[0,1]
    v_pk_add_f32 v[50:51], v[50:51], v[82:83]
    v_pk_add_f32 v[68:69], v[52:53], v[84:85] neg_lo:[0,1] neg_hi:[0,1]
    v_pk_add_f32 v[52:53], v[52:53], v[84:85]
    v_pk_add_f32 v[70:71], v[54:55], v[86:87] neg_lo:[0,1] neg_hi:[0,1]
    v_pk_add_f32 v[54:55], v[54:55], v[86:87]
    v_cvt_pk_bf16_f32 v208, v176, v177
    v_cvt_pk_bf16_f32 v209, v178, v179
    v_cvt_pk_bf16_f32 v210, v180, v181
    v_cvt_pk_bf16_f32 v211, v182, v183
    v_cvt_pk_bf16_f32 v212, v184, v185
    v_cvt_pk_bf16_f32 v213, v186, v187
    v_cvt_pk_bf16_f32 v214, v188, v189
    v_cvt_pk_bf16_f32 v215, v190, v191
    v_cvt_pk_bf16_f32 v192, v40, v41
    v_cvt_pk_bf16_f32 v193, v42, v43
    v_mfma_f32_32x32x16_bf16 v[72:87], v[160:163], v[208:211], 0
    v_cvt_pk_bf16_f32 v194, v44, v45
    v_cvt_pk_bf16_f32 v195, v46, v47
    v_cvt_pk_bf16_f32 v196, v48, v49
    v_cvt_pk_bf16_f32 v197, v50, v51
    v_mfma_f32_32x32x16_bf16 v[72:87], v[164:167], v[212:215], v[72:87]
    v_cvt_pk_bf16_f32 v198, v52, v53
    v_cvt_pk_bf16_f32 v199, v54, v55
    v_cvt_pk_bf16_f32 v200, v56, v57
    v_cvt_pk_bf16_f32 v201, v58, v59
    v_mfma_f32_32x32x16_bf16 v[40:55], v[160:163], v[192:195], 0
    v_cvt_pk_bf16_f32 v202, v60, v61
    v_cvt_pk_bf16_f32 v203, v62, v63
    v_cvt_pk_bf16_f32 v204, v64, v65
    v_cvt_pk_bf16_f32 v205, v66, v67
    v_mfma_f32_32x32x16_bf16 v[40:55], v[164:167], v[196:199], v[40:55]
    v_cvt_pk_bf16_f32 v206, v68, v69
    v_cvt_pk_bf16_f32 v207, v70, v71
    v_cvt_pk_bf16_f32 v216, v88, v89
    v_cvt_pk_bf16_f32 v217, v90, v91
    v_mfma_f32_32x32x16_bf16 v[56:71], v[160:163], v[200:203], 0
    v_cvt_pk_bf16_f32 v218, v92, v93
    v_cvt_pk_bf16_f32 v219, v94, v95
    v_cvt_pk_bf16_f32 v220, v96, v97
    v_cvt_pk_bf16_f32 v221, v98, v99
    v_mfma_f32_32x32x16_bf16 v[56:71], v[164:167], v[204:207], v[56:71]
    v_cvt_pk_bf16_f32 v222, v100, v101
    v_cvt_pk_bf16_f32 v223, v102, v103
    s_nop 1
    s_nop 0
    v_mfma_f32_32x32x16_bf16 v[88:103], v[160:163], v[216:219], 0
    v_mfma_f32_32x32x16_bf16 v[88:103], v[164:167], v[220:223], v[88:103]
    s_mul_i32 s48, s55, 5632
    s_nop 9
    s_cmp_lg_u32 s54, 0
    s_cbranch_scc1 S_dgen
    v_mov_b32 v4, v73
    v_mov_b32 v5, v89
    v_mul_f32 v3, v4, v19
    v_mul_f32 v4, v4, v18
    v_fma_f32 v4, -v5, v19, v4
    v_fma_f32 v5, v5, v18, v3
    v_cvt_pk_bf16_f32 v176, v72, v88
    v_cvt_pk_bf16_f32 v177, v4, v5
    v_cvt_pk_bf16_f32 v178, v74, v90
    v_cvt_pk_bf16_f32 v179, v75, v91
    v_cvt_pk_bf16_f32 v180, v76, v92
    v_cvt_pk_bf16_f32 v181, v77, v93
    v_cvt_pk_bf16_f32 v182, v78, v94
    v_cvt_pk_bf16_f32 v183, v79, v95
    v_cvt_pk_bf16_f32 v184, v80, v96
    v_cvt_pk_bf16_f32 v185, v81, v97
    v_cvt_pk_bf16_f32 v186, v82, v98
    v_cvt_pk_bf16_f32 v187, v83, v99
    v_cvt_pk_bf16_f32 v188, v84, v100
    v_cvt_pk_bf16_f32 v189, v85, v101
    v_cvt_pk_bf16_f32 v190, v86, v102
    v_cvt_pk_bf16_f32 v191, v87, v103
    v_pk_mul_f32 v[72:73], v[72:73], v[16:17]
    v_pk_mul_f32 v[74:75], v[74:75], v[16:17]
    v_pk_mul_f32 v[76:77], v[76:77], v[16:17]
    v_pk_mul_f32 v[78:79], v[78:79], v[16:17]
    v_pk_mul_f32 v[80:81], v[80:81], v[16:17]
    v_pk_mul_f32 v[82:83], v[82:83], v[16:17]
    v_pk_mul_f32 v[84:85], v[84:85], v[16:17]
    v_pk_mul_f32 v[86:87], v[86:87], v[16:17]
    v_pk_mul_f32 v[88:89], v[88:89], v[16:17]
    v_pk_mul_f32 v[90:91], v[90:91], v[16:17]
    v_pk_mul_f32 v[92:93], v[92:93], v[16:17]
    v_pk_mul_f32 v[94:95], v[94:95], v[16:17]
    v_pk_mul_f32 v[96:97], v[96:97], v[16:17]
    v_pk_mul_f32 v[98:99], v[98:99], v[16:17]
    v_pk_mul_f32 v[100:101], v[100:101], v[16:17]
    v_pk_mul_f32 v[102:103], v[102:103], v[16:17]
    s_add_u32 s47, s48, 0
    buffer_store_dwordx4 v[176:179], v36, s[24:27], s47 offen sc1
    s_add_u32 s47, s48, 720896
    buffer_store_dwordx4 v[180:183], v36, s[24:27], s47 offen sc1
    s_add_u32 s47, s48, 1441792
    buffer_store_dwordx4 v[184:187], v36, s[24:27], s47 offen sc1
    s_add_u32 s47, s48, 2162688
    buffer_store_dwordx4 v[188:191], v36, s[24:27], s47 offen sc1
S_dgen:
    v_mul_f32 v3, v41, v19
    v_mul_f32 v41, v41, v18
    v_fma_f32 v41, -v73, v19, v41
    v_fma_f32 v73, v73, v18, v3
    v_mul_f32 v3, v57, v19
    v_mul_f32 v57, v57, v18
    v_fma_f32 v57, -v89, v19, v57
    v_fma_f32 v89, v89, v18, v3
    s_add_u32 s47, s48, 0
    v_cvt_pk_bf16_f32 v40, v40, v72
    v_cvt_pk_bf16_f32 v41, v41, v73
    v_cvt_pk_bf16_f32 v42, v42, v74
    v_cvt_pk_bf16_f32 v43, v43, v75
    buffer_store_dwordx4 v[40:43], v34, s[24:27], s47 offen sc1
    v_cvt_pk_bf16_f32 v56, v56, v88
    v_cvt_pk_bf16_f32 v57, v57, v89
    v_cvt_pk_bf16_f32 v58, v58, v90
    v_cvt_pk_bf16_f32 v59, v59, v91
    buffer_store_dwordx4 v[56:59], v35, s[24:27], s47 offen sc1
    s_add_u32 s47, s48, 720896
    v_cvt_pk_bf16_f32 v44, v44, v76
    v_cvt_pk_bf16_f32 v45, v45, v77
    v_cvt_pk_bf16_f32 v46, v46, v78
    v_cvt_pk_bf16_f32 v47, v47, v79
    buffer_store_dwordx4 v[44:47], v34, s[24:27], s47 offen sc1
    v_cvt_pk_bf16_f32 v60, v60, v92
    v_cvt_pk_bf16_f32 v61, v61, v93
    v_cvt_pk_bf16_f32 v62, v62, v94
    v_cvt_pk_bf16_f32 v63, v63, v95
    buffer_store_dwordx4 v[60:63], v35, s[24:27], s47 offen sc1
    s_add_u32 s47, s48, 1441792
    v_cvt_pk_bf16_f32 v48, v48, v80
    v_cvt_pk_bf16_f32 v49, v49, v81
    v_cvt_pk_bf16_f32 v50, v50, v82
    v_cvt_pk_bf16_f32 v51, v51, v83
    buffer_store_dwordx4 v[48:51], v34, s[24:27], s47 offen sc1
    v_cvt_pk_bf16_f32 v64, v64, v96
    v_cvt_pk_bf16_f32 v65, v65, v97
    v_cvt_pk_bf16_f32 v66, v66, v98
    v_cvt_pk_bf16_f32 v67, v67, v99
    buffer_store_dwordx4 v[64:67], v35, s[24:27], s47 offen sc1
    s_add_u32 s47, s48, 2162688
    v_cvt_pk_bf16_f32 v52, v52, v84
    v_cvt_pk_bf16_f32 v53, v53, v85
    v_cvt_pk_bf16_f32 v54, v54, v86
    v_cvt_pk_bf16_f32 v55, v55, v87
    buffer_store_dwordx4 v[52:55], v34, s[24:27], s47 offen sc1
    v_cvt_pk_bf16_f32 v68, v68, v100
    v_cvt_pk_bf16_f32 v69, v69, v101
    v_cvt_pk_bf16_f32 v70, v70, v102
    v_cvt_pk_bf16_f32 v71, v71, v103
    buffer_store_dwordx4 v[68:71], v35, s[24:27], s47 offen sc1
    s_lshl_b32 s46, s54, 6
    s_add_u32 s46, s46, s55
    s_add_u32 s46, s46, 832
    s_lshl_b32 s46, s46, 7
S_t2:
    s_lshr_b32 s54, s2, 3
    s_sub_u32 s54, s54, 20
    s_lshr_b32 s56, s40, 2
    v_lshrrev_b32 v8, 5, v1
    v_and_b32 v9, 15, v1
    v_lshrrev_b32 v10, 4, v1
    s_and_b32 s55, s2, 7
    s_lshl_b32 s55, s55, 1
    s_add_u32 s55, s55, s56
    v_and_b32 v40, 31, v1
    v_lshrrev_b32 v3, 1, v40
    s_lshl_b32 s47, s41, 4
    v_add_u32 v3, s47, v3
    v_cvt_f32_u32 v11, v3
    v_lshlrev_b32 v42, 8, v3
    v_mul_f32 v5, 0x3c000000, v11
    v_and_b32 v3, 1, v40
    v_cos_f32 v44, v5
    v_sin_f32 v45, -v5
    v_lshlrev_b32 v4, 31, v3
    v_xor_b32 v45, v4, v45
    v_lshl_add_u32 v4, v8, 1, v3
    s_lshr_b32 s47, s55, 1
    s_and_b32 s47, s47, 2
    v_xor_b32 v4, s47, v4
    v_and_b32 v5, 6, v40
    v_xor_b32 v4, v4, v5
    v_lshl_add_u32 v42, v4, 4, v42
    s_lshl_b32 s57, s56, 14
    s_add_u32 s47, s57, 65536
    v_add_u32 v42, s47, v42
    v_xor_b32 v43, 64, v42
    s_add_u32 s57, s57, 32768
    v_lshlrev_b32 v4, 1, v8
    v_mul_f32 v11, 0xbc800000, v11
    v_cvt_f32_u32 v3, v3
    v_cvt_f32_u32 v4, v4
    v_mul_f32 v5, 0x41000000, v11
    v_mul_f32 v12, 0x3e800000, v3
    v_cos_f32 v5, v5
    v_fmac_f32 v12, v4, v11
    v_add_f32 v13, v5, v5
    v_fmamk_f32 v81, v11, 0x3f800000, v12
    v_fmamk_f32 v83, v11, 0x40800000, v12
    v_fmamk_f32 v85, v11, 0x40a00000, v12
    v_fmamk_f32 v87, v11, 0x41000000, v12
    v_fmamk_f32 v89, v11, 0x41100000, v12
    v_fmamk_f32 v91, v11, 0x41400000, v12
    v_fmamk_f32 v93, v11, 0x41500000, v12
    v_cos_f32 v78, v12
    v_sin_f32 v79, v12
    v_cos_f32 v80, v81
    v_sin_f32 v81, v81
    v_cos_f32 v82, v83
    v_sin_f32 v83, v83
    v_cos_f32 v84, v85
    v_sin_f32 v85, v85
    v_cos_f32 v86, v87
    v_sin_f32 v87, v87
    v_cos_f32 v88, v89
    v_sin_f32 v89, v89
    v_cos_f32 v90, v91
    v_sin_f32 v91, v91
    v_cos_f32 v92, v93
    v_sin_f32 v93, v93
    v_cvt_pk_bf16_f32 v46, v78, v79
    v_cvt_pk_bf16_f32 v47, v80, v81
    v_cvt_pk_bf16_f32 v48, v82, v83
    v_cvt_pk_bf16_f32 v49, v84, v85
    v_cvt_pk_bf16_f32 v50, v86, v87
    v_cvt_pk_bf16_f32 v51, v88, v89
    v_cvt_pk_bf16_f32 v52, v90, v91
    v_cvt_pk_bf16_f32 v53, v92, v93
    v_fma_f32 v78, v86, v13, -v78
    v_fma_f32 v79, v87, v13, -v79
    v_fma_f32 v80, v88, v13, -v80
    v_fma_f32 v81, v89, v13, -v81
    v_fma_f32 v82, v90, v13, -v82
    v_fma_f32 v83, v91, v13, -v83
    v_fma_f32 v84, v92, v13, -v84
    v_fma_f32 v85, v93, v13, -v85
    v_cvt_pk_bf16_f32 v54, v78, v79
    v_cvt_pk_bf16_f32 v55, v80, v81
    v_cvt_pk_bf16_f32 v56, v82, v83
    v_cvt_pk_bf16_f32 v57, v84, v85
    v_fma_f32 v86, v78, v13, -v86
    v_fma_f32 v87, v79, v13, -v87
    v_fma_f32 v88, v80, v13, -v88
    v_fma_f32 v89, v81, v13, -v89
    v_fma_f32 v90, v82, v13, -v90
    v_fma_f32 v91, v83, v13, -v91
    v_fma_f32 v92, v84, v13, -v92
    v_fma_f32 v93, v85, v13, -v93
    v_cvt_pk_bf16_f32 v58, v86, v87
    v_cvt_pk_bf16_f32 v59, v88, v89
    v_cvt_pk_bf16_f32 v60, v90, v91
    v_cvt_pk_bf16_f32 v61, v92, v93
    v_fma_f32 v78, v86, v13, -v78
    v_fma_f32 v79, v87, v13, -v79
    v_fma_f32 v80, v88, v13, -v80
    v_fma_f32 v81, v89, v13, -v81
    v_fma_f32 v82, v90, v13, -v82
    v_fma_f32 v83, v91, v13, -v83
    v_fma_f32 v84, v92, v13, -v84
    v_fma_f32 v85, v93, v13, -v85
    v_cvt_pk_bf16_f32 v62, v78, v79
    v_cvt_pk_bf16_f32 v63, v80, v81
    v_cvt_pk_bf16_f32 v64, v82, v83
    v_cvt_pk_bf16_f32 v65, v84, v85
    v_fma_f32 v86, v78, v13, -v86
    v_fma_f32 v87, v79, v13, -v87
    v_fma_f32 v88, v80, v13, -v88
    v_fma_f32 v89, v81, v13, -v89
    v_fma_f32 v90, v82, v13, -v90
    v_fma_f32 v91, v83, v13, -v91
    v_fma_f32 v92, v84, v13, -v92
    v_fma_f32 v93, v85, v13, -v93
    v_cvt_pk_bf16_f32 v66, v86, v87
    v_cvt_pk_bf16_f32 v67, v88, v89
    v_cvt_pk_bf16_f32 v68, v90, v91
    v_cvt_pk_bf16_f32 v69, v92, v93
    v_fma_f32 v78, v86, v13, -v78
    v_fma_f32 v79, v87, v13, -v79
    v_fma_f32 v80, v88, v13, -v80
    v_fma_f32 v81, v89, v13, -v81
    v_fma_f32 v82, v90, v13, -v82
    v_fma_f32 v83, v91, v13, -v83
    v_fma_f32 v84, v92, v13, -v84
    v_fma_f32 v85, v93, v13, -v85
    v_cvt_pk_bf16_f32 v70, v78, v79
    v_cvt_pk_bf16_f32 v71, v80, v81
    v_cvt_pk_bf16_f32 v72, v82, v83
    v_cvt_pk_bf16_f32 v73, v84, v85
    v_fma_f32 v86, v78, v13, -v86
    v_fma_f32 v87, v79, v13, -v87
    v_fma_f32 v88, v80, v13, -v88
    v_fma_f32 v89, v81, v13, -v89
    v_fma_f32 v90, v82, v13, -v90
    v_fma_f32 v91, v83, v13, -v91
    v_fma_f32 v92, v84, v13, -v92
    v_fma_f32 v93, v85, v13, -v93
    v_cvt_pk_bf16_f32 v74, v86, v87
    v_cvt_pk_bf16_f32 v75, v88, v89
    v_cvt_pk_bf16_f32 v76, v90, v91
    v_cvt_pk_bf16_f32 v77, v92, v93
    s_cmp_ge_u32 s40, 4
    s_cbranch_scc1 S_nofl
    s_waitcnt vmcnt(0)
    v_mov_b32 v3, s46
    s_mov_b64 exec, 1
    buffer_store_dword v6, v3, s[36:39], 0 offen sc1
    s_mov_b64 exec, -1
S_nofl:
    s_cmp_eq_u32 s56, 0
    s_cbranch_scc1 S_now2
    s_mov_b32 s24, s16
    s_mov_b32 s25, s17
    s_mov_b32 s26, 2211840
    s_mov_b32 s27, 0x20000
    s_lshl_b32 s47, s54, 2
    s_add_u32 s47, s47, s41
    s_mul_i32 s47, s47, 13824
    s_mul_i32 s48, s42, 1105920
    s_add_u32 s47, s47, s48
    s_add_u32 s47, s47, 442368
    v_min_u32 v3, 53, v1
    v_lshlrev_b32 v3, 8, v3
    buffer_load_dword v7, v3, s[24:27], s47 offen
    buffer_load_dword v7, v3, s[24:27], s47 offen offset:128
S_now2:
    s_cmp_ge_u32 s54, 11
    s_cbranch_scc1 S_not2
    s_add_u32 s32, s22, 7077888
    s_addc_u32 s33, s23, 0
    s_mov_b32 s34, 2883584
    s_mov_b32 s35, 0x20000
    s_cmp_gt_u32 s54, 5
    s_cselect_b32 s47, 1, 0
    v_and_b32 v4, 1, v10
    v_xor_b32 v4, s47, v4
    v_lshl_add_u32 v41, v9, 1, v4
    s_sub_u32 s47, 10, s54
    s_cmp_eq_u32 s54, 5
    s_cselect_b32 s47, 0, s47
    s_min_u32 s47, s47, s54
    s_lshl_b32 s47, s47, 6
    s_add_u32 s47, s47, 832
    s_lshl_b32 s48, s40, 3
    s_add_u32 s47, s47, s48
    v_and_b32 v3, 7, v1
    v_add_lshl_u32 v15, v3, s47, 7
    v_mul_u32_u24 v4, 5120, v8
    v_add_u32 v4, v4, v2
    s_cmp_eq_u32 s54, 5
    s_cselect_b32 s47, 8, 32
    v_cmp_gt_u32 vcc, s47, v40
    v_mov_b32 v3, 2130706432
    s_nop 0
    v_cndmask_b32 v4, v3, v4, vcc
    s_and_b32 s47, s2, 7
    s_lshl_b32 s47, s47, 3
    s_add_u32 s47, s47, s40
    s_mul_i32 s47, s47, 45056
    s_lshl_b32 s48, s54, 9
    s_add_u32 s47, s47, s48
    s_lshl_b32 m0, s40, 12
    s_cmp_lt_u32 s40, 4
    s_cbranch_scc1 S_now
    s_waitcnt vmcnt(0)
S_now:
    s_barrier
    s_mov_b32 s50, 0
S_vp:
    buffer_load_dword v16, v15, s[36:39], 0 offen sc1
    s_add_u32 s50, s50, 1
    s_waitcnt vmcnt(0)
    v_xor_b32 v16, v16, v6
    v_cmp_ne_u32 vcc, 0, v16
    s_cmp_ge_u32 s50, 131072
    s_cbranch_scc1 S_vp_e
    s_cbranch_vccz S_vp_e
    s_mov_b64 exec, vcc
    s_sleep 2
    s_branch S_vp
S_vp_e:
    s_mov_b64 exec, -1
S_vp_ok:
    s_add_u32 s48, s47, 0
    buffer_load_dwordx4 v4, s[32:35], s48 offen offset:0 sc1 lds
    s_add_u32 s48, s47, 10240
    buffer_load_dwordx4 v4, s[32:35], s48 offen offset:1024 sc1 lds
    s_add_u32 s48, s47, 20480
    buffer_load_dwordx4 v4, s[32:35], s48 offen offset:2048 sc1 lds
    s_add_u32 s48, s47, 30720
    buffer_load_dwordx4 v4, s[32:35], s48 offen offset:3072 sc1 lds
    s_add_u32 s32, s22, 9961472
    s_addc_u32 s33, s23, 0
    s_mov_b32 s34, 2883584
    s_mov_b32 s35, 0x20000
    v_lshlrev_b32 v14, 4, v41
    v_lshl_add_u32 v14, v8, 10, v14
    s_lshl_b32 s47, s56, 3
    v_add_u32 v14, s47, v14
    s_lshl_b32 s47, s40, 12
    s_add_u32 s47, s47, 114688
    v_lshl_add_u32 v15, v41, 1, s47
    v_lshl_add_u32 v15, v8, 7, v15
    ds_read_u16_d16_hi v110, v15 offset:0
    ds_read_u16_d16_hi v111, v15 offset:1024
    ds_read_u16_d16_hi v126, v15 offset:2048
    ds_read_u16_d16_hi v127, v15 offset:3072
    ds_read_u16_d16_hi v112, v15 offset:64
    ds_read_u16_d16_hi v113, v15 offset:1088
    ds_read_u16_d16_hi v128, v15 offset:2112
    ds_read_u16_d16_hi v129, v15 offset:3136
    ds_read_u16_d16_hi v114, v15 offset:256
    ds_read_u16_d16_hi v115, v15 offset:1280
    ds_read_u16_d16_hi v130, v15 offset:2304
    ds_read_u16_d16_hi v131, v15 offset:3328
    ds_read_u16_d16_hi v116, v15 offset:320
    ds_read_u16_d16_hi v117, v15 offset:1344
    ds_read_u16_d16_hi v132, v15 offset:2368
    ds_read_u16_d16_hi v133, v15 offset:3392
    ds_read_u16_d16_hi v118, v15 offset:512
    ds_read_u16_d16_hi v119, v15 offset:1536
    ds_read_u16_d16_hi v134, v15 offset:2560
    ds_read_u16_d16_hi v135, v15 offset:3584
    ds_read_u16_d16_hi v120, v15 offset:576
    ds_read_u16_d16_hi v121, v15 offset:1600
    ds_read_u16_d16_hi v136, v15 offset:2624
    ds_read_u16_d16_hi v137, v15 offset:3648
    ds_read_u16_d16_hi v122, v15 offset:768
    ds_read_u16_d16_hi v123, v15 offset:1792
    ds_read_u16_d16_hi v138, v15 offset:2816
    ds_read_u16_d16_hi v139, v15 offset:3840
    ds_read_u16_d16_hi v124, v15 offset:832
    ds_read_u16_d16_hi v125, v15 offset:1856
    ds_read_u16_d16_hi v140, v15 offset:2880
    ds_read_u16_d16_hi v141, v15 offset:3904
    s_waitcnt vmcnt(0) lgkmcnt(0)
    s_barrier
    ds_read_b64 v[78:79], v14 offset:0
    ds_read_b64 v[80:81], v14 offset:2048
    ds_read_b64 v[82:83], v14 offset:512
    ds_read_b64 v[84:85], v14 offset:2560
    ds_read_b64 v[86:87], v14 offset:4096
    ds_read_b64 v[88:89], v14 offset:6144
    ds_read_b64 v[90:91], v14 offset:4608
    ds_read_b64 v[92:93], v14 offset:6656
    ds_read_b64 v[94:95], v14 offset:8192
    ds_read_b64 v[96:97], v14 offset:10240
    ds_read_b64 v[98:99], v14 offset:8704
    ds_read_b64 v[100:101], v14 offset:10752
    s_waitcnt lgkmcnt(8)
    v_swap_b32 v79, v82
    v_swap_b32 v81, v84
    s_waitcnt lgkmcnt(4)
    v_swap_b32 v87, v90
    v_swap_b32 v89, v92
    ds_read_b64 v[102:103], v14 offset:12288
    ds_read_b64 v[104:105], v14 offset:14336
    ds_read_b64 v[106:107], v14 offset:12800
    ds_read_b64 v[108:109], v14 offset:14848
    v_mfma_f32_32x32x16_bf16 v[24:39], v[46:49], v[78:81], 0
    v_mfma_f32_32x32x16_bf16 v[142:157], v[46:49], v[82:85], 0
    s_waitcnt lgkmcnt(4)
    v_swap_b32 v95, v98
    v_swap_b32 v97, v100
    ds_read_b64 v[78:79], v14 offset:16384
    ds_read_b64 v[80:81], v14 offset:18432
    ds_read_b64 v[82:83], v14 offset:16896
    ds_read_b64 v[84:85], v14 offset:18944
    v_mfma_f32_32x32x16_bf16 v[24:39], v[50:53], v[86:89], v[24:39]
    v_mfma_f32_32x32x16_bf16 v[142:157], v[50:53], v[90:93], v[142:157]
    s_waitcnt lgkmcnt(4)
    v_swap_b32 v103, v106
    v_swap_b32 v105, v108
    ds_read_b64 v[86:87], v14 offset:20480
    ds_read_b64 v[88:89], v14 offset:22528
    ds_read_b64 v[90:91], v14 offset:20992
    ds_read_b64 v[92:93], v14 offset:23040
    v_mfma_f32_32x32x16_bf16 v[24:39], v[54:57], v[94:97], v[24:39]
    v_mfma_f32_32x32x16_bf16 v[142:157], v[54:57], v[98:101], v[142:157]
    s_waitcnt lgkmcnt(4)
    v_swap_b32 v79, v82
    v_swap_b32 v81, v84
    ds_read_b64 v[94:95], v14 offset:24576
    ds_read_b64 v[96:97], v14 offset:26624
    ds_read_b64 v[98:99], v14 offset:25088
    ds_read_b64 v[100:101], v14 offset:27136
    v_mfma_f32_32x32x16_bf16 v[24:39], v[58:61], v[102:105], v[24:39]
    v_mfma_f32_32x32x16_bf16 v[142:157], v[58:61], v[106:109], v[142:157]
    s_waitcnt lgkmcnt(4)
    v_swap_b32 v87, v90
    v_swap_b32 v89, v92
    ds_read_b64 v[102:103], v14 offset:28672
    ds_read_b64 v[104:105], v14 offset:30720
    ds_read_b64 v[106:107], v14 offset:29184
    ds_read_b64 v[108:109], v14 offset:31232
    v_mfma_f32_32x32x16_bf16 v[24:39], v[62:65], v[78:81], v[24:39]
    v_mfma_f32_32x32x16_bf16 v[142:157], v[62:65], v[82:85], v[142:157]
    s_waitcnt lgkmcnt(4)
    v_swap_b32 v95, v98
    v_swap_b32 v97, v100
    v_mfma_f32_32x32x16_bf16 v[24:39], v[66:69], v[86:89], v[24:39]
    v_mfma_f32_32x32x16_bf16 v[142:157], v[66:69], v[90:93], v[142:157]
    s_waitcnt lgkmcnt(0)
    v_swap_b32 v103, v106
    v_swap_b32 v105, v108
    v_mfma_f32_32x32x16_bf16 v[24:39], v[70:73], v[94:97], v[24:39]
    v_mfma_f32_32x32x16_bf16 v[142:157], v[70:73], v[98:101], v[142:157]
    v_mfma_f32_32x32x16_bf16 v[24:39], v[74:77], v[102:105], v[24:39]
    v_mfma_f32_32x32x16_bf16 v[142:157], v[74:77], v[106:109], v[142:157]
    v_cmp_eq_u32 vcc, 0, v41
    v_add_u32 v15, s57, v2
    s_lshl_b32 s47, s41, 11
    v_add_u32 v14, s47, v15
    s_nop 11
    s_barrier
    s_waitcnt lgkmcnt(0)
    s_cmp_eq_u32 s55, 0
    s_cbranch_scc1 S_mid0
    v_pk_add_f32 v[78:79], v[24:25], v[142:143] op_sel:[0,1] op_sel_hi:[1,0] neg_lo:[0,1]
    v_pk_add_f32 v[80:81], v[24:25], v[142:143] op_sel:[0,1] op_sel_hi:[1,0] neg_hi:[0,1]
    v_pk_mul_f32 v[82:83], v[78:79], v[110:111] op_sel_hi:[0,1]
    v_pk_mul_f32 v[84:85], v[80:81], v[126:127] op_sel_hi:[0,1]
    v_pk_fma_f32 v[82:83], v[78:79], v[110:111], v[82:83] op_sel:[1,1,0] op_sel_hi:[1,0,1] neg_hi:[0,1,0]
    v_pk_fma_f32 v[84:85], v[80:81], v[126:127], v[84:85] op_sel:[1,1,0] op_sel_hi:[1,0,1] neg_hi:[0,1,0]
    v_pk_add_f32 v[86:87], v[82:83], v[84:85]
    v_pk_add_f32 v[88:89], v[82:83], v[84:85] neg_lo:[0,1] neg_hi:[0,1]
    v_cvt_pk_bf16_f32 v94, v86, v87
    v_cvt_pk_bf16_f32 v102, v89, -v88
    v_pk_add_f32 v[78:79], v[26:27], v[144:145] op_sel:[0,1] op_sel_hi:[1,0] neg_lo:[0,1]
    v_pk_add_f32 v[80:81], v[26:27], v[144:145] op_sel:[0,1] op_sel_hi:[1,0] neg_hi:[0,1]
    v_pk_mul_f32 v[82:83], v[78:79], v[112:113] op_sel_hi:[0,1]
    v_pk_mul_f32 v[84:85], v[80:81], v[128:129] op_sel_hi:[0,1]
    v_pk_fma_f32 v[82:83], v[78:79], v[112:113], v[82:83] op_sel:[1,1,0] op_sel_hi:[1,0,1] neg_hi:[0,1,0]
    v_pk_fma_f32 v[84:85], v[80:81], v[128:129], v[84:85] op_sel:[1,1,0] op_sel_hi:[1,0,1] neg_hi:[0,1,0]
    v_pk_add_f32 v[86:87], v[82:83], v[84:85]
    v_pk_add_f32 v[88:89], v[82:83], v[84:85] neg_lo:[0,1] neg_hi:[0,1]
    v_cvt_pk_bf16_f32 v95, v86, v87
    v_cvt_pk_bf16_f32 v103, v89, -v88
    v_pk_add_f32 v[78:79], v[28:29], v[146:147] op_sel:[0,1] op_sel_hi:[1,0] neg_lo:[0,1]
    v_pk_add_f32 v[80:81], v[28:29], v[146:147] op_sel:[0,1] op_sel_hi:[1,0] neg_hi:[0,1]
    v_pk_mul_f32 v[82:83], v[78:79], v[114:115] op_sel_hi:[0,1]
    v_pk_mul_f32 v[84:85], v[80:81], v[130:131] op_sel_hi:[0,1]
    v_pk_fma_f32 v[82:83], v[78:79], v[114:115], v[82:83] op_sel:[1,1,0] op_sel_hi:[1,0,1] neg_hi:[0,1,0]
    v_pk_fma_f32 v[84:85], v[80:81], v[130:131], v[84:85] op_sel:[1,1,0] op_sel_hi:[1,0,1] neg_hi:[0,1,0]
    v_pk_add_f32 v[86:87], v[82:83], v[84:85]
    v_pk_add_f32 v[88:89], v[82:83], v[84:85] neg_lo:[0,1] neg_hi:[0,1]
    v_cvt_pk_bf16_f32 v96, v86, v87
    v_cvt_pk_bf16_f32 v104, v89, -v88
    v_pk_add_f32 v[78:79], v[30:31], v[148:149] op_sel:[0,1] op_sel_hi:[1,0] neg_lo:[0,1]
    v_pk_add_f32 v[80:81], v[30:31], v[148:149] op_sel:[0,1] op_sel_hi:[1,0] neg_hi:[0,1]
    v_pk_mul_f32 v[82:83], v[78:79], v[116:117] op_sel_hi:[0,1]
    v_pk_mul_f32 v[84:85], v[80:81], v[132:133] op_sel_hi:[0,1]
    v_pk_fma_f32 v[82:83], v[78:79], v[116:117], v[82:83] op_sel:[1,1,0] op_sel_hi:[1,0,1] neg_hi:[0,1,0]
    v_pk_fma_f32 v[84:85], v[80:81], v[132:133], v[84:85] op_sel:[1,1,0] op_sel_hi:[1,0,1] neg_hi:[0,1,0]
    v_pk_add_f32 v[86:87], v[82:83], v[84:85]
    v_pk_add_f32 v[88:89], v[82:83], v[84:85] neg_lo:[0,1] neg_hi:[0,1]
    v_cvt_pk_bf16_f32 v97, v86, v87
    v_cvt_pk_bf16_f32 v105, v89, -v88
    v_pk_add_f32 v[78:79], v[32:33], v[150:151] op_sel:[0,1] op_sel_hi:[1,0] neg_lo:[0,1]
    v_pk_add_f32 v[80:81], v[32:33], v[150:151] op_sel:[0,1] op_sel_hi:[1,0] neg_hi:[0,1]
    v_pk_mul_f32 v[82:83], v[78:79], v[118:119] op_sel_hi:[0,1]
    v_pk_mul_f32 v[84:85], v[80:81], v[134:135] op_sel_hi:[0,1]
    v_pk_fma_f32 v[82:83], v[78:79], v[118:119], v[82:83] op_sel:[1,1,0] op_sel_hi:[1,0,1] neg_hi:[0,1,0]
    v_pk_fma_f32 v[84:85], v[80:81], v[134:135], v[84:85] op_sel:[1,1,0] op_sel_hi:[1,0,1] neg_hi:[0,1,0]
    v_pk_add_f32 v[86:87], v[82:83], v[84:85]
    v_pk_add_f32 v[88:89], v[82:83], v[84:85] neg_lo:[0,1] neg_hi:[0,1]
    v_cvt_pk_bf16_f32 v98, v86, v87
    v_cvt_pk_bf16_f32 v106, v89, -v88
    v_pk_add_f32 v[78:79], v[34:35], v[152:153] op_sel:[0,1] op_sel_hi:[1,0] neg_lo:[0,1]
    v_pk_add_f32 v[80:81], v[34:35], v[152:153] op_sel:[0,1] op_sel_hi:[1,0] neg_hi:[0,1]
    v_pk_mul_f32 v[82:83], v[78:79], v[120:121] op_sel_hi:[0,1]
    v_pk_mul_f32 v[84:85], v[80:81], v[136:137] op_sel_hi:[0,1]
    v_pk_fma_f32 v[82:83], v[78:79], v[120:121], v[82:83] op_sel:[1,1,0] op_sel_hi:[1,0,1] neg_hi:[0,1,0]
    v_pk_fma_f32 v[84:85], v[80:81], v[136:137], v[84:85] op_sel:[1,1,0] op_sel_hi:[1,0,1] neg_hi:[0,1,0]
    v_pk_add_f32 v[86:87], v[82:83], v[84:85]
    v_pk_add_f32 v[88:89], v[82:83], v[84:85] neg_lo:[0,1] neg_hi:[0,1]
    v_cvt_pk_bf16_f32 v99, v86, v87
    v_cvt_pk_bf16_f32 v107, v89, -v88
    v_pk_add_f32 v[78:79], v[36:37], v[154:155] op_sel:[0,1] op_sel_hi:[1,0] neg_lo:[0,1]
    v_pk_add_f32 v[80:81], v[36:37], v[154:155] op_sel:[0,1] op_sel_hi:[1,0] neg_hi:[0,1]
    v_pk_mul_f32 v[82:83], v[78:79], v[122:123] op_sel_hi:[0,1]
    v_pk_mul_f32 v[84:85], v[80:81], v[138:139] op_sel_hi:[0,1]
    v_pk_fma_f32 v[82:83], v[78:79], v[122:123], v[82:83] op_sel:[1,1,0] op_sel_hi:[1,0,1] neg_hi:[0,1,0]
    v_pk_fma_f32 v[84:85], v[80:81], v[138:139], v[84:85] op_sel:[1,1,0] op_sel_hi:[1,0,1] neg_hi:[0,1,0]
    v_pk_add_f32 v[86:87], v[82:83], v[84:85]
    v_pk_add_f32 v[88:89], v[82:83], v[84:85] neg_lo:[0,1] neg_hi:[0,1]
    v_cvt_pk_bf16_f32 v100, v86, v87
    v_cvt_pk_bf16_f32 v108, v89, -v88
    v_pk_add_f32 v[78:79], v[38:39], v[156:157] op_sel:[0,1] op_sel_hi:[1,0] neg_lo:[0,1]
    v_pk_add_f32 v[80:81], v[38:39], v[156:157] op_sel:[0,1] op_sel_hi:[1,0] neg_hi:[0,1]
    v_pk_mul_f32 v[82:83], v[78:79], v[124:125] op_sel_hi:[0,1]
    v_pk_mul_f32 v[84:85], v[80:81], v[140:141] op_sel_hi:[0,1]
    v_pk_fma_f32 v[82:83], v[78:79], v[124:125], v[82:83] op_sel:[1,1,0] op_sel_hi:[1,0,1] neg_hi:[0,1,0]
    v_pk_fma_f32 v[84:85], v[80:81], v[140:141], v[84:85] op_sel:[1,1,0] op_sel_hi:[1,0,1] neg_hi:[0,1,0]
    v_pk_add_f32 v[86:87], v[82:83], v[84:85]
    v_pk_add_f32 v[88:89], v[82:83], v[84:85] neg_lo:[0,1] neg_hi:[0,1]
    v_cvt_pk_bf16_f32 v101, v86, v87
    v_cvt_pk_bf16_f32 v109, v89, -v88
    s_branch S_mide
S_mid0:
    v_pk_mul_f32 v[82:83], v[24:25], v[110:111] op_sel_hi:[0,1]
    v_pk_mul_f32 v[84:85], v[142:143], v[126:127] op_sel_hi:[0,1]
    v_pk_fma_f32 v[82:83], v[24:25], v[110:111], v[82:83] op_sel:[1,1,0] op_sel_hi:[1,0,1] neg_hi:[0,1,0]
    v_pk_fma_f32 v[84:85], v[142:143], v[126:127], v[84:85] op_sel:[1,1,0] op_sel_hi:[1,0,1] neg_hi:[0,1,0]
    v_cvt_pk_bf16_f32 v94, v82, v83
    v_cvt_pk_bf16_f32 v102, v84, v85
    v_pk_mul_f32 v[82:83], v[26:27], v[112:113] op_sel_hi:[0,1]
    v_pk_mul_f32 v[84:85], v[144:145], v[128:129] op_sel_hi:[0,1]
    v_pk_fma_f32 v[82:83], v[26:27], v[112:113], v[82:83] op_sel:[1,1,0] op_sel_hi:[1,0,1] neg_hi:[0,1,0]
    v_pk_fma_f32 v[84:85], v[144:145], v[128:129], v[84:85] op_sel:[1,1,0] op_sel_hi:[1,0,1] neg_hi:[0,1,0]
    v_cvt_pk_bf16_f32 v95, v82, v83
    v_cvt_pk_bf16_f32 v103, v84, v85
    v_pk_mul_f32 v[82:83], v[28:29], v[114:115] op_sel_hi:[0,1]
    v_pk_mul_f32 v[84:85], v[146:147], v[130:131] op_sel_hi:[0,1]
    v_pk_fma_f32 v[82:83], v[28:29], v[114:115], v[82:83] op_sel:[1,1,0] op_sel_hi:[1,0,1] neg_hi:[0,1,0]
    v_pk_fma_f32 v[84:85], v[146:147], v[130:131], v[84:85] op_sel:[1,1,0] op_sel_hi:[1,0,1] neg_hi:[0,1,0]
    v_cvt_pk_bf16_f32 v96, v82, v83
    v_cvt_pk_bf16_f32 v104, v84, v85
    v_pk_mul_f32 v[82:83], v[30:31], v[116:117] op_sel_hi:[0,1]
    v_pk_mul_f32 v[84:85], v[148:149], v[132:133] op_sel_hi:[0,1]
    v_pk_fma_f32 v[82:83], v[30:31], v[116:117], v[82:83] op_sel:[1,1,0] op_sel_hi:[1,0,1] neg_hi:[0,1,0]
    v_pk_fma_f32 v[84:85], v[148:149], v[132:133], v[84:85] op_sel:[1,1,0] op_sel_hi:[1,0,1] neg_hi:[0,1,0]
    v_cvt_pk_bf16_f32 v97, v82, v83
    v_cvt_pk_bf16_f32 v105, v84, v85
    v_pk_mul_f32 v[82:83], v[32:33], v[118:119] op_sel_hi:[0,1]
    v_pk_mul_f32 v[84:85], v[150:151], v[134:135] op_sel_hi:[0,1]
    v_pk_fma_f32 v[82:83], v[32:33], v[118:119], v[82:83] op_sel:[1,1,0] op_sel_hi:[1,0,1] neg_hi:[0,1,0]
    v_pk_fma_f32 v[84:85], v[150:151], v[134:135], v[84:85] op_sel:[1,1,0] op_sel_hi:[1,0,1] neg_hi:[0,1,0]
    v_cvt_pk_bf16_f32 v98, v82, v83
    v_cvt_pk_bf16_f32 v106, v84, v85
    v_pk_mul_f32 v[82:83], v[34:35], v[120:121] op_sel_hi:[0,1]
    v_pk_mul_f32 v[84:85], v[152:153], v[136:137] op_sel_hi:[0,1]
    v_pk_fma_f32 v[82:83], v[34:35], v[120:121], v[82:83] op_sel:[1,1,0] op_sel_hi:[1,0,1] neg_hi:[0,1,0]
    v_pk_fma_f32 v[84:85], v[152:153], v[136:137], v[84:85] op_sel:[1,1,0] op_sel_hi:[1,0,1] neg_hi:[0,1,0]
    v_cvt_pk_bf16_f32 v99, v82, v83
    v_cvt_pk_bf16_f32 v107, v84, v85
    v_pk_mul_f32 v[82:83], v[36:37], v[122:123] op_sel_hi:[0,1]
    v_pk_mul_f32 v[84:85], v[154:155], v[138:139] op_sel_hi:[0,1]
    v_pk_fma_f32 v[82:83], v[36:37], v[122:123], v[82:83] op_sel:[1,1,0] op_sel_hi:[1,0,1] neg_hi:[0,1,0]
    v_pk_fma_f32 v[84:85], v[154:155], v[138:139], v[84:85] op_sel:[1,1,0] op_sel_hi:[1,0,1] neg_hi:[0,1,0]
    v_cvt_pk_bf16_f32 v100, v82, v83
    v_cvt_pk_bf16_f32 v108, v84, v85
    v_pk_mul_f32 v[82:83], v[38:39], v[124:125] op_sel_hi:[0,1]
    v_pk_mul_f32 v[84:85], v[156:157], v[140:141] op_sel_hi:[0,1]
    v_pk_fma_f32 v[82:83], v[38:39], v[124:125], v[82:83] op_sel:[1,1,0] op_sel_hi:[1,0,1] neg_hi:[0,1,0]
    v_pk_fma_f32 v[84:85], v[156:157], v[140:141], v[84:85] op_sel:[1,1,0] op_sel_hi:[1,0,1] neg_hi:[0,1,0]
    v_cvt_pk_bf16_f32 v101, v82, v83
    v_cvt_pk_bf16_f32 v109, v84, v85
S_mide:
    s_cmp_lg_u32 s54, 5
    s_cbranch_scc1 S_nomask
    v_cndmask_b32 v94, 0, v94, vcc
    v_cndmask_b32 v95, 0, v95, vcc
    v_cndmask_b32 v96, 0, v96, vcc
    v_cndmask_b32 v97, 0, v97, vcc
    v_cndmask_b32 v98, 0, v98, vcc
    v_cndmask_b32 v99, 0, v99, vcc
    v_cndmask_b32 v100, 0, v100, vcc
    v_cndmask_b32 v101, 0, v101, vcc
    v_cndmask_b32 v102, 0, v102, vcc
    v_cndmask_b32 v103, 0, v103, vcc
    v_cndmask_b32 v104, 0, v104, vcc
    v_cndmask_b32 v105, 0, v105, vcc
    v_cndmask_b32 v106, 0, v106, vcc
    v_cndmask_b32 v107, 0, v107, vcc
    v_cndmask_b32 v108, 0, v108, vcc
    v_cndmask_b32 v109, 0, v109, vcc
S_nomask:
    ds_write_b128 v14, v[94:97] offset:0
    ds_write_b128 v14, v[98:101] offset:1024
    ds_write_b128 v14, v[102:105] offset:8192
    ds_write_b128 v14, v[106:109] offset:9216
    s_waitcnt lgkmcnt(0)
    s_barrier
    ds_read_b128 v[78:81], v15 offset:0
    ds_read_b128 v[82:85], v15 offset:8192
    ds_read_b128 v[86:89], v15 offset:1024
    ds_read_b128 v[90:93], v15 offset:9216
    ds_read_b128 v[94:97], v15 offset:2048
    ds_read_b128 v[98:101], v15 offset:10240
    ds_read_b128 v[102:105], v15 offset:3072
    ds_read_b128 v[106:109], v15 offset:11264
    ds_read_b128 v[110:113], v15 offset:4096
    ds_read_b128 v[114:117], v15 offset:12288
    ds_read_b128 v[118:121], v15 offset:5120
    ds_read_b128 v[122:125], v15 offset:13312
    ds_read_b128 v[126:129], v15 offset:6144
    ds_read_b128 v[130:133], v15 offset:14336
    s_waitcnt lgkmcnt(12)
    v_mfma_f32_32x32x16_bf16 v[24:39], v[78:81], v[46:49], 0
    v_mfma_f32_32x32x16_bf16 v[142:157], v[82:85], v[46:49], 0
    ds_read_b128 v[134:137], v15 offset:7168
    ds_read_b128 v[138:141], v15 offset:15360
    s_waitcnt lgkmcnt(12)
    v_mfma_f32_32x32x16_bf16 v[24:39], v[86:89], v[50:53], v[24:39]
    v_mfma_f32_32x32x16_bf16 v[142:157], v[90:93], v[50:53], v[142:157]
    s_waitcnt lgkmcnt(10)
    v_mfma_f32_32x32x16_bf16 v[24:39], v[94:97], v[54:57], v[24:39]
    v_mfma_f32_32x32x16_bf16 v[142:157], v[98:101], v[54:57], v[142:157]
    s_waitcnt lgkmcnt(8)
    v_mfma_f32_32x32x16_bf16 v[24:39], v[102:105], v[58:61], v[24:39]
    v_mfma_f32_32x32x16_bf16 v[142:157], v[106:109], v[58:61], v[142:157]
    s_waitcnt lgkmcnt(6)
    v_mfma_f32_32x32x16_bf16 v[24:39], v[110:113], v[62:65], v[24:39]
    v_mfma_f32_32x32x16_bf16 v[142:157], v[114:117], v[62:65], v[142:157]
    s_waitcnt lgkmcnt(4)
    v_mfma_f32_32x32x16_bf16 v[24:39], v[118:121], v[66:69], v[24:39]
    v_mfma_f32_32x32x16_bf16 v[142:157], v[122:125], v[66:69], v[142:157]
    s_waitcnt lgkmcnt(2)
    v_mfma_f32_32x32x16_bf16 v[24:39], v[126:129], v[70:73], v[24:39]
    v_mfma_f32_32x32x16_bf16 v[142:157], v[130:133], v[70:73], v[142:157]
    s_waitcnt lgkmcnt(0)
    v_mfma_f32_32x32x16_bf16 v[24:39], v[134:137], v[74:77], v[24:39]
    v_mfma_f32_32x32x16_bf16 v[142:157], v[138:141], v[74:77], v[142:157]
    v_lshrrev_b32 v3, 4, v1
    v_lshlrev_b32 v5, 5, v3
    v_xor_b32 v14, v5, v2
    s_lshl_b32 s47, s40, 12
    s_add_u32 s47, s47, 65536
    v_add_u32 v14, s47, v14
    v_mul_u32_u24 v15, 45056, v3
    v_bfe_u32 v3, v1, 3, 1
    v_mul_u32_u24 v3, 22528, v3
    v_and_b32 v5, 0x70, v2
    v_add3_u32 v15, v15, v3, v5
    s_cmp_gt_u32 s54, 5
    s_subb_u32 s58, s54, 0
    s_cmp_eq_u32 s54, 5
    s_cselect_b32 s58, 10, s58
    s_lshl_b32 s58, s58, 4
    s_add_u32 s58, s58, s55
    s_lshl_b32 s58, s58, 7
    s_mul_i32 s47, s41, 720896
    s_add_u32 s58, s58, s47
    s_cmp_lg_u32 s55, 0
    s_cbranch_scc1 S_norot
    v_mul_f32 v78, v142, v44
    v_mul_f32 v79, v143, v44
    v_mul_f32 v80, v144, v44
    v_mul_f32 v81, v145, v44
    v_mul_f32 v82, v146, v44
    v_mul_f32 v83, v147, v44
    v_mul_f32 v84, v148, v44
    v_mul_f32 v85, v149, v44
    v_mul_f32 v86, v150, v44
    v_mul_f32 v87, v151, v44
    v_mul_f32 v88, v152, v44
    v_mul_f32 v89, v153, v44
    v_mul_f32 v90, v154, v44
    v_mul_f32 v91, v155, v44
    v_mul_f32 v92, v156, v44
    v_mul_f32 v93, v157, v44
    v_fmac_f32_dpp v78, v142, v45 quad_perm:[1,0,3,2] row_mask:0xf bank_mask:0xf
    v_fmac_f32_dpp v79, v143, v45 quad_perm:[1,0,3,2] row_mask:0xf bank_mask:0xf
    v_fmac_f32_dpp v80, v144, v45 quad_perm:[1,0,3,2] row_mask:0xf bank_mask:0xf
    v_fmac_f32_dpp v81, v145, v45 quad_perm:[1,0,3,2] row_mask:0xf bank_mask:0xf
    v_fmac_f32_dpp v82, v146, v45 quad_perm:[1,0,3,2] row_mask:0xf bank_mask:0xf
    v_fmac_f32_dpp v83, v147, v45 quad_perm:[1,0,3,2] row_mask:0xf bank_mask:0xf
    v_fmac_f32_dpp v84, v148, v45 quad_perm:[1,0,3,2] row_mask:0xf bank_mask:0xf
    v_fmac_f32_dpp v85, v149, v45 quad_perm:[1,0,3,2] row_mask:0xf bank_mask:0xf
    v_fmac_f32_dpp v86, v150, v45 quad_perm:[1,0,3,2] row_mask:0xf bank_mask:0xf
    v_fmac_f32_dpp v87, v151, v45 quad_perm:[1,0,3,2] row_mask:0xf bank_mask:0xf
    v_fmac_f32_dpp v88, v152, v45 quad_perm:[1,0,3,2] row_mask:0xf bank_mask:0xf
    v_fmac_f32_dpp v89, v153, v45 quad_perm:[1,0,3,2] row_mask:0xf bank_mask:0xf
    v_fmac_f32_dpp v90, v154, v45 quad_perm:[1,0,3,2] row_mask:0xf bank_mask:0xf
    v_fmac_f32_dpp v91, v155, v45 quad_perm:[1,0,3,2] row_mask:0xf bank_mask:0xf
    v_fmac_f32_dpp v92, v156, v45 quad_perm:[1,0,3,2] row_mask:0xf bank_mask:0xf
    v_fmac_f32_dpp v93, v157, v45 quad_perm:[1,0,3,2] row_mask:0xf bank_mask:0xf
    v_mov_b32 v142, v78
    v_mov_b32 v143, v79
    v_mov_b32 v144, v80
    v_mov_b32 v145, v81
    v_mov_b32 v146, v82
    v_mov_b32 v147, v83
    v_mov_b32 v148, v84
    v_mov_b32 v149, v85
    v_mov_b32 v150, v86
    v_mov_b32 v151, v87
    v_mov_b32 v152, v88
    v_mov_b32 v153, v89
    v_mov_b32 v154, v90
    v_mov_b32 v155, v91
    v_mov_b32 v156, v92
    v_mov_b32 v157, v93
S_norot:
    v_cvt_pk_bf16_f32 v24, v24, v25
    v_cvt_pk_bf16_f32 v25, v26, v27
    v_cvt_pk_bf16_f32 v26, v28, v29
    v_cvt_pk_bf16_f32 v27, v30, v31
    v_cvt_pk_bf16_f32 v28, v32, v33
    v_cvt_pk_bf16_f32 v29, v34, v35
    v_cvt_pk_bf16_f32 v30, v36, v37
    v_cvt_pk_bf16_f32 v31, v38, v39
    ds_write_b128 v42, v[24:27] offset:0
    ds_write_b128 v42, v[28:31] offset:128
    v_cvt_pk_bf16_f32 v142, v142, v143
    v_cvt_pk_bf16_f32 v143, v144, v145
    v_cvt_pk_bf16_f32 v144, v146, v147
    v_cvt_pk_bf16_f32 v145, v148, v149
    v_cvt_pk_bf16_f32 v146, v150, v151
    v_cvt_pk_bf16_f32 v147, v152, v153
    v_cvt_pk_bf16_f32 v148, v154, v155
    v_cvt_pk_bf16_f32 v149, v156, v157
    ds_write_b128 v43, v[142:145] offset:0
    ds_write_b128 v43, v[146:149] offset:128
    ds_read_b128 v[78:81], v14 offset:0
    ds_read_b128 v[82:85], v14 offset:1024
    ds_read_b128 v[86:89], v14 offset:2048
    ds_read_b128 v[90:93], v14 offset:3072
    s_waitcnt lgkmcnt(3)
    buffer_store_dwordx4 v[78:81], v15, s[32:35], s58 offen sc1
    s_add_u32 s58, s58, 180224
    s_waitcnt lgkmcnt(2)
    buffer_store_dwordx4 v[82:85], v15, s[32:35], s58 offen sc1
    s_add_u32 s58, s58, 180224
    s_waitcnt lgkmcnt(1)
    buffer_store_dwordx4 v[86:89], v15, s[32:35], s58 offen sc1
    s_add_u32 s58, s58, 180224
    s_waitcnt lgkmcnt(0)
    buffer_store_dwordx4 v[90:93], v15, s[32:35], s58 offen sc1
    s_add_u32 s58, s58, 180224
    s_and_b32 s46, s2, 7
    s_mul_i32 s46, s46, 11
    s_add_u32 s46, s46, s54
    s_add_u32 s46, s46, 1152
    s_lshl_b32 s46, s46, 7
    s_cmp_lg_u32 s40, 0
    s_cselect_b32 s46, 2130706432, s46
    s_waitcnt vmcnt(0)
    s_barrier
    v_mov_b32 v3, s46
    s_mov_b64 exec, 1
    buffer_store_dword v6, v3, s[36:39], 0 offen sc1
    s_mov_b64 exec, -1
    s_endpgm
S_not2:
    s_sub_u32 s47, s2, s40
    s_cmp_lg_u32 s47, 255
    s_cbranch_scc1 S_fin
    v_lshlrev_b32 v4, 7, v1
    v_add_u32 v20, 0, v4
    v_add_u32 v21, 8192, v4
    v_add_u32 v22, 16384, v4
    v_add_u32 v23, 24576, v4
    s_mov_b32 s50, 0
S_ep:
    buffer_load_dword v16, v20, s[36:39], 0 offen sc1
    buffer_load_dword v17, v21, s[36:39], 0 offen sc1
    buffer_load_dword v18, v22, s[36:39], 0 offen sc1
    buffer_load_dword v19, v23, s[36:39], 0 offen sc1
    s_add_u32 s50, s50, 1
    s_waitcnt vmcnt(0)
    v_xor_b32 v16, v16, v6
    v_xor_b32 v17, v17, v6
    v_xor_b32 v18, v18, v6
    v_xor_b32 v19, v19, v6
    v_or_b32 v16, v16, v17
    v_or_b32 v16, v16, v18
    v_or_b32 v16, v16, v19
    v_cmp_ne_u32 vcc, 0, v16
    s_cmp_ge_u32 s50, 131072
    s_cbranch_scc1 S_ep_e
    s_cbranch_vccz S_ep_e
    s_mov_b64 exec, vcc
    s_sleep 8
    s_branch S_ep
S_ep_e:
    s_mov_b64 exec, -1
S_ep_ok:
    s_mov_b32 s47, 289792
    v_mov_b32 v3, s47
    s_mov_b64 exec, 1
    buffer_store_dword v6, v3, s[36:39], 0 offen sc1
    s_mov_b64 exec, -1
S_fin:
    s_endpgm
code_end:
.section .rodata,"a"
.p2align 6
.amdhsa_kernel parallel_sum__spectral_gfnet__dense_activation_gelu__prompt_kernel
  .amdhsa_next_free_vgpr 256
  .amdhsa_next_free_sgpr 102
  .amdhsa_accum_offset 256
  .amdhsa_group_segment_fixed_size 0
  .amdhsa_kernarg_size 88
  .amdhsa_user_sgpr_count 2
  .amdhsa_user_sgpr_kernarg_segment_ptr 1
  .amdhsa_system_sgpr_workgroup_id_x 1
.end_amdhsa_kernel
```
